```python
import torch

def _softmax(x, axis=-1):
    return torch.softmax(x, dim=axis)

def _gelu(x):
    return torch.nn.functional.gelu(x, approximate='tanh')

def _silu(x):
    return torch.nn.functional.silu(x)

def _sigmoid(x):
    return torch.sigmoid(x)

def _layernorm(x, axis=-1, eps=1e-05):
    m = x.mean(dim=axis, keepdim=True)
    v = x.var(dim=axis, keepdim=True, unbiased=False)
    return (x - m) / torch.sqrt(v + eps)

def _scatter_add(tgt, idx, src, axis=0):
    return tgt.clone().index_add_(axis, idx, src)

def _segment_sum(src, seg, n):
    out = torch.zeros((n,) + src.shape[1:], dtype=src.dtype)
    return out.index_add_(0, seg, src)

def _pad(x, pw):
    flat = tuple((v for pair in reversed(pw) for v in pair))
    return torch.nn.functional.pad(x, flat)
kernel_name = 'gated_mix__linear_kernel_hedgehog__memory_aug_recurrent_mem_tr__prompt'

def setup_inputs():

    _w = lambda a: (lambda t: t.to(torch.bfloat16) if t.is_floating_point() else t)(torch.as_tensor(a))

    def _A_setup():
        B, S, D, H = (1, 2048, 448, 16)
        Dh = D // H
        return {'x': _w((lambda *s: torch.randn(*s, dtype=torch.bfloat16) * 0.05)(B, S, D)), 'wqkv': _w((lambda *s: torch.randn(*s, dtype=torch.bfloat16) * 1.6)(D, 3 * D)), 'w_phi': _w((lambda *s: torch.randn(*s, dtype=torch.bfloat16) * 1.6)(H, Dh, Dh) * Dh ** (-0.5)), 'wo': _w((lambda *s: torch.randn(*s, dtype=torch.bfloat16) * 0.05)(D, D))}
    _A_in = _A_setup()

    def _B_setup():
        B, S, Dm = (1, 2048, 448)
        H, Dh = (16, 256)
        M, seg = (8, 32)
        seg = min(seg, S)
        S = S // seg * seg
        return {'x': _w((lambda *s: torch.randn(*s, dtype=torch.bfloat16) * 0.05)(B, S, Dm)), 'mem0': _w((lambda *s: torch.randn(*s, dtype=torch.bfloat16) * 0.8)(B, M, Dm)), 'Wq': _w((lambda *s: torch.randn(*s, dtype=torch.bfloat16) * 1.6)(Dm, H, Dh) * Dm ** (-0.5)), 'Wk': _w((lambda *s: torch.randn(*s, dtype=torch.bfloat16) * 1.6)(Dm, H, Dh) * Dm ** (-0.5)), 'Wv': _w((lambda *s: torch.randn(*s, dtype=torch.bfloat16) * 0.8)(Dm, H, Dh) * Dm ** (-0.5)), 'Wo': _w((lambda *s: torch.randn(*s, dtype=torch.bfloat16) * 0.8)(H, Dh, Dm) * (H * Dh) ** (-0.5)), 'seg_len': seg}
    _B_in = _B_setup()
    return {'A_x': _A_in['x'], 'A_wqkv': _A_in['wqkv'], 'A_w_phi': _A_in['w_phi'], 'A_wo': _A_in['wo'], 'B_x': _B_in['x'], 'B_mem0': _B_in['mem0'], 'B_Wq': _B_in['Wq'], 'B_Wk': _B_in['Wk'], 'B_Wv': _B_in['Wv'], 'B_Wo': _B_in['Wo'], 'B_seg_len': _B_in['seg_len'], 'gate_w': _w((lambda *s: torch.randn(*s, dtype=torch.bfloat16) * 0.05)(448) * 16.0)}

def reference(A_x, A_wqkv, A_w_phi, A_wo, B_x, B_mem0, B_Wq, B_Wk, B_Wv, B_Wo, B_seg_len, gate_w):

    def _A_ref(x, wqkv, w_phi, wo):
        B, S, D = x.shape
        H = 16
        Dh = D // H
        qkv = (lambda x, *d: x.permute(*d))((x @ wqkv).reshape(B, S, 3, H, Dh), 2, 0, 3, 1, 4)
        q, k, v = (qkv[0], qkv[1], qkv[2])
        pq = torch.einsum('bhsd,hdf->bhsf', q, w_phi)
        pk = torch.einsum('bhsd,hdf->bhsf', k, w_phi)
        phi_q = torch.concatenate([_softmax(pq, axis=-1), _softmax(-pq, axis=-1)], axis=-1)
        phi_k = torch.concatenate([_softmax(pk, axis=-1), _softmax(-pk, axis=-1)], axis=-1)
        kv = torch.einsum('bhsf,bhsd->bhfd', phi_k, v)
        z = torch.einsum('bhsf->bhf', phi_k)
        num = torch.einsum('bhqf,bhfd->bhqd', phi_q, kv)
        den = torch.einsum('bhqf,bhf->bhq', phi_q, z)[..., None] + 1e-06
        o = num / den
        return (lambda x, *d: x.permute(*d))(o, 0, 2, 1, 3).reshape(B, S, D) @ wo

    def _B_ref(x, mem0, Wq, Wk, Wv, Wo, seg_len):
        B, S, Dm = x.shape
        H, Dh = (Wq.shape[1], Wq.shape[2])
        M = mem0.shape[1]
        scale = Dh ** (-0.5)
        n_seg = S // seg_len
        L = M + seg_len
        idx = torch.arange(L)
        mask = (idx[:, None] < M) | (idx[:, None] >= idx[None, :])
        mem = mem0
        outs = []
        for s in range(n_seg):
            xs = x[:, s * seg_len:(s + 1) * seg_len, :].clone()
            h = torch.concatenate([mem, xs], axis=1)
            q = torch.einsum('btd,dhe->bhte', h, Wq)
            k = torch.einsum('btd,dhe->bhte', h, Wk)
            v = torch.einsum('btd,dhe->bhte', h, Wv)
            scores = torch.einsum('bhqe,bhke->bhqk', q, k) * scale
            scores = torch.where(mask[None, None], scores, -1000000000.0)
            p = _softmax(scores, axis=-1)
            o = torch.einsum('bhqk,bhke->bhqe', p, v)
            o = torch.einsum('bhte,hed->btd', o, Wo)
            mem = o[:, :M, :].clone()
            outs.append(o[:, M:, :])
        return torch.concatenate(outs, axis=1)
    x = A_x
    g = _sigmoid((x * gate_w).sum(-1, keepdims=True))
    a = _A_ref(x, A_wqkv, A_w_phi, A_wo)
    b = _B_ref(x, B_mem0, B_Wq, B_Wk, B_Wv, B_Wo, B_seg_len)
    return g * a + (1 - g) * b
```

```asm
; @launch grid=(256,1,1) block=(256,1,1) lds=151552
.amdgcn_target "amdgcn-amd-amdhsa--gfx950"
.text
.globl gated_mix__linear_kernel_hedgehog__memory_aug_recurrent_mem_tr__prompt_kernel
.p2align 8
.type gated_mix__linear_kernel_hedgehog__memory_aug_recurrent_mem_tr__prompt_kernel,@function
gated_mix__linear_kernel_hedgehog__memory_aug_recurrent_mem_tr__prompt_kernel:
    s_cmp_ge_u32 s2, 256
    s_cbranch_scc1 L_end
    s_getpc_b64 s[26:27]
L_pc:
    s_bfe_u32 s24, s2, 0x30003
    s_lshl_b32 s24, s24, 15
    v_lshlrev_b32 v1, 7, v0
    v_add_u32 v1, s24, v1
    v_min_u32 v1, L_end-L_pc, v1
    global_load_dword v117, v1, s[26:27]
    s_load_dwordx2 s[8:9], s[0:1], 0
    s_load_dwordx2 s[40:41], s[0:1], 104
    s_load_dwordx2 s[4:5], s[0:1], 112
    s_getreg_b32 s3, hwreg(HW_REG_XCC_ID, 0, 4)
    s_and_b32 s3, s3, 7
    s_mov_b32 s6, 268435456
    s_mov_b32 s7, 0x20000
    s_mov_b32 s10, 1835008
    s_mov_b32 s11, 0x20000
    v_mov_b32 v119, v0
    s_mov_b32 s70, 0
    v_lshrrev_b32 v1, 6, v0
    s_nop 0
    v_readfirstlane_b32 s12, v1
    s_and_b32 s24, s2, 7
    s_lshl_b32 s13, s24, 5
    s_lshr_b32 s25, s2, 3
    s_add_u32 s13, s13, s25
    s_waitcnt lgkmcnt(0)
    s_cmp_lt_u32 s13, 16
    s_cbranch_scc1 L_S
    s_cmp_lt_u32 s13, 32
    s_cbranch_scc1 L_V
    v_and_b32 v20, 63, v119
    v_and_b32 v21, 15, v119
    v_bfe_u32 v22, v119, 4, 2
    s_sub_u32 s46, s13, 32
    s_lshl_b32 s24, s46, 2
    s_add_u32 s24, s24, s12
    s_cmp_lg_u32 s24, 3
    s_cbranch_scc1 L_inf_1
    v_lshlrev_b32 v24, 4, v20
    v_mov_b32 v4, 0
    v_mov_b32 v5, 0
    v_mov_b32 v6, 0
    v_mov_b32 v7, 0
    s_mov_b32 s24, 59768832
    s_mov_b32 s25, 59772928
    buffer_store_dwordx4 v[4:7], v24, s[4:7], s24 offen offset:0 sc1
    buffer_store_dwordx4 v[4:7], v24, s[4:7], s24 offen offset:1024 sc1
    buffer_store_dwordx4 v[4:7], v24, s[4:7], s24 offen offset:2048 sc1
    buffer_store_dwordx4 v[4:7], v24, s[4:7], s24 offen offset:3072 sc1
    buffer_store_dwordx4 v[4:7], v24, s[4:7], s25 offen offset:0 sc1
    buffer_store_dwordx4 v[4:7], v24, s[4:7], s25 offen offset:1024 sc1
    buffer_store_dwordx4 v[4:7], v24, s[4:7], s25 offen offset:2048 sc1
    buffer_store_dwordx4 v[4:7], v24, s[4:7], s25 offen offset:3072 sc1
    s_waitcnt vmcnt(0)
    v_mov_b32 v8, 1
    global_store_dword v4, v8, s[40:41] offset:128 sc1
L_inf_1:
    s_nop 0
    s_mul_i32 s14, s46, 4682
    s_lshr_b32 s14, s14, 16
    s_mul_i32 s26, s14, 14
    s_sub_u32 s19, s46, s26
    s_and_b32 s16, s19, 1
    s_and_b32 s15, s19, 14
    s_lshr_b32 s24, s12, 1
    s_add_u32 s15, s15, s24
    s_and_b32 s17, s12, 1
    v_lshrrev_b32 v6, 2, v20
    v_lshrrev_b32 v7, 5, v20
    v_lshlrev_b32 v7, 1, v7
    v_and_b32 v24, 3, v20
    v_xor_b32 v7, v7, v24
    v_and_b32 v24, 12, v6
    v_add_u32 v6, v6, v24
    s_mov_b32 s27, 8192
    v_mul_lo_u32 v24, v6, s27
    v_lshl_add_u32 v24, v7, 4, v24
    s_load_dwordx2 s[32:33], s[0:1], 64
    s_load_dwordx2 s[36:37], s[0:1], 72
    s_mov_b32 s34, 3670016
    s_mov_b32 s35, 0x20000
    s_mov_b32 s38, 3670016
    s_mov_b32 s39, 0x20000
    v_cmp_lt_u32 vcc, 27, v20
    v_mov_b32 v6, 448
    s_nop 0
    v_cndmask_b32 v6, 0, v6, vcc
    v_lshl_add_u32 v26, v20, 4, v6
    s_mul_i32 s24, s14, 229376
    s_mul_i32 s25, s12, 57344
    s_add_u32 s24, s24, s25
    s_mul_i32 s25, s16, 448
    s_add_u32 s24, s24, s25
    s_mul_i32 s25, s12, 28672
    s_add_u32 s25, s25, 32768
    s_mov_b32 s26, 0
    s_lshr_b32 s18, s19, 1
    s_mul_i32 s18, s18, 5
    s_waitcnt lgkmcnt(0)
    s_lshl_b32 s21, s15, 5
    s_lshl_b32 s22, s17, 2
    s_add_u32 s21, s21, s22
    s_lshl_b32 s21, s21, 13
    s_lshl_b32 s22, s14, 9
    s_add_u32 s21, s21, s22
    s_lshl_b32 s22, s12, 13
    s_add_u32 m0, s22, 0
    s_nop 0
    buffer_load_dwordx4 v24, s[32:35], s21 offen offset:0 lds
    s_add_u32 m0, s22, 960
    s_nop 0
    buffer_load_dwordx4 v24, s[32:35], s21 offen offset:64 lds
    s_add_u32 m0, s22, 1920
    s_nop 0
    buffer_load_dwordx4 v24, s[32:35], s21 offen offset:128 lds
    s_add_u32 m0, s22, 2880
    s_nop 0
    buffer_load_dwordx4 v24, s[32:35], s21 offen offset:192 lds
    s_add_u32 m0, s22, 3840
    s_nop 0
    buffer_load_dwordx4 v24, s[32:35], s21 offen offset:256 lds
    s_add_u32 m0, s22, 4800
    s_nop 0
    buffer_load_dwordx4 v24, s[32:35], s21 offen offset:320 lds
    s_add_u32 m0, s22, 5760
    s_nop 0
    buffer_load_dwordx4 v24, s[32:35], s21 offen offset:384 lds
    s_add_u32 m0, s22, 6720
    s_nop 0
    buffer_load_dwordx4 v24, s[32:35], s21 offen offset:448 lds
    s_mov_b32 exec_hi, 0x00ffffff
L_pwo_2:
    s_and_b32 s18, s18, 31
    s_mul_i32 s27, s18, 896
    s_add_u32 m0, s25, s27
    s_lshl_b32 s27, s27, 1
    s_add_u32 s27, s27, s24
    buffer_load_dwordx4 v26, s[36:39], s27 offen lds
    s_add_u32 s18, s18, 1
    s_add_u32 s26, s26, 1
    s_cmp_lt_u32 s26, 32
    s_cbranch_scc1 L_pwo_2
    s_mov_b64 exec, -1
    v_lshrrev_b32 v6, 2, v20
    v_lshrrev_b32 v7, 5, v20
    v_lshlrev_b32 v7, 1, v7
    v_and_b32 v25, 3, v20
    v_xor_b32 v7, v7, v25
    s_mov_b32 s27, 8192
    v_mul_lo_u32 v25, v6, s27
    v_lshl_add_u32 v25, v7, 4, v25
    v_lshrrev_b32 v6, 3, v21
    v_lshlrev_b32 v6, 1, v6
    v_xor_b32 v6, v6, v22
    v_lshlrev_b32 v27, 6, v21
    v_lshl_add_u32 v27, v6, 4, v27
    s_lshr_b32 s24, s12, 1
    s_lshl_b32 s24, s24, 14
    v_add_u32 v27, s24, v27
    v_lshlrev_b32 v29, 4, v20
    v_lshrrev_b32 v6, 2, v21
    v_lshl_add_u32 v6, v22, 3, v6
    v_mul_u32_u24 v28, 448, v6
    v_and_b32 v6, 3, v21
    v_lshl_add_u32 v28, v6, 3, v28
    s_mul_i32 s24, s17, 224
    s_add_u32 s24, s24, 32768
    v_add_u32 v28, s24, v28
    s_mul_i32 s25, s14, 28
    s_mov_b32 s26, 401408
    v_add_u32 v6, 0, v21
    v_mul_u32_u24 v7, 2341, v6
    v_lshrrev_b32 v7, 16, v7
    v_mul_u32_u24 v8, 28, v7
    v_sub_u32 v6, v6, v8
    v_add_u32 v6, s25, v6
    v_mul_lo_u32 v7, v7, s26
    v_lshrrev_b32 v8, 4, v6
    v_mul_u32_u24 v8, 14336, v8
    v_and_b32 v6, 15, v6
    v_lshl_add_u32 v6, v22, 4, v6
    v_lshl_add_u32 v6, v6, 4, v8
    v_add_u32 v30, v6, v7
    v_add_u32 v6, 16, v21
    v_mul_u32_u24 v7, 2341, v6
    v_lshrrev_b32 v7, 16, v7
    v_mul_u32_u24 v8, 28, v7
    v_sub_u32 v6, v6, v8
    v_add_u32 v6, s25, v6
    v_mul_lo_u32 v7, v7, s26
    v_lshrrev_b32 v8, 4, v6
    v_mul_u32_u24 v8, 14336, v8
    v_and_b32 v6, 15, v6
    v_lshl_add_u32 v6, v22, 4, v6
    v_lshl_add_u32 v6, v6, 4, v8
    v_add_u32 v31, v6, v7
    v_add_u32 v6, 32, v21
    v_mul_u32_u24 v7, 2341, v6
    v_lshrrev_b32 v7, 16, v7
    v_mul_u32_u24 v8, 28, v7
    v_sub_u32 v6, v6, v8
    v_add_u32 v6, s25, v6
    v_mul_lo_u32 v7, v7, s26
    v_lshrrev_b32 v8, 4, v6
    v_mul_u32_u24 v8, 14336, v8
    v_and_b32 v6, 15, v6
    v_lshl_add_u32 v6, v22, 4, v6
    v_lshl_add_u32 v6, v6, 4, v8
    v_add_u32 v32, v6, v7
    v_add_u32 v6, 48, v21
    v_mul_u32_u24 v7, 2341, v6
    v_lshrrev_b32 v7, 16, v7
    v_mul_u32_u24 v8, 28, v7
    v_sub_u32 v6, v6, v8
    v_add_u32 v6, s25, v6
    v_mul_lo_u32 v7, v7, s26
    v_lshrrev_b32 v8, 4, v6
    v_mul_u32_u24 v8, 14336, v8
    v_and_b32 v6, 15, v6
    v_lshl_add_u32 v6, v22, 4, v6
    v_lshl_add_u32 v6, v6, 4, v8
    v_add_u32 v33, v6, v7
    v_add_u32 v6, 64, v21
    v_mul_u32_u24 v7, 2341, v6
    v_lshrrev_b32 v7, 16, v7
    v_mul_u32_u24 v8, 28, v7
    v_sub_u32 v6, v6, v8
    v_add_u32 v6, s25, v6
    v_mul_lo_u32 v7, v7, s26
    v_lshrrev_b32 v8, 4, v6
    v_mul_u32_u24 v8, 14336, v8
    v_and_b32 v6, 15, v6
    v_lshl_add_u32 v6, v22, 4, v6
    v_lshl_add_u32 v6, v6, 4, v8
    v_add_u32 v34, v6, v7
    v_add_u32 v6, 80, v21
    v_mul_u32_u24 v7, 2341, v6
    v_lshrrev_b32 v7, 16, v7
    v_mul_u32_u24 v8, 28, v7
    v_sub_u32 v6, v6, v8
    v_add_u32 v6, s25, v6
    v_mul_lo_u32 v7, v7, s26
    v_lshrrev_b32 v8, 4, v6
    v_mul_u32_u24 v8, 14336, v8
    v_and_b32 v6, 15, v6
    v_lshl_add_u32 v6, v22, 4, v6
    v_lshl_add_u32 v6, v6, 4, v8
    v_add_u32 v35, v6, v7
    v_add_u32 v6, 96, v21
    v_mul_u32_u24 v7, 2341, v6
    v_lshrrev_b32 v7, 16, v7
    v_mul_u32_u24 v8, 28, v7
    v_sub_u32 v6, v6, v8
    v_add_u32 v6, s25, v6
    v_mul_lo_u32 v7, v7, s26
    v_lshrrev_b32 v8, 4, v6
    v_mul_u32_u24 v8, 14336, v8
    v_and_b32 v6, 15, v6
    v_lshl_add_u32 v6, v22, 4, v6
    v_lshl_add_u32 v6, v6, 4, v8
    v_add_u32 v36, v6, v7
    s_cmp_lg_u32 s12, 0
    s_cbranch_scc1 L_pw0_3
    s_mov_b32 s20, 0x20000
    v_mov_b32 v6, 0
L_wd_4:
    global_load_dword v7, v6, s[40:41] offset:128 sc1
    s_waitcnt vmcnt(0)
    v_cmp_gt_u32 vcc, 1, v7
    s_cbranch_vccz L_wdd_5
    s_sleep 2
    s_sub_u32 s20, s20, 1
    s_cbranch_scc0 L_wd_4
    s_branch L_end
L_wdd_5:
L_pw0_3:
    s_waitcnt vmcnt(0)
    s_barrier
    ds_read_b128 v[96:99], v27 offset:0
    ds_read_b128 v[100:103], v27 offset:8192
    ds_read_b64_tr_b16 v[128:129], v28 offset:0
    ds_read_b64_tr_b16 v[130:131], v28 offset:1792
    ds_read_b64_tr_b16 v[132:133], v28 offset:32
    ds_read_b64_tr_b16 v[134:135], v28 offset:1824
    ds_read_b64_tr_b16 v[136:137], v28 offset:64
    ds_read_b64_tr_b16 v[138:139], v28 offset:1856
    ds_read_b64_tr_b16 v[140:141], v28 offset:96
    ds_read_b64_tr_b16 v[142:143], v28 offset:1888
    ds_read_b64_tr_b16 v[144:145], v28 offset:128
    ds_read_b64_tr_b16 v[146:147], v28 offset:1920
    ds_read_b64_tr_b16 v[148:149], v28 offset:160
    ds_read_b64_tr_b16 v[150:151], v28 offset:1952
    ds_read_b64_tr_b16 v[152:153], v28 offset:192
    ds_read_b64_tr_b16 v[154:155], v28 offset:1984
    s_waitcnt lgkmcnt(0)
    v_mfma_f32_16x16x32_bf16 v[40:43], v[96:99], v[128:131], 0
    ds_read_b128 v[104:107], v27 offset:1024
    ds_read_b128 v[108:111], v27 offset:9216
    v_mfma_f32_16x16x32_bf16 v[68:71], v[100:103], v[128:131], 0
    ds_read_b64_tr_b16 v[156:157], v28 offset:14336
    ds_read_b64_tr_b16 v[158:159], v28 offset:16128
    v_mfma_f32_16x16x32_bf16 v[44:47], v[96:99], v[132:135], 0
    ds_read_b64_tr_b16 v[160:161], v28 offset:14368
    v_mfma_f32_16x16x32_bf16 v[72:75], v[100:103], v[132:135], 0
    ds_read_b64_tr_b16 v[162:163], v28 offset:16160
    v_mfma_f32_16x16x32_bf16 v[48:51], v[96:99], v[136:139], 0
    ds_read_b64_tr_b16 v[164:165], v28 offset:14400
    v_mfma_f32_16x16x32_bf16 v[76:79], v[100:103], v[136:139], 0
    ds_read_b64_tr_b16 v[166:167], v28 offset:16192
    v_mfma_f32_16x16x32_bf16 v[52:55], v[96:99], v[140:143], 0
    ds_read_b64_tr_b16 v[168:169], v28 offset:14432
    v_mfma_f32_16x16x32_bf16 v[80:83], v[100:103], v[140:143], 0
    ds_read_b64_tr_b16 v[170:171], v28 offset:16224
    v_mfma_f32_16x16x32_bf16 v[56:59], v[96:99], v[144:147], 0
    ds_read_b64_tr_b16 v[172:173], v28 offset:14464
    v_mfma_f32_16x16x32_bf16 v[84:87], v[100:103], v[144:147], 0
    ds_read_b64_tr_b16 v[174:175], v28 offset:16256
    v_mfma_f32_16x16x32_bf16 v[60:63], v[96:99], v[148:151], 0
    ds_read_b64_tr_b16 v[176:177], v28 offset:14496
    v_mfma_f32_16x16x32_bf16 v[88:91], v[100:103], v[148:151], 0
    ds_read_b64_tr_b16 v[178:179], v28 offset:16288
    v_mfma_f32_16x16x32_bf16 v[64:67], v[96:99], v[152:155], 0
    ds_read_b64_tr_b16 v[180:181], v28 offset:14528
    v_mfma_f32_16x16x32_bf16 v[92:95], v[100:103], v[152:155], 0
    ds_read_b64_tr_b16 v[182:183], v28 offset:16320
    s_waitcnt lgkmcnt(0)
    v_mfma_f32_16x16x32_bf16 v[40:43], v[104:107], v[156:159], v[40:43]
    ds_read_b128 v[96:99], v27 offset:2048
    ds_read_b128 v[100:103], v27 offset:10240
    v_mfma_f32_16x16x32_bf16 v[68:71], v[108:111], v[156:159], v[68:71]
    ds_read_b64_tr_b16 v[128:129], v28 offset:28672
    ds_read_b64_tr_b16 v[130:131], v28 offset:30464
    v_mfma_f32_16x16x32_bf16 v[44:47], v[104:107], v[160:163], v[44:47]
    ds_read_b64_tr_b16 v[132:133], v28 offset:28704
    v_mfma_f32_16x16x32_bf16 v[72:75], v[108:111], v[160:163], v[72:75]
    ds_read_b64_tr_b16 v[134:135], v28 offset:30496
    v_mfma_f32_16x16x32_bf16 v[48:51], v[104:107], v[164:167], v[48:51]
    ds_read_b64_tr_b16 v[136:137], v28 offset:28736
    v_mfma_f32_16x16x32_bf16 v[76:79], v[108:111], v[164:167], v[76:79]
    ds_read_b64_tr_b16 v[138:139], v28 offset:30528
    v_mfma_f32_16x16x32_bf16 v[52:55], v[104:107], v[168:171], v[52:55]
    ds_read_b64_tr_b16 v[140:141], v28 offset:28768
    v_mfma_f32_16x16x32_bf16 v[80:83], v[108:111], v[168:171], v[80:83]
    ds_read_b64_tr_b16 v[142:143], v28 offset:30560
    v_mfma_f32_16x16x32_bf16 v[56:59], v[104:107], v[172:175], v[56:59]
    ds_read_b64_tr_b16 v[144:145], v28 offset:28800
    v_mfma_f32_16x16x32_bf16 v[84:87], v[108:111], v[172:175], v[84:87]
    ds_read_b64_tr_b16 v[146:147], v28 offset:30592
    v_mfma_f32_16x16x32_bf16 v[60:63], v[104:107], v[176:179], v[60:63]
    ds_read_b64_tr_b16 v[148:149], v28 offset:28832
    v_mfma_f32_16x16x32_bf16 v[88:91], v[108:111], v[176:179], v[88:91]
    ds_read_b64_tr_b16 v[150:151], v28 offset:30624
    v_mfma_f32_16x16x32_bf16 v[64:67], v[104:107], v[180:183], v[64:67]
    ds_read_b64_tr_b16 v[152:153], v28 offset:28864
    v_mfma_f32_16x16x32_bf16 v[92:95], v[108:111], v[180:183], v[92:95]
    ds_read_b64_tr_b16 v[154:155], v28 offset:30656
    s_waitcnt lgkmcnt(0)
    v_mfma_f32_16x16x32_bf16 v[40:43], v[96:99], v[128:131], v[40:43]
    ds_read_b128 v[104:107], v27 offset:3072
    ds_read_b128 v[108:111], v27 offset:11264
    v_mfma_f32_16x16x32_bf16 v[68:71], v[100:103], v[128:131], v[68:71]
    ds_read_b64_tr_b16 v[156:157], v28 offset:43008
    ds_read_b64_tr_b16 v[158:159], v28 offset:44800
    v_mfma_f32_16x16x32_bf16 v[44:47], v[96:99], v[132:135], v[44:47]
    ds_read_b64_tr_b16 v[160:161], v28 offset:43040
    v_mfma_f32_16x16x32_bf16 v[72:75], v[100:103], v[132:135], v[72:75]
    ds_read_b64_tr_b16 v[162:163], v28 offset:44832
    v_mfma_f32_16x16x32_bf16 v[48:51], v[96:99], v[136:139], v[48:51]
    ds_read_b64_tr_b16 v[164:165], v28 offset:43072
    v_mfma_f32_16x16x32_bf16 v[76:79], v[100:103], v[136:139], v[76:79]
    ds_read_b64_tr_b16 v[166:167], v28 offset:44864
    v_mfma_f32_16x16x32_bf16 v[52:55], v[96:99], v[140:143], v[52:55]
    ds_read_b64_tr_b16 v[168:169], v28 offset:43104
    v_mfma_f32_16x16x32_bf16 v[80:83], v[100:103], v[140:143], v[80:83]
    ds_read_b64_tr_b16 v[170:171], v28 offset:44896
    v_mfma_f32_16x16x32_bf16 v[56:59], v[96:99], v[144:147], v[56:59]
    ds_read_b64_tr_b16 v[172:173], v28 offset:43136
    v_mfma_f32_16x16x32_bf16 v[84:87], v[100:103], v[144:147], v[84:87]
    ds_read_b64_tr_b16 v[174:175], v28 offset:44928
    v_mfma_f32_16x16x32_bf16 v[60:63], v[96:99], v[148:151], v[60:63]
    ds_read_b64_tr_b16 v[176:177], v28 offset:43168
    v_mfma_f32_16x16x32_bf16 v[88:91], v[100:103], v[148:151], v[88:91]
    ds_read_b64_tr_b16 v[178:179], v28 offset:44960
    v_mfma_f32_16x16x32_bf16 v[64:67], v[96:99], v[152:155], v[64:67]
    ds_read_b64_tr_b16 v[180:181], v28 offset:43200
    v_mfma_f32_16x16x32_bf16 v[92:95], v[100:103], v[152:155], v[92:95]
    ds_read_b64_tr_b16 v[182:183], v28 offset:44992
    v_add_u32 v28, 57344, v28
    s_waitcnt lgkmcnt(0)
    v_mfma_f32_16x16x32_bf16 v[40:43], v[104:107], v[156:159], v[40:43]
    ds_read_b128 v[96:99], v27 offset:4096
    ds_read_b128 v[100:103], v27 offset:12288
    v_mfma_f32_16x16x32_bf16 v[68:71], v[108:111], v[156:159], v[68:71]
    ds_read_b64_tr_b16 v[128:129], v28 offset:0
    ds_read_b64_tr_b16 v[130:131], v28 offset:1792
    v_mfma_f32_16x16x32_bf16 v[44:47], v[104:107], v[160:163], v[44:47]
    ds_read_b64_tr_b16 v[132:133], v28 offset:32
    v_mfma_f32_16x16x32_bf16 v[72:75], v[108:111], v[160:163], v[72:75]
    ds_read_b64_tr_b16 v[134:135], v28 offset:1824
    v_mfma_f32_16x16x32_bf16 v[48:51], v[104:107], v[164:167], v[48:51]
    ds_read_b64_tr_b16 v[136:137], v28 offset:64
    v_mfma_f32_16x16x32_bf16 v[76:79], v[108:111], v[164:167], v[76:79]
    ds_read_b64_tr_b16 v[138:139], v28 offset:1856
    v_mfma_f32_16x16x32_bf16 v[52:55], v[104:107], v[168:171], v[52:55]
    ds_read_b64_tr_b16 v[140:141], v28 offset:96
    v_mfma_f32_16x16x32_bf16 v[80:83], v[108:111], v[168:171], v[80:83]
    ds_read_b64_tr_b16 v[142:143], v28 offset:1888
    v_mfma_f32_16x16x32_bf16 v[56:59], v[104:107], v[172:175], v[56:59]
    ds_read_b64_tr_b16 v[144:145], v28 offset:128
    v_mfma_f32_16x16x32_bf16 v[84:87], v[108:111], v[172:175], v[84:87]
    ds_read_b64_tr_b16 v[146:147], v28 offset:1920
    v_mfma_f32_16x16x32_bf16 v[60:63], v[104:107], v[176:179], v[60:63]
    ds_read_b64_tr_b16 v[148:149], v28 offset:160
    v_mfma_f32_16x16x32_bf16 v[88:91], v[108:111], v[176:179], v[88:91]
    ds_read_b64_tr_b16 v[150:151], v28 offset:1952
    v_mfma_f32_16x16x32_bf16 v[64:67], v[104:107], v[180:183], v[64:67]
    ds_read_b64_tr_b16 v[152:153], v28 offset:192
    v_mfma_f32_16x16x32_bf16 v[92:95], v[108:111], v[180:183], v[92:95]
    ds_read_b64_tr_b16 v[154:155], v28 offset:1984
    s_waitcnt lgkmcnt(0)
    v_mfma_f32_16x16x32_bf16 v[40:43], v[96:99], v[128:131], v[40:43]
    ds_read_b128 v[104:107], v27 offset:5120
    ds_read_b128 v[108:111], v27 offset:13312
    v_mfma_f32_16x16x32_bf16 v[68:71], v[100:103], v[128:131], v[68:71]
    ds_read_b64_tr_b16 v[156:157], v28 offset:14336
    ds_read_b64_tr_b16 v[158:159], v28 offset:16128
    v_mfma_f32_16x16x32_bf16 v[44:47], v[96:99], v[132:135], v[44:47]
    ds_read_b64_tr_b16 v[160:161], v28 offset:14368
    v_mfma_f32_16x16x32_bf16 v[72:75], v[100:103], v[132:135], v[72:75]
    ds_read_b64_tr_b16 v[162:163], v28 offset:16160
    v_mfma_f32_16x16x32_bf16 v[48:51], v[96:99], v[136:139], v[48:51]
    ds_read_b64_tr_b16 v[164:165], v28 offset:14400
    v_mfma_f32_16x16x32_bf16 v[76:79], v[100:103], v[136:139], v[76:79]
    ds_read_b64_tr_b16 v[166:167], v28 offset:16192
    v_mfma_f32_16x16x32_bf16 v[52:55], v[96:99], v[140:143], v[52:55]
    ds_read_b64_tr_b16 v[168:169], v28 offset:14432
    v_mfma_f32_16x16x32_bf16 v[80:83], v[100:103], v[140:143], v[80:83]
    ds_read_b64_tr_b16 v[170:171], v28 offset:16224
    v_mfma_f32_16x16x32_bf16 v[56:59], v[96:99], v[144:147], v[56:59]
    ds_read_b64_tr_b16 v[172:173], v28 offset:14464
    v_mfma_f32_16x16x32_bf16 v[84:87], v[100:103], v[144:147], v[84:87]
    ds_read_b64_tr_b16 v[174:175], v28 offset:16256
    v_mfma_f32_16x16x32_bf16 v[60:63], v[96:99], v[148:151], v[60:63]
    ds_read_b64_tr_b16 v[176:177], v28 offset:14496
    v_mfma_f32_16x16x32_bf16 v[88:91], v[100:103], v[148:151], v[88:91]
    ds_read_b64_tr_b16 v[178:179], v28 offset:16288
    v_mfma_f32_16x16x32_bf16 v[64:67], v[96:99], v[152:155], v[64:67]
    ds_read_b64_tr_b16 v[180:181], v28 offset:14528
    v_mfma_f32_16x16x32_bf16 v[92:95], v[100:103], v[152:155], v[92:95]
    ds_read_b64_tr_b16 v[182:183], v28 offset:16320
    s_waitcnt lgkmcnt(0)
    v_mfma_f32_16x16x32_bf16 v[40:43], v[104:107], v[156:159], v[40:43]
    ds_read_b128 v[96:99], v27 offset:6144
    ds_read_b128 v[100:103], v27 offset:14336
    v_mfma_f32_16x16x32_bf16 v[68:71], v[108:111], v[156:159], v[68:71]
    ds_read_b64_tr_b16 v[128:129], v28 offset:28672
    ds_read_b64_tr_b16 v[130:131], v28 offset:30464
    v_mfma_f32_16x16x32_bf16 v[44:47], v[104:107], v[160:163], v[44:47]
    ds_read_b64_tr_b16 v[132:133], v28 offset:28704
    v_mfma_f32_16x16x32_bf16 v[72:75], v[108:111], v[160:163], v[72:75]
    ds_read_b64_tr_b16 v[134:135], v28 offset:30496
    v_mfma_f32_16x16x32_bf16 v[48:51], v[104:107], v[164:167], v[48:51]
    ds_read_b64_tr_b16 v[136:137], v28 offset:28736
    v_mfma_f32_16x16x32_bf16 v[76:79], v[108:111], v[164:167], v[76:79]
    ds_read_b64_tr_b16 v[138:139], v28 offset:30528
    v_mfma_f32_16x16x32_bf16 v[52:55], v[104:107], v[168:171], v[52:55]
    ds_read_b64_tr_b16 v[140:141], v28 offset:28768
    v_mfma_f32_16x16x32_bf16 v[80:83], v[108:111], v[168:171], v[80:83]
    ds_read_b64_tr_b16 v[142:143], v28 offset:30560
    v_mfma_f32_16x16x32_bf16 v[56:59], v[104:107], v[172:175], v[56:59]
    ds_read_b64_tr_b16 v[144:145], v28 offset:28800
    v_mfma_f32_16x16x32_bf16 v[84:87], v[108:111], v[172:175], v[84:87]
    ds_read_b64_tr_b16 v[146:147], v28 offset:30592
    v_mfma_f32_16x16x32_bf16 v[60:63], v[104:107], v[176:179], v[60:63]
    ds_read_b64_tr_b16 v[148:149], v28 offset:28832
    v_mfma_f32_16x16x32_bf16 v[88:91], v[108:111], v[176:179], v[88:91]
    ds_read_b64_tr_b16 v[150:151], v28 offset:30624
    v_mfma_f32_16x16x32_bf16 v[64:67], v[104:107], v[180:183], v[64:67]
    ds_read_b64_tr_b16 v[152:153], v28 offset:28864
    v_mfma_f32_16x16x32_bf16 v[92:95], v[108:111], v[180:183], v[92:95]
    ds_read_b64_tr_b16 v[154:155], v28 offset:30656
    s_waitcnt lgkmcnt(0)
    v_mfma_f32_16x16x32_bf16 v[40:43], v[96:99], v[128:131], v[40:43]
    ds_read_b128 v[104:107], v27 offset:7168
    ds_read_b128 v[108:111], v27 offset:15360
    v_mfma_f32_16x16x32_bf16 v[68:71], v[100:103], v[128:131], v[68:71]
    ds_read_b64_tr_b16 v[156:157], v28 offset:43008
    ds_read_b64_tr_b16 v[158:159], v28 offset:44800
    v_mfma_f32_16x16x32_bf16 v[44:47], v[96:99], v[132:135], v[44:47]
    ds_read_b64_tr_b16 v[160:161], v28 offset:43040
    v_mfma_f32_16x16x32_bf16 v[72:75], v[100:103], v[132:135], v[72:75]
    ds_read_b64_tr_b16 v[162:163], v28 offset:44832
    v_mfma_f32_16x16x32_bf16 v[48:51], v[96:99], v[136:139], v[48:51]
    ds_read_b64_tr_b16 v[164:165], v28 offset:43072
    v_mfma_f32_16x16x32_bf16 v[76:79], v[100:103], v[136:139], v[76:79]
    ds_read_b64_tr_b16 v[166:167], v28 offset:44864
    v_mfma_f32_16x16x32_bf16 v[52:55], v[96:99], v[140:143], v[52:55]
    ds_read_b64_tr_b16 v[168:169], v28 offset:43104
    v_mfma_f32_16x16x32_bf16 v[80:83], v[100:103], v[140:143], v[80:83]
    ds_read_b64_tr_b16 v[170:171], v28 offset:44896
    v_mfma_f32_16x16x32_bf16 v[56:59], v[96:99], v[144:147], v[56:59]
    ds_read_b64_tr_b16 v[172:173], v28 offset:43136
    v_mfma_f32_16x16x32_bf16 v[84:87], v[100:103], v[144:147], v[84:87]
    ds_read_b64_tr_b16 v[174:175], v28 offset:44928
    v_mfma_f32_16x16x32_bf16 v[60:63], v[96:99], v[148:151], v[60:63]
    ds_read_b64_tr_b16 v[176:177], v28 offset:43168
    v_mfma_f32_16x16x32_bf16 v[88:91], v[100:103], v[148:151], v[88:91]
    ds_read_b64_tr_b16 v[178:179], v28 offset:44960
    v_mfma_f32_16x16x32_bf16 v[64:67], v[96:99], v[152:155], v[64:67]
    ds_read_b64_tr_b16 v[180:181], v28 offset:43200
    v_mfma_f32_16x16x32_bf16 v[92:95], v[100:103], v[152:155], v[92:95]
    ds_read_b64_tr_b16 v[182:183], v28 offset:44992
    s_waitcnt lgkmcnt(0)
    v_mfma_f32_16x16x32_bf16 v[40:43], v[104:107], v[156:159], v[40:43]
    v_mfma_f32_16x16x32_bf16 v[68:71], v[108:111], v[156:159], v[68:71]
    v_mfma_f32_16x16x32_bf16 v[44:47], v[104:107], v[160:163], v[44:47]
    v_mfma_f32_16x16x32_bf16 v[72:75], v[108:111], v[160:163], v[72:75]
    v_mfma_f32_16x16x32_bf16 v[48:51], v[104:107], v[164:167], v[48:51]
    v_mfma_f32_16x16x32_bf16 v[76:79], v[108:111], v[164:167], v[76:79]
    v_mfma_f32_16x16x32_bf16 v[52:55], v[104:107], v[168:171], v[52:55]
    v_mfma_f32_16x16x32_bf16 v[80:83], v[108:111], v[168:171], v[80:83]
    v_mfma_f32_16x16x32_bf16 v[56:59], v[104:107], v[172:175], v[56:59]
    v_mfma_f32_16x16x32_bf16 v[84:87], v[108:111], v[172:175], v[84:87]
    v_mfma_f32_16x16x32_bf16 v[60:63], v[104:107], v[176:179], v[60:63]
    v_mfma_f32_16x16x32_bf16 v[88:91], v[108:111], v[176:179], v[88:91]
    v_mfma_f32_16x16x32_bf16 v[64:67], v[104:107], v[180:183], v[64:67]
    v_mfma_f32_16x16x32_bf16 v[92:95], v[108:111], v[180:183], v[92:95]
    s_lshl_b32 s24, s16, 3
    s_lshl_b32 s25, s17, 2
    s_add_u32 s24, s24, s25
    s_add_u32 s24, s24, 16
    s_mul_i32 s24, s24, 401408
    s_lshl_b32 s25, s15, 10
    s_add_u32 s24, s24, s25
    v_cvt_pk_bf16_f32 v184, v40, v41
    v_cvt_pk_bf16_f32 v185, v42, v43
    v_cvt_pk_bf16_f32 v186, v68, v69
    v_cvt_pk_bf16_f32 v187, v70, v71
    buffer_store_dwordx4 v[184:187], v30, s[4:7], s24 offen sc1
    v_cvt_pk_bf16_f32 v188, v44, v45
    v_cvt_pk_bf16_f32 v189, v46, v47
    v_cvt_pk_bf16_f32 v190, v72, v73
    v_cvt_pk_bf16_f32 v191, v74, v75
    buffer_store_dwordx4 v[188:191], v31, s[4:7], s24 offen sc1
    v_cvt_pk_bf16_f32 v192, v48, v49
    v_cvt_pk_bf16_f32 v193, v50, v51
    v_cvt_pk_bf16_f32 v194, v76, v77
    v_cvt_pk_bf16_f32 v195, v78, v79
    buffer_store_dwordx4 v[192:195], v32, s[4:7], s24 offen sc1
    v_cvt_pk_bf16_f32 v196, v52, v53
    v_cvt_pk_bf16_f32 v197, v54, v55
    v_cvt_pk_bf16_f32 v198, v80, v81
    v_cvt_pk_bf16_f32 v199, v82, v83
    buffer_store_dwordx4 v[196:199], v33, s[4:7], s24 offen sc1
    v_cvt_pk_bf16_f32 v200, v56, v57
    v_cvt_pk_bf16_f32 v201, v58, v59
    v_cvt_pk_bf16_f32 v202, v84, v85
    v_cvt_pk_bf16_f32 v203, v86, v87
    buffer_store_dwordx4 v[200:203], v34, s[4:7], s24 offen sc1
    v_cvt_pk_bf16_f32 v204, v60, v61
    v_cvt_pk_bf16_f32 v205, v62, v63
    v_cvt_pk_bf16_f32 v206, v88, v89
    v_cvt_pk_bf16_f32 v207, v90, v91
    buffer_store_dwordx4 v[204:207], v35, s[4:7], s24 offen sc1
    v_cvt_pk_bf16_f32 v208, v64, v65
    v_cvt_pk_bf16_f32 v209, v66, v67
    v_cvt_pk_bf16_f32 v210, v92, v93
    v_cvt_pk_bf16_f32 v211, v94, v95
    buffer_store_dwordx4 v[208:211], v36, s[4:7], s24 offen sc1
    s_sub_u32 s19, s46, 96
    s_cmp_lt_u32 s19, 112
    s_cbranch_scc0 L_pnoa_7
    s_load_dwordx2 s[32:33], s[0:1], 48
    s_load_dwordx2 s[36:37], s[0:1], 56
    s_mul_i32 s14, s19, 9363
    s_lshr_b32 s14, s14, 16
    s_mul_i32 s24, s14, 7
    s_sub_u32 s16, s19, s24
    s_lshl_b32 s15, s16, 1
    s_lshr_b32 s24, s12, 1
    s_add_u32 s15, s15, s24
    s_waitcnt lgkmcnt(0)
    s_barrier
    s_lshl_b32 s24, s15, 5
    s_lshl_b32 s25, s17, 2
    s_add_u32 s24, s24, s25
    s_lshl_b32 s24, s24, 13
    s_lshl_b32 s25, s14, 9
    s_add_u32 s24, s24, s25
    s_lshl_b32 s25, s12, 13
    s_add_u32 m0, s25, 0
    s_nop 0
    buffer_load_dwordx4 v24, s[32:35], s24 offen offset:0 lds
    s_add_u32 m0, s25, 960
    s_nop 0
    buffer_load_dwordx4 v24, s[32:35], s24 offen offset:64 lds
    s_add_u32 m0, s25, 1920
    s_nop 0
    buffer_load_dwordx4 v24, s[32:35], s24 offen offset:128 lds
    s_add_u32 m0, s25, 2880
    s_nop 0
    buffer_load_dwordx4 v24, s[32:35], s24 offen offset:192 lds
    s_add_u32 m0, s25, 3840
    s_nop 0
    buffer_load_dwordx4 v24, s[32:35], s24 offen offset:256 lds
    s_add_u32 m0, s25, 4800
    s_nop 0
    buffer_load_dwordx4 v24, s[32:35], s24 offen offset:320 lds
    s_add_u32 m0, s25, 5760
    s_nop 0
    buffer_load_dwordx4 v24, s[32:35], s24 offen offset:384 lds
    s_add_u32 m0, s25, 6720
    s_nop 0
    buffer_load_dwordx4 v24, s[32:35], s24 offen offset:448 lds
    s_waitcnt vmcnt(8)
    s_branch L_pbf_8
L_pnoa_7:
    s_waitcnt vmcnt(0)
L_pbf_8:
    s_barrier
    s_cmp_lg_u32 s12, 0
    s_cbranch_scc1 L_pf_9
    s_lshl_b32 s24, s46, 2
    s_add_u32 s24, s24, 59768832
    v_mov_b32 v6, 0
    v_mov_b32 v7, 1
    s_mov_b64 exec, 1
    buffer_store_dword v7, v6, s[4:7], s24 offen sc1
    s_mov_b64 exec, -1
L_pf_9:
    s_cmp_lt_u32 s46, 96
    s_cbranch_scc1 L_pfin_6
    s_cmp_lt_u32 s19, 112
    s_cbranch_scc0 L_ppx_10
    s_mov_b32 s15, 4
    s_mov_b32 s23, 1
L_pap_11:
    s_mul_i32 s24, s12, 917504
    s_lshl_b32 s25, s14, 9
    s_add_u32 s24, s24, s25
    s_lshl_b32 s25, s15, 17
    s_add_u32 s24, s24, s25
    s_mul_i32 s25, s12, 24576
    s_add_u32 s25, s25, 32768
    s_lshl_b32 s18, s16, 1
    s_mov_b32 s26, 0
L_pwk_12:
    s_cmp_ge_u32 s18, 12
    s_cselect_b32 s27, 12, 0
    s_sub_u32 s18, s18, s27
    s_lshr_b32 s21, s18, 2
    s_lshl_b32 s21, s21, 17
    s_and_b32 s22, s18, 3
    s_lshl_b32 s22, s22, 7
    s_add_u32 s21, s21, s22
    s_add_u32 s21, s21, s24
    s_lshl_b32 s22, s18, 11
    s_add_u32 m0, s22, s25
    s_add_u32 s18, s18, 1
    buffer_load_dwordx4 v25, s[36:39], s21 offen lds
    s_add_u32 m0, m0, 960
    s_add_u32 s26, s26, 1
    buffer_load_dwordx4 v25, s[36:39], s21 offen offset:64 lds
    s_cmp_lt_u32 s26, 12
    s_cbranch_scc1 L_pwk_12
    v_lshrrev_b32 v6, 3, v21
    v_lshlrev_b32 v6, 1, v6
    v_xor_b32 v6, v6, v22
    v_lshlrev_b32 v27, 6, v21
    v_lshl_add_u32 v27, v6, 4, v27
    v_add_u32 v28, s25, v27
    s_waitcnt vmcnt(0)
    s_barrier
    ds_read_b128 v[128:131], v27 offset:0
    ds_read_b128 v[132:135], v27 offset:8192
    ds_read_b128 v[136:139], v27 offset:16384
    ds_read_b128 v[140:143], v27 offset:24576
    ds_read_b128 v[144:147], v28 offset:0
    ds_read_b128 v[148:151], v28 offset:8192
    ds_read_b128 v[152:155], v28 offset:16384
    s_waitcnt lgkmcnt(0)
    v_mfma_f32_16x16x32_bf16 v[40:43], v[128:131], v[144:147], 0
    ds_read_b128 v[156:159], v27 offset:1024
    v_mfma_f32_16x16x32_bf16 v[44:47], v[132:135], v[144:147], 0
    ds_read_b128 v[160:163], v27 offset:9216
    v_mfma_f32_16x16x32_bf16 v[48:51], v[136:139], v[144:147], 0
    ds_read_b128 v[164:167], v27 offset:17408
    v_mfma_f32_16x16x32_bf16 v[52:55], v[140:143], v[144:147], 0
    ds_read_b128 v[168:171], v27 offset:25600
    v_mfma_f32_16x16x32_bf16 v[56:59], v[128:131], v[148:151], 0
    ds_read_b128 v[172:175], v28 offset:1024
    v_mfma_f32_16x16x32_bf16 v[60:63], v[132:135], v[148:151], 0
    ds_read_b128 v[176:179], v28 offset:9216
    v_mfma_f32_16x16x32_bf16 v[64:67], v[136:139], v[148:151], 0
    ds_read_b128 v[180:183], v28 offset:17408
    v_mfma_f32_16x16x32_bf16 v[68:71], v[140:143], v[148:151], 0
    v_mfma_f32_16x16x32_bf16 v[72:75], v[128:131], v[152:155], 0
    v_mfma_f32_16x16x32_bf16 v[76:79], v[132:135], v[152:155], 0
    v_mfma_f32_16x16x32_bf16 v[80:83], v[136:139], v[152:155], 0
    v_mfma_f32_16x16x32_bf16 v[84:87], v[140:143], v[152:155], 0
    s_waitcnt lgkmcnt(0)
    v_mfma_f32_16x16x32_bf16 v[40:43], v[156:159], v[172:175], v[40:43]
    ds_read_b128 v[128:131], v27 offset:2048
    v_mfma_f32_16x16x32_bf16 v[44:47], v[160:163], v[172:175], v[44:47]
    ds_read_b128 v[132:135], v27 offset:10240
    v_mfma_f32_16x16x32_bf16 v[48:51], v[164:167], v[172:175], v[48:51]
    ds_read_b128 v[136:139], v27 offset:18432
    v_mfma_f32_16x16x32_bf16 v[52:55], v[168:171], v[172:175], v[52:55]
    ds_read_b128 v[140:143], v27 offset:26624
    v_mfma_f32_16x16x32_bf16 v[56:59], v[156:159], v[176:179], v[56:59]
    ds_read_b128 v[144:147], v28 offset:2048
    v_mfma_f32_16x16x32_bf16 v[60:63], v[160:163], v[176:179], v[60:63]
    ds_read_b128 v[148:151], v28 offset:10240
    v_mfma_f32_16x16x32_bf16 v[64:67], v[164:167], v[176:179], v[64:67]
    ds_read_b128 v[152:155], v28 offset:18432
    v_mfma_f32_16x16x32_bf16 v[68:71], v[168:171], v[176:179], v[68:71]
    v_mfma_f32_16x16x32_bf16 v[72:75], v[156:159], v[180:183], v[72:75]
    v_mfma_f32_16x16x32_bf16 v[76:79], v[160:163], v[180:183], v[76:79]
    v_mfma_f32_16x16x32_bf16 v[80:83], v[164:167], v[180:183], v[80:83]
    v_mfma_f32_16x16x32_bf16 v[84:87], v[168:171], v[180:183], v[84:87]
    s_waitcnt lgkmcnt(0)
    v_mfma_f32_16x16x32_bf16 v[40:43], v[128:131], v[144:147], v[40:43]
    ds_read_b128 v[156:159], v27 offset:3072
    v_mfma_f32_16x16x32_bf16 v[44:47], v[132:135], v[144:147], v[44:47]
    ds_read_b128 v[160:163], v27 offset:11264
    v_mfma_f32_16x16x32_bf16 v[48:51], v[136:139], v[144:147], v[48:51]
    ds_read_b128 v[164:167], v27 offset:19456
    v_mfma_f32_16x16x32_bf16 v[52:55], v[140:143], v[144:147], v[52:55]
    ds_read_b128 v[168:171], v27 offset:27648
    v_mfma_f32_16x16x32_bf16 v[56:59], v[128:131], v[148:151], v[56:59]
    ds_read_b128 v[172:175], v28 offset:3072
    v_mfma_f32_16x16x32_bf16 v[60:63], v[132:135], v[148:151], v[60:63]
    ds_read_b128 v[176:179], v28 offset:11264
    v_mfma_f32_16x16x32_bf16 v[64:67], v[136:139], v[148:151], v[64:67]
    ds_read_b128 v[180:183], v28 offset:19456
    v_mfma_f32_16x16x32_bf16 v[68:71], v[140:143], v[148:151], v[68:71]
    v_mfma_f32_16x16x32_bf16 v[72:75], v[128:131], v[152:155], v[72:75]
    v_mfma_f32_16x16x32_bf16 v[76:79], v[132:135], v[152:155], v[76:79]
    v_mfma_f32_16x16x32_bf16 v[80:83], v[136:139], v[152:155], v[80:83]
    v_mfma_f32_16x16x32_bf16 v[84:87], v[140:143], v[152:155], v[84:87]
    s_waitcnt lgkmcnt(0)
    v_mfma_f32_16x16x32_bf16 v[40:43], v[156:159], v[172:175], v[40:43]
    ds_read_b128 v[128:131], v27 offset:4096
    v_mfma_f32_16x16x32_bf16 v[44:47], v[160:163], v[172:175], v[44:47]
    ds_read_b128 v[132:135], v27 offset:12288
    v_mfma_f32_16x16x32_bf16 v[48:51], v[164:167], v[172:175], v[48:51]
    ds_read_b128 v[136:139], v27 offset:20480
    v_mfma_f32_16x16x32_bf16 v[52:55], v[168:171], v[172:175], v[52:55]
    ds_read_b128 v[140:143], v27 offset:28672
    v_mfma_f32_16x16x32_bf16 v[56:59], v[156:159], v[176:179], v[56:59]
    ds_read_b128 v[144:147], v28 offset:4096
    v_mfma_f32_16x16x32_bf16 v[60:63], v[160:163], v[176:179], v[60:63]
    ds_read_b128 v[148:151], v28 offset:12288
    v_mfma_f32_16x16x32_bf16 v[64:67], v[164:167], v[176:179], v[64:67]
    ds_read_b128 v[152:155], v28 offset:20480
    v_mfma_f32_16x16x32_bf16 v[68:71], v[168:171], v[176:179], v[68:71]
    v_mfma_f32_16x16x32_bf16 v[72:75], v[156:159], v[180:183], v[72:75]
    v_mfma_f32_16x16x32_bf16 v[76:79], v[160:163], v[180:183], v[76:79]
    v_mfma_f32_16x16x32_bf16 v[80:83], v[164:167], v[180:183], v[80:83]
    v_mfma_f32_16x16x32_bf16 v[84:87], v[168:171], v[180:183], v[84:87]
    s_waitcnt lgkmcnt(0)
    v_mfma_f32_16x16x32_bf16 v[40:43], v[128:131], v[144:147], v[40:43]
    ds_read_b128 v[156:159], v27 offset:5120
    v_mfma_f32_16x16x32_bf16 v[44:47], v[132:135], v[144:147], v[44:47]
    ds_read_b128 v[160:163], v27 offset:13312
    v_mfma_f32_16x16x32_bf16 v[48:51], v[136:139], v[144:147], v[48:51]
    ds_read_b128 v[164:167], v27 offset:21504
    v_mfma_f32_16x16x32_bf16 v[52:55], v[140:143], v[144:147], v[52:55]
    ds_read_b128 v[168:171], v27 offset:29696
    v_mfma_f32_16x16x32_bf16 v[56:59], v[128:131], v[148:151], v[56:59]
    ds_read_b128 v[172:175], v28 offset:5120
    v_mfma_f32_16x16x32_bf16 v[60:63], v[132:135], v[148:151], v[60:63]
    ds_read_b128 v[176:179], v28 offset:13312
    v_mfma_f32_16x16x32_bf16 v[64:67], v[136:139], v[148:151], v[64:67]
    ds_read_b128 v[180:183], v28 offset:21504
    v_mfma_f32_16x16x32_bf16 v[68:71], v[140:143], v[148:151], v[68:71]
    v_mfma_f32_16x16x32_bf16 v[72:75], v[128:131], v[152:155], v[72:75]
    v_mfma_f32_16x16x32_bf16 v[76:79], v[132:135], v[152:155], v[76:79]
    v_mfma_f32_16x16x32_bf16 v[80:83], v[136:139], v[152:155], v[80:83]
    v_mfma_f32_16x16x32_bf16 v[84:87], v[140:143], v[152:155], v[84:87]
    s_waitcnt lgkmcnt(0)
    v_mfma_f32_16x16x32_bf16 v[40:43], v[156:159], v[172:175], v[40:43]
    ds_read_b128 v[128:131], v27 offset:6144
    v_mfma_f32_16x16x32_bf16 v[44:47], v[160:163], v[172:175], v[44:47]
    ds_read_b128 v[132:135], v27 offset:14336
    v_mfma_f32_16x16x32_bf16 v[48:51], v[164:167], v[172:175], v[48:51]
    ds_read_b128 v[136:139], v27 offset:22528
    v_mfma_f32_16x16x32_bf16 v[52:55], v[168:171], v[172:175], v[52:55]
    ds_read_b128 v[140:143], v27 offset:30720
    v_mfma_f32_16x16x32_bf16 v[56:59], v[156:159], v[176:179], v[56:59]
    ds_read_b128 v[144:147], v28 offset:6144
    v_mfma_f32_16x16x32_bf16 v[60:63], v[160:163], v[176:179], v[60:63]
    ds_read_b128 v[148:151], v28 offset:14336
    v_mfma_f32_16x16x32_bf16 v[64:67], v[164:167], v[176:179], v[64:67]
    ds_read_b128 v[152:155], v28 offset:22528
    v_mfma_f32_16x16x32_bf16 v[68:71], v[168:171], v[176:179], v[68:71]
    v_mfma_f32_16x16x32_bf16 v[72:75], v[156:159], v[180:183], v[72:75]
    v_mfma_f32_16x16x32_bf16 v[76:79], v[160:163], v[180:183], v[76:79]
    v_mfma_f32_16x16x32_bf16 v[80:83], v[164:167], v[180:183], v[80:83]
    v_mfma_f32_16x16x32_bf16 v[84:87], v[168:171], v[180:183], v[84:87]
    s_waitcnt lgkmcnt(0)
    v_mfma_f32_16x16x32_bf16 v[40:43], v[128:131], v[144:147], v[40:43]
    ds_read_b128 v[156:159], v27 offset:7168
    v_mfma_f32_16x16x32_bf16 v[44:47], v[132:135], v[144:147], v[44:47]
    ds_read_b128 v[160:163], v27 offset:15360
    v_mfma_f32_16x16x32_bf16 v[48:51], v[136:139], v[144:147], v[48:51]
    ds_read_b128 v[164:167], v27 offset:23552
    v_mfma_f32_16x16x32_bf16 v[52:55], v[140:143], v[144:147], v[52:55]
    ds_read_b128 v[168:171], v27 offset:31744
    v_mfma_f32_16x16x32_bf16 v[56:59], v[128:131], v[148:151], v[56:59]
    ds_read_b128 v[172:175], v28 offset:7168
    v_mfma_f32_16x16x32_bf16 v[60:63], v[132:135], v[148:151], v[60:63]
    ds_read_b128 v[176:179], v28 offset:15360
    v_mfma_f32_16x16x32_bf16 v[64:67], v[136:139], v[148:151], v[64:67]
    ds_read_b128 v[180:183], v28 offset:23552
    v_mfma_f32_16x16x32_bf16 v[68:71], v[140:143], v[148:151], v[68:71]
    v_mfma_f32_16x16x32_bf16 v[72:75], v[128:131], v[152:155], v[72:75]
    v_mfma_f32_16x16x32_bf16 v[76:79], v[132:135], v[152:155], v[76:79]
    v_mfma_f32_16x16x32_bf16 v[80:83], v[136:139], v[152:155], v[80:83]
    v_mfma_f32_16x16x32_bf16 v[84:87], v[140:143], v[152:155], v[84:87]
    s_waitcnt lgkmcnt(0)
    v_mfma_f32_16x16x32_bf16 v[40:43], v[156:159], v[172:175], v[40:43]
    v_mfma_f32_16x16x32_bf16 v[44:47], v[160:163], v[172:175], v[44:47]
    v_mfma_f32_16x16x32_bf16 v[48:51], v[164:167], v[172:175], v[48:51]
    v_mfma_f32_16x16x32_bf16 v[52:55], v[168:171], v[172:175], v[52:55]
    v_mfma_f32_16x16x32_bf16 v[56:59], v[156:159], v[176:179], v[56:59]
    v_mfma_f32_16x16x32_bf16 v[60:63], v[160:163], v[176:179], v[60:63]
    v_mfma_f32_16x16x32_bf16 v[64:67], v[164:167], v[176:179], v[64:67]
    v_mfma_f32_16x16x32_bf16 v[68:71], v[168:171], v[176:179], v[68:71]
    v_mfma_f32_16x16x32_bf16 v[72:75], v[156:159], v[180:183], v[72:75]
    v_mfma_f32_16x16x32_bf16 v[76:79], v[160:163], v[180:183], v[76:79]
    v_mfma_f32_16x16x32_bf16 v[80:83], v[164:167], v[180:183], v[80:83]
    v_mfma_f32_16x16x32_bf16 v[84:87], v[168:171], v[180:183], v[84:87]
    s_mul_i32 s24, s14, 401408
    s_mul_i32 s25, s12, 100352
    s_add_u32 s24, s24, s25
    s_lshl_b32 s25, s16, 11
    s_add_u32 s24, s24, s25
    s_mul_i32 s25, s15, 14336
    s_add_u32 s24, s24, s25
    v_cvt_pk_bf16_f32 v184, v40, v41
    v_cvt_pk_bf16_f32 v185, v42, v43
    v_cvt_pk_bf16_f32 v186, v44, v45
    v_cvt_pk_bf16_f32 v187, v46, v47
    buffer_store_dwordx4 v[184:187], v29, s[4:7], s24 offen offset:0 sc1
    v_cvt_pk_bf16_f32 v188, v48, v49
    v_cvt_pk_bf16_f32 v189, v50, v51
    v_cvt_pk_bf16_f32 v190, v52, v53
    v_cvt_pk_bf16_f32 v191, v54, v55
    buffer_store_dwordx4 v[188:191], v29, s[4:7], s24 offen offset:1024 sc1
    s_add_u32 s24, s24, 14336
    v_cvt_pk_bf16_f32 v192, v56, v57
    v_cvt_pk_bf16_f32 v193, v58, v59
    v_cvt_pk_bf16_f32 v194, v60, v61
    v_cvt_pk_bf16_f32 v195, v62, v63
    buffer_store_dwordx4 v[192:195], v29, s[4:7], s24 offen offset:0 sc1
    v_cvt_pk_bf16_f32 v196, v64, v65
    v_cvt_pk_bf16_f32 v197, v66, v67
    v_cvt_pk_bf16_f32 v198, v68, v69
    v_cvt_pk_bf16_f32 v199, v70, v71
    buffer_store_dwordx4 v[196:199], v29, s[4:7], s24 offen offset:1024 sc1
    s_add_u32 s24, s24, 14336
    v_cvt_pk_bf16_f32 v200, v72, v73
    v_cvt_pk_bf16_f32 v201, v74, v75
    v_cvt_pk_bf16_f32 v202, v76, v77
    v_cvt_pk_bf16_f32 v203, v78, v79
    buffer_store_dwordx4 v[200:203], v29, s[4:7], s24 offen offset:0 sc1
    v_cvt_pk_bf16_f32 v204, v80, v81
    v_cvt_pk_bf16_f32 v205, v82, v83
    v_cvt_pk_bf16_f32 v206, v84, v85
    v_cvt_pk_bf16_f32 v207, v86, v87
    buffer_store_dwordx4 v[204:207], v29, s[4:7], s24 offen offset:1024 sc1
    s_add_u32 s24, s24, 14336
    s_waitcnt vmcnt(0)
    s_barrier
    s_cmp_lg_u32 s12, 0
    s_cbranch_scc1 L_pf_13
    s_lshl_b32 s24, s14, 6
    s_lshl_b32 s25, s16, 2
    s_add_u32 s24, s24, s25
    s_add_u32 s24, s24, 59769856
    v_mov_b32 v6, 0
    v_mov_b32 v7, s23
    s_mov_b64 exec, 1
    buffer_store_dword v7, v6, s[4:7], s24 offen sc1
    s_mov_b64 exec, -1
L_pf_13:
    s_cmp_lg_u32 s12, 0
    s_cbranch_scc1 L_g_14
    s_mov_b32 s20, 0x20000
    v_mov_b32 v6, 0
L_wd_15:
    global_load_dword v7, v6, s[40:41] offset:136 sc1
    s_waitcnt vmcnt(0)
    v_cmp_gt_u32 vcc, 32, v7
    s_cbranch_vccz L_wdd_16
    s_sleep 16
    s_sub_u32 s20, s20, 1
    s_cbranch_scc0 L_wd_15
    s_branch L_end
L_wdd_16:
L_g_14:
    s_barrier
    s_lshr_b32 s15, s15, 2
    s_add_u32 s23, s23, 1
    s_cmp_le_u32 s23, 3
    s_cbranch_scc1 L_pap_11
L_ppx_10:
    s_mul_i32 s24, s19, 69632
    s_add_u32 s24, s24, 50360320
    s_cmp_lt_u32 s19, 64
    s_cbranch_scc0 L_pfin_6
    v_lshlrev_b32 v6, 4, v119
    v_mov_b32 v8, -1
    v_mov_b32 v9, -1
    v_mov_b32 v10, -1
    v_mov_b32 v11, -1
    buffer_store_dwordx4 v[8:11], v6, s[4:7], s24 offen sc1
    s_add_u32 s24, s24, 4096
    buffer_store_dwordx4 v[8:11], v6, s[4:7], s24 offen sc1
    s_add_u32 s24, s24, 4096
    buffer_store_dwordx4 v[8:11], v6, s[4:7], s24 offen sc1
    s_add_u32 s24, s24, 4096
    buffer_store_dwordx4 v[8:11], v6, s[4:7], s24 offen sc1
    s_add_u32 s24, s24, 4096
    buffer_store_dwordx4 v[8:11], v6, s[4:7], s24 offen sc1
    s_add_u32 s24, s24, 4096
    buffer_store_dwordx4 v[8:11], v6, s[4:7], s24 offen sc1
    s_add_u32 s24, s24, 4096
    buffer_store_dwordx4 v[8:11], v6, s[4:7], s24 offen sc1
    s_add_u32 s24, s24, 4096
    buffer_store_dwordx4 v[8:11], v6, s[4:7], s24 offen sc1
    s_add_u32 s24, s24, 4096
    buffer_store_dwordx4 v[8:11], v6, s[4:7], s24 offen sc1
    s_add_u32 s24, s24, 4096
    buffer_store_dwordx4 v[8:11], v6, s[4:7], s24 offen sc1
    s_add_u32 s24, s24, 4096
    s_waitcnt vmcnt(0)
    s_barrier
    s_cmp_lg_u32 s12, 0
    s_cbranch_scc1 L_pfin_6
    v_mov_b32 v6, 0
    v_mov_b32 v7, 1
    s_mov_b64 exec, 1
    global_atomic_add v6, v7, s[40:41] offset:132
    s_mov_b64 exec, -1
L_pfin_6:
    s_cmp_lt_u32 s13, 240
    s_cbranch_scc1 L_lm0_17
    s_sub_u32 s14, s13, 240
    s_mul_i32 s24, s14, 278528
    s_add_u32 s24, s24, 50331648
    v_lshlrev_b32 v6, 4, v119
    v_mov_b32 v7, 1073741824
    s_cmp_eq_u32 s14, 0
    s_cselect_b64 vcc, -1, 0
    v_cndmask_b32 v7, v6, v7, vcc
    v_mov_b32 v8, -1
    v_mov_b32 v9, -1
    v_mov_b32 v10, -1
    v_mov_b32 v11, -1
    s_mov_b32 s15, 0
L_lf_19:
    buffer_store_dwordx4 v[8:11], v7, s[4:7], s24 offen sc1
    s_add_u32 s24, s24, 4096
    buffer_store_dwordx4 v[8:11], v7, s[4:7], s24 offen sc1
    s_add_u32 s24, s24, 4096
    buffer_store_dwordx4 v[8:11], v6, s[4:7], s24 offen sc1
    s_add_u32 s24, s24, 4096
    buffer_store_dwordx4 v[8:11], v6, s[4:7], s24 offen sc1
    s_add_u32 s24, s24, 4096
    buffer_store_dwordx4 v[8:11], v6, s[4:7], s24 offen sc1
    s_add_u32 s24, s24, 4096
    buffer_store_dwordx4 v[8:11], v6, s[4:7], s24 offen sc1
    s_add_u32 s24, s24, 4096
    buffer_store_dwordx4 v[8:11], v6, s[4:7], s24 offen sc1
    s_add_u32 s24, s24, 45056
    v_mov_b32 v7, v6
    s_add_u32 s15, s15, 1
    s_cmp_lt_u32 s15, 4
    s_cbranch_scc1 L_lf_19
    s_cmp_lg_u32 s13, 240
    s_cbranch_scc1 L_lm2_18
    s_load_dwordx2 s[36:37], s[0:1], 40
    s_mov_b32 s38, 7168
    s_mov_b32 s39, 0x20000
    s_waitcnt lgkmcnt(0)
    v_lshlrev_b32 v12, 2, v119
    v_lshrrev_b32 v13, 3, v119
    v_lshlrev_b32 v13, 8, v13
    v_and_b32 v14, 1, v119
    v_lshl_add_u32 v13, v14, 5, v13
    v_bfe_u32 v15, v119, 1, 2
    v_lshl_add_u32 v13, v15, 2, v13
    v_mov_b32 v7, 1073741824
    v_cmp_gt_u32 vcc, 224, v119
    s_nop 1
    v_cndmask_b32 v13, v7, v13, vcc
    v_cndmask_b32 v12, v7, v12, vcc
    s_mov_b32 s24, 50331648
    s_mov_b32 s27, 0
    buffer_load_dword v30, v12, s[36:39], s27 offen
    s_mov_b32 s27, 896
    buffer_load_dword v31, v12, s[36:39], s27 offen
    s_mov_b32 s27, 1792
    buffer_load_dword v32, v12, s[36:39], s27 offen
    s_mov_b32 s27, 2688
    buffer_load_dword v33, v12, s[36:39], s27 offen
    s_mov_b32 s27, 3584
    buffer_load_dword v34, v12, s[36:39], s27 offen
    s_mov_b32 s27, 4480
    buffer_load_dword v35, v12, s[36:39], s27 offen
    s_mov_b32 s27, 5376
    buffer_load_dword v36, v12, s[36:39], s27 offen
    s_mov_b32 s27, 6272
    buffer_load_dword v37, v12, s[36:39], s27 offen
    s_waitcnt vmcnt(0)
    v_min_u32 v30, -2, v30
    buffer_store_dword v30, v13, s[4:7], s24 offen offset:0 sc1
    v_min_u32 v31, -2, v31
    buffer_store_dword v31, v13, s[4:7], s24 offen offset:16 sc1
    v_min_u32 v32, -2, v32
    buffer_store_dword v32, v13, s[4:7], s24 offen offset:64 sc1
    v_min_u32 v33, -2, v33
    buffer_store_dword v33, v13, s[4:7], s24 offen offset:80 sc1
    v_min_u32 v34, -2, v34
    buffer_store_dword v34, v13, s[4:7], s24 offen offset:128 sc1
    v_min_u32 v35, -2, v35
    buffer_store_dword v35, v13, s[4:7], s24 offen offset:144 sc1
    v_min_u32 v36, -2, v36
    buffer_store_dword v36, v13, s[4:7], s24 offen offset:192 sc1
    v_min_u32 v37, -2, v37
    buffer_store_dword v37, v13, s[4:7], s24 offen offset:208 sc1
L_lm2_18:
    s_waitcnt vmcnt(0)
    s_barrier
    s_cmp_lg_u32 s12, 0
    s_cbranch_scc1 L_lm0_17
    v_mov_b32 v6, 0
    v_mov_b32 v7, 1
    s_mov_b64 exec, 1
    global_atomic_add v6, v7, s[40:41] offset:4
    s_mov_b64 exec, -1
L_lm0_17:
    s_cmp_lt_u32 s13, 128
    s_cbranch_scc1 L_O
    s_cmp_lt_u32 s13, 192
    s_cbranch_scc1 L_X
    s_branch L_BA
L_S:
    v_and_b32 v20, 63, v119
    v_and_b32 v21, 15, v119
    v_bfe_u32 v22, v119, 4, 2
    s_load_dwordx2 s[32:33], s[0:1], 48
    s_load_dwordx2 s[36:37], s[0:1], 56
    s_mov_b32 s34, 3670016
    s_mov_b32 s35, 0x20000
    s_mov_b32 s38, 3670016
    s_mov_b32 s39, 0x20000
    s_and_b32 s14, s13, 15
    s_mul_i32 s24, s3, s3
    s_lshl_b32 s24, s24, 16
    s_lshl_b32 s46, s3, 8
    s_add_u32 s46, s46, s24
    s_add_u32 s46, s46, 1
    s_cmp_lg_u32 s12, 0
    s_cbranch_scc1 L_la0_20
    v_mov_b32 v6, 0
    v_mov_b32 v7, s46
    s_mov_b64 exec, 1
    global_atomic_add v6, v7, s[40:41] offset:0
    s_mov_b64 exec, -1
L_la0_20:
    v_lshrrev_b32 v6, 2, v20
    v_lshrrev_b32 v7, 5, v20
    v_lshlrev_b32 v7, 1, v7
    v_and_b32 v113, 3, v20
    v_xor_b32 v7, v7, v113
    s_mov_b32 s27, 8192
    v_mul_lo_u32 v113, v6, s27
    v_lshl_add_u32 v113, v7, 4, v113
    v_lshrrev_b32 v6, 2, v20
    v_lshrrev_b32 v7, 5, v20
    v_lshlrev_b32 v7, 1, v7
    v_and_b32 v112, 3, v20
    v_xor_b32 v7, v7, v112
    v_and_b32 v112, 12, v6
    v_add_u32 v6, v6, v112
    s_mov_b32 s27, 8192
    v_mul_lo_u32 v112, v6, s27
    v_lshl_add_u32 v112, v7, 4, v112
    v_lshrrev_b32 v6, 3, v21
    v_lshlrev_b32 v6, 1, v6
    v_xor_b32 v6, v6, v22
    v_lshlrev_b32 v114, 6, v21
    v_lshl_add_u32 v114, v6, 4, v114
    v_lshlrev_b32 v116, 4, v20
    s_mul_i32 s24, s12, 917504
    s_lshl_b32 s25, s14, 9
    s_add_u32 s24, s24, s25
    s_add_u32 s24, s24, 0
    s_lshl_b32 s26, s12, 15
    s_lshr_b32 s16, s12, 1
    s_lshl_b32 s16, s16, 15
    s_and_b32 s27, s12, 1
    s_lshl_b32 s27, s27, 8
    s_add_u32 s16, s16, s27
    s_add_u32 s16, s16, s25
    s_add_u32 s16, s16, 0
    s_lshl_b32 s17, s12, 12
    s_add_u32 s17, s17, 131072
    s_waitcnt lgkmcnt(0)
    s_add_u32 m0, s26, 0
    s_nop 0
    buffer_load_dwordx4 v113, s[36:39], s24 offen offset:0 lds
    s_add_u32 m0, s26, 960
    s_nop 0
    buffer_load_dwordx4 v113, s[36:39], s24 offen offset:64 lds
    s_add_u32 m0, s26, 1920
    s_nop 0
    buffer_load_dwordx4 v113, s[36:39], s24 offen offset:128 lds
    s_add_u32 m0, s26, 2880
    s_nop 0
    buffer_load_dwordx4 v113, s[36:39], s24 offen offset:192 lds
    s_add_u32 m0, s26, 3840
    s_nop 0
    buffer_load_dwordx4 v113, s[36:39], s24 offen offset:256 lds
    s_add_u32 m0, s26, 4800
    s_nop 0
    buffer_load_dwordx4 v113, s[36:39], s24 offen offset:320 lds
    s_add_u32 m0, s26, 5760
    s_nop 0
    buffer_load_dwordx4 v113, s[36:39], s24 offen offset:384 lds
    s_add_u32 m0, s26, 6720
    s_nop 0
    buffer_load_dwordx4 v113, s[36:39], s24 offen offset:448 lds
    s_add_u32 s24, s24, 131072
    s_add_u32 m0, s26, 8192
    s_nop 0
    buffer_load_dwordx4 v113, s[36:39], s24 offen offset:0 lds
    s_add_u32 m0, s26, 9152
    s_nop 0
    buffer_load_dwordx4 v113, s[36:39], s24 offen offset:64 lds
    s_add_u32 m0, s26, 10112
    s_nop 0
    buffer_load_dwordx4 v113, s[36:39], s24 offen offset:128 lds
    s_add_u32 m0, s26, 11072
    s_nop 0
    buffer_load_dwordx4 v113, s[36:39], s24 offen offset:192 lds
    s_add_u32 m0, s26, 12032
    s_nop 0
    buffer_load_dwordx4 v113, s[36:39], s24 offen offset:256 lds
    s_add_u32 m0, s26, 12992
    s_nop 0
    buffer_load_dwordx4 v113, s[36:39], s24 offen offset:320 lds
    s_add_u32 m0, s26, 13952
    s_nop 0
    buffer_load_dwordx4 v113, s[36:39], s24 offen offset:384 lds
    s_add_u32 m0, s26, 14912
    s_nop 0
    buffer_load_dwordx4 v113, s[36:39], s24 offen offset:448 lds
    s_add_u32 s24, s24, 131072
    s_add_u32 m0, s26, 16384
    s_nop 0
    buffer_load_dwordx4 v113, s[36:39], s24 offen offset:0 lds
    s_add_u32 m0, s26, 17344
    s_nop 0
    buffer_load_dwordx4 v113, s[36:39], s24 offen offset:64 lds
    s_add_u32 m0, s26, 18304
    s_nop 0
    buffer_load_dwordx4 v113, s[36:39], s24 offen offset:128 lds
    s_add_u32 m0, s26, 19264
    s_nop 0
    buffer_load_dwordx4 v113, s[36:39], s24 offen offset:192 lds
    s_add_u32 m0, s26, 20224
    s_nop 0
    buffer_load_dwordx4 v113, s[36:39], s24 offen offset:256 lds
    s_add_u32 m0, s26, 21184
    s_nop 0
    buffer_load_dwordx4 v113, s[36:39], s24 offen offset:320 lds
    s_add_u32 m0, s26, 22144
    s_nop 0
    buffer_load_dwordx4 v113, s[36:39], s24 offen offset:384 lds
    s_add_u32 m0, s26, 23104
    s_nop 0
    buffer_load_dwordx4 v113, s[36:39], s24 offen offset:448 lds
    s_add_u32 s24, s24, 131072
    s_add_u32 m0, s26, 24576
    s_nop 0
    buffer_load_dwordx4 v113, s[36:39], s24 offen offset:0 lds
    s_add_u32 m0, s26, 25536
    s_nop 0
    buffer_load_dwordx4 v113, s[36:39], s24 offen offset:64 lds
    s_add_u32 m0, s26, 26496
    s_nop 0
    buffer_load_dwordx4 v113, s[36:39], s24 offen offset:128 lds
    s_add_u32 m0, s26, 27456
    s_nop 0
    buffer_load_dwordx4 v113, s[36:39], s24 offen offset:192 lds
    s_add_u32 m0, s26, 28416
    s_nop 0
    buffer_load_dwordx4 v113, s[36:39], s24 offen offset:256 lds
    s_add_u32 m0, s26, 29376
    s_nop 0
    buffer_load_dwordx4 v113, s[36:39], s24 offen offset:320 lds
    s_add_u32 m0, s26, 30336
    s_nop 0
    buffer_load_dwordx4 v113, s[36:39], s24 offen offset:384 lds
    s_add_u32 m0, s26, 31296
    s_nop 0
    buffer_load_dwordx4 v113, s[36:39], s24 offen offset:448 lds
    s_add_u32 s24, s24, 131072
    s_add_u32 m0, s17, 0
    s_nop 0
    buffer_load_dwordx4 v112, s[32:35], s16 offen offset:0 lds
    s_add_u32 m0, s17, 960
    s_nop 0
    buffer_load_dwordx4 v112, s[32:35], s16 offen offset:64 lds
    s_add_u32 m0, s17, 1920
    s_nop 0
    buffer_load_dwordx4 v112, s[32:35], s16 offen offset:128 lds
    s_add_u32 m0, s17, 2880
    s_nop 0
    buffer_load_dwordx4 v112, s[32:35], s16 offen offset:192 lds
    s_add_u32 s16, s16, 262144
    s_add_u32 s17, s17, 16384
    s_cmp_ge_u32 s17, 147456
    s_cselect_b32 s27, 65536, 0
    s_sub_u32 s17, s17, s27
    v_add_u32 v115, s26, v114
    v_mov_b32 v117, 0
    global_load_dword v118, v117, s[40:41] offset:128 sc1
    s_waitcnt vmcnt(1)
    ds_read_b128 v[120:123], v115 offset:0
    ds_read_b128 v[124:127], v115 offset:1024
    ds_read_b128 v[128:131], v115 offset:2048
    ds_read_b128 v[132:135], v115 offset:3072
    ds_read_b128 v[136:139], v115 offset:4096
    ds_read_b128 v[140:143], v115 offset:5120
    ds_read_b128 v[144:147], v115 offset:6144
    ds_read_b128 v[148:151], v115 offset:7168
    s_waitcnt lgkmcnt(0)
    ds_read_b128 v[152:155], v115 offset:8192
    ds_read_b128 v[156:159], v115 offset:9216
    ds_read_b128 v[160:163], v115 offset:10240
    ds_read_b128 v[164:167], v115 offset:11264
    ds_read_b128 v[168:171], v115 offset:12288
    ds_read_b128 v[172:175], v115 offset:13312
    ds_read_b128 v[176:179], v115 offset:14336
    ds_read_b128 v[180:183], v115 offset:15360
    s_waitcnt lgkmcnt(0)
    ds_read_b128 v[184:187], v115 offset:16384
    ds_read_b128 v[188:191], v115 offset:17408
    ds_read_b128 v[192:195], v115 offset:18432
    ds_read_b128 v[196:199], v115 offset:19456
    ds_read_b128 v[200:203], v115 offset:20480
    ds_read_b128 v[204:207], v115 offset:21504
    ds_read_b128 v[208:211], v115 offset:22528
    ds_read_b128 v[212:215], v115 offset:23552
    s_waitcnt lgkmcnt(0)
    ds_read_b128 v[216:219], v115 offset:24576
    ds_read_b128 v[220:223], v115 offset:25600
    ds_read_b128 v[224:227], v115 offset:26624
    ds_read_b128 v[228:231], v115 offset:27648
    ds_read_b128 v[232:235], v115 offset:28672
    ds_read_b128 v[236:239], v115 offset:29696
    ds_read_b128 v[240:243], v115 offset:30720
    ds_read_b128 v[244:247], v115 offset:31744
    s_waitcnt lgkmcnt(0)
    s_barrier
    s_mov_b32 s19, 1073741824
    s_add_u32 m0, s17, 0
    s_nop 0
    buffer_load_dwordx4 v112, s[32:35], s16 offen offset:0 lds
    s_add_u32 m0, s17, 960
    s_nop 0
    buffer_load_dwordx4 v112, s[32:35], s16 offen offset:64 lds
    s_add_u32 m0, s17, 1920
    s_nop 0
    buffer_load_dwordx4 v112, s[32:35], s16 offen offset:128 lds
    s_add_u32 m0, s17, 2880
    s_nop 0
    buffer_load_dwordx4 v112, s[32:35], s16 offen offset:192 lds
    s_add_u32 s16, s16, 262144
    s_add_u32 s17, s17, 16384
    s_cmp_ge_u32 s17, 147456
    s_cselect_b32 s27, 65536, 0
    s_sub_u32 s17, s17, s27
    s_add_u32 m0, s17, 0
    s_nop 0
    buffer_load_dwordx4 v112, s[32:35], s16 offen offset:0 lds
    s_add_u32 m0, s17, 960
    s_nop 0
    buffer_load_dwordx4 v112, s[32:35], s16 offen offset:64 lds
    s_add_u32 m0, s17, 1920
    s_nop 0
    buffer_load_dwordx4 v112, s[32:35], s16 offen offset:128 lds
    s_add_u32 m0, s17, 2880
    s_nop 0
    buffer_load_dwordx4 v112, s[32:35], s16 offen offset:192 lds
    s_add_u32 s16, s16, 262144
    s_add_u32 s17, s17, 16384
    s_cmp_ge_u32 s17, 147456
    s_cselect_b32 s27, 65536, 0
    s_sub_u32 s17, s17, s27
    v_add_u32 v115, 131072, v114
    s_mov_b32 s15, 0
    s_mov_b32 s21, 106181136
    s_cmp_eq_u32 s12, 1
    s_cselect_b32 s21, 103944276, s21
    s_cmp_eq_u32 s12, 2
    s_cselect_b32 s21, 101733426, s21
    s_cmp_eq_u32 s12, 3
    s_cselect_b32 s21, 5517921, s21
    s_lshl_b32 s21, s21, 4
    s_or_b32 s21, s21, 7
    s_mul_i32 s18, s14, 401408
    s_mul_i32 s25, s12, 100352
    s_add_u32 s18, s18, s25
    s_mov_b32 s19, 1073741824
    ds_read_b128 v[96:99], v115 offset:0
    ds_read_b128 v[100:103], v115 offset:8192
L_la_21:
    s_waitcnt lgkmcnt(0)
    v_mfma_f32_16x16x32_bf16 v[0:3], v[96:99], v[120:123], 0
    ds_read_b128 v[104:107], v115 offset:1024
    v_mfma_f32_16x16x32_bf16 v[4:7], v[100:103], v[120:123], 0
    ds_read_b128 v[108:111], v115 offset:9216
    v_mfma_f32_16x16x32_bf16 v[8:11], v[96:99], v[152:155], 0
    s_add_u32 m0, s17, 0
    s_nop 0
    buffer_load_dwordx4 v112, s[32:35], s16 offen offset:0 lds
    v_mfma_f32_16x16x32_bf16 v[12:15], v[100:103], v[152:155], 0
    v_cvt_pk_bf16_f32 v80, v32, v33
    v_mfma_f32_16x16x32_bf16 v[16:19], v[96:99], v[184:187], 0
    v_cvt_pk_bf16_f32 v81, v34, v35
    v_mfma_f32_16x16x32_bf16 v[20:23], v[100:103], v[184:187], 0
    v_cvt_pk_bf16_f32 v82, v36, v37
    v_mfma_f32_16x16x32_bf16 v[24:27], v[96:99], v[216:219], 0
    v_cvt_pk_bf16_f32 v83, v38, v39
    v_mfma_f32_16x16x32_bf16 v[28:31], v[100:103], v[216:219], 0
    v_cvt_pk_bf16_f32 v84, v40, v41
    s_waitcnt lgkmcnt(0)
    v_mfma_f32_16x16x32_bf16 v[0:3], v[104:107], v[124:127], v[0:3]
    ds_read_b128 v[96:99], v115 offset:2048
    v_mfma_f32_16x16x32_bf16 v[4:7], v[108:111], v[124:127], v[4:7]
    ds_read_b128 v[100:103], v115 offset:10240
    v_mfma_f32_16x16x32_bf16 v[8:11], v[104:107], v[156:159], v[8:11]
    s_add_u32 m0, s17, 960
    s_nop 0
    buffer_load_dwordx4 v112, s[32:35], s16 offen offset:64 lds
    v_mfma_f32_16x16x32_bf16 v[12:15], v[108:111], v[156:159], v[12:15]
    v_cvt_pk_bf16_f32 v85, v42, v43
    v_mfma_f32_16x16x32_bf16 v[16:19], v[104:107], v[188:191], v[16:19]
    v_cvt_pk_bf16_f32 v86, v44, v45
    v_mfma_f32_16x16x32_bf16 v[20:23], v[108:111], v[188:191], v[20:23]
    v_cvt_pk_bf16_f32 v87, v46, v47
    v_mfma_f32_16x16x32_bf16 v[24:27], v[104:107], v[220:223], v[24:27]
    v_cvt_pk_bf16_f32 v88, v48, v49
    v_mfma_f32_16x16x32_bf16 v[28:31], v[108:111], v[220:223], v[28:31]
    v_cvt_pk_bf16_f32 v89, v50, v51
    s_waitcnt lgkmcnt(0)
    v_mfma_f32_16x16x32_bf16 v[0:3], v[96:99], v[128:131], v[0:3]
    ds_read_b128 v[104:107], v115 offset:3072
    v_mfma_f32_16x16x32_bf16 v[4:7], v[100:103], v[128:131], v[4:7]
    ds_read_b128 v[108:111], v115 offset:11264
    v_mfma_f32_16x16x32_bf16 v[8:11], v[96:99], v[160:163], v[8:11]
    s_add_u32 m0, s17, 1920
    s_nop 0
    buffer_load_dwordx4 v112, s[32:35], s16 offen offset:128 lds
    v_mfma_f32_16x16x32_bf16 v[12:15], v[100:103], v[160:163], v[12:15]
    v_cvt_pk_bf16_f32 v90, v52, v53
    v_mfma_f32_16x16x32_bf16 v[16:19], v[96:99], v[192:195], v[16:19]
    v_cvt_pk_bf16_f32 v91, v54, v55
    v_mfma_f32_16x16x32_bf16 v[20:23], v[100:103], v[192:195], v[20:23]
    v_cvt_pk_bf16_f32 v92, v56, v57
    v_mfma_f32_16x16x32_bf16 v[24:27], v[96:99], v[224:227], v[24:27]
    v_cvt_pk_bf16_f32 v93, v58, v59
    v_mfma_f32_16x16x32_bf16 v[28:31], v[100:103], v[224:227], v[28:31]
    v_cvt_pk_bf16_f32 v94, v60, v61
    s_waitcnt lgkmcnt(0)
    v_mfma_f32_16x16x32_bf16 v[0:3], v[104:107], v[132:135], v[0:3]
    ds_read_b128 v[96:99], v115 offset:4096
    v_mfma_f32_16x16x32_bf16 v[4:7], v[108:111], v[132:135], v[4:7]
    ds_read_b128 v[100:103], v115 offset:12288
    v_mfma_f32_16x16x32_bf16 v[8:11], v[104:107], v[164:167], v[8:11]
    s_add_u32 m0, s17, 2880
    s_nop 0
    buffer_load_dwordx4 v112, s[32:35], s16 offen offset:192 lds
    v_mfma_f32_16x16x32_bf16 v[12:15], v[108:111], v[164:167], v[12:15]
    v_cvt_pk_bf16_f32 v95, v62, v63
    v_mfma_f32_16x16x32_bf16 v[16:19], v[104:107], v[196:199], v[16:19]
    v_mfma_f32_16x16x32_bf16 v[20:23], v[108:111], v[196:199], v[20:23]
    v_mfma_f32_16x16x32_bf16 v[24:27], v[104:107], v[228:231], v[24:27]
    v_mfma_f32_16x16x32_bf16 v[28:31], v[108:111], v[228:231], v[28:31]
    s_waitcnt lgkmcnt(0)
    v_mfma_f32_16x16x32_bf16 v[0:3], v[96:99], v[136:139], v[0:3]
    ds_read_b128 v[104:107], v115 offset:5120
    v_mfma_f32_16x16x32_bf16 v[4:7], v[100:103], v[136:139], v[4:7]
    ds_read_b128 v[108:111], v115 offset:13312
    v_mfma_f32_16x16x32_bf16 v[8:11], v[96:99], v[168:171], v[8:11]
    s_add_u32 s16, s16, 262144
    s_add_u32 s17, s17, 16384
    s_cmp_ge_u32 s17, 147456
    s_cselect_b32 s27, 65536, 0
    s_sub_u32 s17, s17, s27
    v_mfma_f32_16x16x32_bf16 v[12:15], v[100:103], v[168:171], v[12:15]
    v_mfma_f32_16x16x32_bf16 v[16:19], v[96:99], v[200:203], v[16:19]
    v_mfma_f32_16x16x32_bf16 v[20:23], v[100:103], v[200:203], v[20:23]
    v_mfma_f32_16x16x32_bf16 v[24:27], v[96:99], v[232:235], v[24:27]
    v_mfma_f32_16x16x32_bf16 v[28:31], v[100:103], v[232:235], v[28:31]
    s_waitcnt lgkmcnt(0)
    v_mfma_f32_16x16x32_bf16 v[0:3], v[104:107], v[140:143], v[0:3]
    ds_read_b128 v[96:99], v115 offset:6144
    v_mfma_f32_16x16x32_bf16 v[4:7], v[108:111], v[140:143], v[4:7]
    ds_read_b128 v[100:103], v115 offset:14336
    v_mfma_f32_16x16x32_bf16 v[8:11], v[104:107], v[172:175], v[8:11]
    v_mfma_f32_16x16x32_bf16 v[12:15], v[108:111], v[172:175], v[12:15]
    v_mfma_f32_16x16x32_bf16 v[16:19], v[104:107], v[204:207], v[16:19]
    v_mfma_f32_16x16x32_bf16 v[20:23], v[108:111], v[204:207], v[20:23]
    v_mfma_f32_16x16x32_bf16 v[24:27], v[104:107], v[236:239], v[24:27]
    v_mfma_f32_16x16x32_bf16 v[28:31], v[108:111], v[236:239], v[28:31]
    s_waitcnt lgkmcnt(0)
    v_mfma_f32_16x16x32_bf16 v[0:3], v[96:99], v[144:147], v[0:3]
    ds_read_b128 v[104:107], v115 offset:7168
    v_mfma_f32_16x16x32_bf16 v[4:7], v[100:103], v[144:147], v[4:7]
    ds_read_b128 v[108:111], v115 offset:15360
    v_mfma_f32_16x16x32_bf16 v[8:11], v[96:99], v[176:179], v[8:11]
    v_mfma_f32_16x16x32_bf16 v[12:15], v[100:103], v[176:179], v[12:15]
    v_mfma_f32_16x16x32_bf16 v[16:19], v[96:99], v[208:211], v[16:19]
    v_mfma_f32_16x16x32_bf16 v[20:23], v[100:103], v[208:211], v[20:23]
    v_mfma_f32_16x16x32_bf16 v[24:27], v[96:99], v[240:243], v[24:27]
    v_mfma_f32_16x16x32_bf16 v[28:31], v[100:103], v[240:243], v[28:31]
    v_add_u32 v115, 16384, v115
    v_add_u32 v113, -65536, v115
    v_cmp_le_u32 vcc, 147456, v115
    s_nop 1
    v_cndmask_b32 v115, v115, v113, vcc
    s_waitcnt vmcnt(8) lgkmcnt(0)
    s_barrier
    v_mfma_f32_16x16x32_bf16 v[0:3], v[104:107], v[148:151], v[0:3]
    ds_read_b128 v[96:99], v115 offset:0
    v_mfma_f32_16x16x32_bf16 v[4:7], v[108:111], v[148:151], v[4:7]
    ds_read_b128 v[100:103], v115 offset:8192
    v_mfma_f32_16x16x32_bf16 v[8:11], v[104:107], v[180:183], v[8:11]
    v_mfma_f32_16x16x32_bf16 v[12:15], v[108:111], v[180:183], v[12:15]
    v_mfma_f32_16x16x32_bf16 v[16:19], v[104:107], v[212:215], v[16:19]
    v_mfma_f32_16x16x32_bf16 v[20:23], v[108:111], v[212:215], v[20:23]
    v_mfma_f32_16x16x32_bf16 v[24:27], v[104:107], v[244:247], v[24:27]
    v_mfma_f32_16x16x32_bf16 v[28:31], v[108:111], v[244:247], v[28:31]
L_lcm_23:
    s_and_b32 s24, s21, 15
    s_lshr_b32 s21, s21, 4
    s_cmp_eq_u32 s24, 0
    s_cbranch_scc1 L_lc_25
    s_cmp_eq_u32 s24, 1
    s_cbranch_scc1 L_lc_26
    s_cmp_eq_u32 s24, 2
    s_cbranch_scc1 L_lc_27
    s_cmp_eq_u32 s24, 3
    s_cbranch_scc1 L_lc_28
    s_cmp_eq_u32 s24, 4
    s_cbranch_scc1 L_lc_29
    s_cmp_eq_u32 s24, 5
    s_cbranch_scc1 L_lc_30
    s_cmp_eq_u32 s24, 6
    s_cbranch_scc1 L_lc_31
    s_branch L_lce_24
L_lc_25:
    v_accvgpr_write_b32 a0, v64
    v_accvgpr_write_b32 a1, v65
    v_accvgpr_write_b32 a2, v66
    v_accvgpr_write_b32 a3, v67
    v_accvgpr_write_b32 a4, v80
    v_accvgpr_write_b32 a5, v81
    v_accvgpr_write_b32 a6, v82
    v_accvgpr_write_b32 a7, v83
    v_accvgpr_write_b32 a56, v68
    v_accvgpr_write_b32 a57, v69
    v_accvgpr_write_b32 a58, v70
    v_accvgpr_write_b32 a59, v71
    v_accvgpr_write_b32 a60, v84
    v_accvgpr_write_b32 a61, v85
    v_accvgpr_write_b32 a62, v86
    v_accvgpr_write_b32 a63, v87
    v_accvgpr_write_b32 a112, v72
    v_accvgpr_write_b32 a113, v73
    v_accvgpr_write_b32 a114, v74
    v_accvgpr_write_b32 a115, v75
    v_accvgpr_write_b32 a116, v88
    v_accvgpr_write_b32 a117, v89
    v_accvgpr_write_b32 a118, v90
    v_accvgpr_write_b32 a119, v91
    v_accvgpr_write_b32 a168, v76
    v_accvgpr_write_b32 a169, v77
    v_accvgpr_write_b32 a170, v78
    v_accvgpr_write_b32 a171, v79
    v_accvgpr_write_b32 a172, v92
    v_accvgpr_write_b32 a173, v93
    v_accvgpr_write_b32 a174, v94
    v_accvgpr_write_b32 a175, v95
    s_branch L_lce_24
L_lc_26:
    v_accvgpr_write_b32 a8, v64
    v_accvgpr_write_b32 a9, v65
    v_accvgpr_write_b32 a10, v66
    v_accvgpr_write_b32 a11, v67
    v_accvgpr_write_b32 a12, v80
    v_accvgpr_write_b32 a13, v81
    v_accvgpr_write_b32 a14, v82
    v_accvgpr_write_b32 a15, v83
    v_accvgpr_write_b32 a64, v68
    v_accvgpr_write_b32 a65, v69
    v_accvgpr_write_b32 a66, v70
    v_accvgpr_write_b32 a67, v71
    v_accvgpr_write_b32 a68, v84
    v_accvgpr_write_b32 a69, v85
    v_accvgpr_write_b32 a70, v86
    v_accvgpr_write_b32 a71, v87
    v_accvgpr_write_b32 a120, v72
    v_accvgpr_write_b32 a121, v73
    v_accvgpr_write_b32 a122, v74
    v_accvgpr_write_b32 a123, v75
    v_accvgpr_write_b32 a124, v88
    v_accvgpr_write_b32 a125, v89
    v_accvgpr_write_b32 a126, v90
    v_accvgpr_write_b32 a127, v91
    v_accvgpr_write_b32 a176, v76
    v_accvgpr_write_b32 a177, v77
    v_accvgpr_write_b32 a178, v78
    v_accvgpr_write_b32 a179, v79
    v_accvgpr_write_b32 a180, v92
    v_accvgpr_write_b32 a181, v93
    v_accvgpr_write_b32 a182, v94
    v_accvgpr_write_b32 a183, v95
    s_branch L_lce_24
L_lc_27:
    v_accvgpr_write_b32 a16, v64
    v_accvgpr_write_b32 a17, v65
    v_accvgpr_write_b32 a18, v66
    v_accvgpr_write_b32 a19, v67
    v_accvgpr_write_b32 a20, v80
    v_accvgpr_write_b32 a21, v81
    v_accvgpr_write_b32 a22, v82
    v_accvgpr_write_b32 a23, v83
    v_accvgpr_write_b32 a72, v68
    v_accvgpr_write_b32 a73, v69
    v_accvgpr_write_b32 a74, v70
    v_accvgpr_write_b32 a75, v71
    v_accvgpr_write_b32 a76, v84
    v_accvgpr_write_b32 a77, v85
    v_accvgpr_write_b32 a78, v86
    v_accvgpr_write_b32 a79, v87
    v_accvgpr_write_b32 a128, v72
    v_accvgpr_write_b32 a129, v73
    v_accvgpr_write_b32 a130, v74
    v_accvgpr_write_b32 a131, v75
    v_accvgpr_write_b32 a132, v88
    v_accvgpr_write_b32 a133, v89
    v_accvgpr_write_b32 a134, v90
    v_accvgpr_write_b32 a135, v91
    v_accvgpr_write_b32 a184, v76
    v_accvgpr_write_b32 a185, v77
    v_accvgpr_write_b32 a186, v78
    v_accvgpr_write_b32 a187, v79
    v_accvgpr_write_b32 a188, v92
    v_accvgpr_write_b32 a189, v93
    v_accvgpr_write_b32 a190, v94
    v_accvgpr_write_b32 a191, v95
    s_branch L_lce_24
L_lc_28:
    v_accvgpr_write_b32 a24, v64
    v_accvgpr_write_b32 a25, v65
    v_accvgpr_write_b32 a26, v66
    v_accvgpr_write_b32 a27, v67
    v_accvgpr_write_b32 a28, v80
    v_accvgpr_write_b32 a29, v81
    v_accvgpr_write_b32 a30, v82
    v_accvgpr_write_b32 a31, v83
    v_accvgpr_write_b32 a80, v68
    v_accvgpr_write_b32 a81, v69
    v_accvgpr_write_b32 a82, v70
    v_accvgpr_write_b32 a83, v71
    v_accvgpr_write_b32 a84, v84
    v_accvgpr_write_b32 a85, v85
    v_accvgpr_write_b32 a86, v86
    v_accvgpr_write_b32 a87, v87
    v_accvgpr_write_b32 a136, v72
    v_accvgpr_write_b32 a137, v73
    v_accvgpr_write_b32 a138, v74
    v_accvgpr_write_b32 a139, v75
    v_accvgpr_write_b32 a140, v88
    v_accvgpr_write_b32 a141, v89
    v_accvgpr_write_b32 a142, v90
    v_accvgpr_write_b32 a143, v91
    v_accvgpr_write_b32 a192, v76
    v_accvgpr_write_b32 a193, v77
    v_accvgpr_write_b32 a194, v78
    v_accvgpr_write_b32 a195, v79
    v_accvgpr_write_b32 a196, v92
    v_accvgpr_write_b32 a197, v93
    v_accvgpr_write_b32 a198, v94
    v_accvgpr_write_b32 a199, v95
    s_branch L_lce_24
L_lc_29:
    v_accvgpr_write_b32 a32, v64
    v_accvgpr_write_b32 a33, v65
    v_accvgpr_write_b32 a34, v66
    v_accvgpr_write_b32 a35, v67
    v_accvgpr_write_b32 a36, v80
    v_accvgpr_write_b32 a37, v81
    v_accvgpr_write_b32 a38, v82
    v_accvgpr_write_b32 a39, v83
    v_accvgpr_write_b32 a88, v68
    v_accvgpr_write_b32 a89, v69
    v_accvgpr_write_b32 a90, v70
    v_accvgpr_write_b32 a91, v71
    v_accvgpr_write_b32 a92, v84
    v_accvgpr_write_b32 a93, v85
    v_accvgpr_write_b32 a94, v86
    v_accvgpr_write_b32 a95, v87
    v_accvgpr_write_b32 a144, v72
    v_accvgpr_write_b32 a145, v73
    v_accvgpr_write_b32 a146, v74
    v_accvgpr_write_b32 a147, v75
    v_accvgpr_write_b32 a148, v88
    v_accvgpr_write_b32 a149, v89
    v_accvgpr_write_b32 a150, v90
    v_accvgpr_write_b32 a151, v91
    v_accvgpr_write_b32 a200, v76
    v_accvgpr_write_b32 a201, v77
    v_accvgpr_write_b32 a202, v78
    v_accvgpr_write_b32 a203, v79
    v_accvgpr_write_b32 a204, v92
    v_accvgpr_write_b32 a205, v93
    v_accvgpr_write_b32 a206, v94
    v_accvgpr_write_b32 a207, v95
    s_branch L_lce_24
L_lc_30:
    v_accvgpr_write_b32 a40, v64
    v_accvgpr_write_b32 a41, v65
    v_accvgpr_write_b32 a42, v66
    v_accvgpr_write_b32 a43, v67
    v_accvgpr_write_b32 a44, v80
    v_accvgpr_write_b32 a45, v81
    v_accvgpr_write_b32 a46, v82
    v_accvgpr_write_b32 a47, v83
    v_accvgpr_write_b32 a96, v68
    v_accvgpr_write_b32 a97, v69
    v_accvgpr_write_b32 a98, v70
    v_accvgpr_write_b32 a99, v71
    v_accvgpr_write_b32 a100, v84
    v_accvgpr_write_b32 a101, v85
    v_accvgpr_write_b32 a102, v86
    v_accvgpr_write_b32 a103, v87
    v_accvgpr_write_b32 a152, v72
    v_accvgpr_write_b32 a153, v73
    v_accvgpr_write_b32 a154, v74
    v_accvgpr_write_b32 a155, v75
    v_accvgpr_write_b32 a156, v88
    v_accvgpr_write_b32 a157, v89
    v_accvgpr_write_b32 a158, v90
    v_accvgpr_write_b32 a159, v91
    v_accvgpr_write_b32 a208, v76
    v_accvgpr_write_b32 a209, v77
    v_accvgpr_write_b32 a210, v78
    v_accvgpr_write_b32 a211, v79
    v_accvgpr_write_b32 a212, v92
    v_accvgpr_write_b32 a213, v93
    v_accvgpr_write_b32 a214, v94
    v_accvgpr_write_b32 a215, v95
    s_branch L_lce_24
L_lc_31:
    v_accvgpr_write_b32 a48, v64
    v_accvgpr_write_b32 a49, v65
    v_accvgpr_write_b32 a50, v66
    v_accvgpr_write_b32 a51, v67
    v_accvgpr_write_b32 a52, v80
    v_accvgpr_write_b32 a53, v81
    v_accvgpr_write_b32 a54, v82
    v_accvgpr_write_b32 a55, v83
    v_accvgpr_write_b32 a104, v68
    v_accvgpr_write_b32 a105, v69
    v_accvgpr_write_b32 a106, v70
    v_accvgpr_write_b32 a107, v71
    v_accvgpr_write_b32 a108, v84
    v_accvgpr_write_b32 a109, v85
    v_accvgpr_write_b32 a110, v86
    v_accvgpr_write_b32 a111, v87
    v_accvgpr_write_b32 a160, v72
    v_accvgpr_write_b32 a161, v73
    v_accvgpr_write_b32 a162, v74
    v_accvgpr_write_b32 a163, v75
    v_accvgpr_write_b32 a164, v88
    v_accvgpr_write_b32 a165, v89
    v_accvgpr_write_b32 a166, v90
    v_accvgpr_write_b32 a167, v91
    v_accvgpr_write_b32 a216, v76
    v_accvgpr_write_b32 a217, v77
    v_accvgpr_write_b32 a218, v78
    v_accvgpr_write_b32 a219, v79
    v_accvgpr_write_b32 a220, v92
    v_accvgpr_write_b32 a221, v93
    v_accvgpr_write_b32 a222, v94
    v_accvgpr_write_b32 a223, v95
L_lce_24:
    s_cmp_ge_u32 s15, 7
    s_cbranch_scc1 L_lax_22
    s_waitcnt lgkmcnt(0)
    v_mfma_f32_16x16x32_bf16 v[32:35], v[96:99], v[120:123], 0
    ds_read_b128 v[104:107], v115 offset:1024
    v_mfma_f32_16x16x32_bf16 v[36:39], v[100:103], v[120:123], 0
    ds_read_b128 v[108:111], v115 offset:9216
    v_mfma_f32_16x16x32_bf16 v[40:43], v[96:99], v[152:155], 0
    s_add_u32 m0, s17, 0
    s_nop 0
    buffer_load_dwordx4 v112, s[32:35], s16 offen offset:0 lds
    v_mfma_f32_16x16x32_bf16 v[44:47], v[100:103], v[152:155], 0
    v_cvt_pk_bf16_f32 v64, v0, v1
    v_mfma_f32_16x16x32_bf16 v[48:51], v[96:99], v[184:187], 0
    v_cvt_pk_bf16_f32 v65, v2, v3
    v_mfma_f32_16x16x32_bf16 v[52:55], v[100:103], v[184:187], 0
    v_cvt_pk_bf16_f32 v66, v4, v5
    v_mfma_f32_16x16x32_bf16 v[56:59], v[96:99], v[216:219], 0
    v_cvt_pk_bf16_f32 v67, v6, v7
    v_mfma_f32_16x16x32_bf16 v[60:63], v[100:103], v[216:219], 0
    v_cvt_pk_bf16_f32 v68, v8, v9
    s_waitcnt lgkmcnt(0)
    v_mfma_f32_16x16x32_bf16 v[32:35], v[104:107], v[124:127], v[32:35]
    ds_read_b128 v[96:99], v115 offset:2048
    v_mfma_f32_16x16x32_bf16 v[36:39], v[108:111], v[124:127], v[36:39]
    ds_read_b128 v[100:103], v115 offset:10240
    v_mfma_f32_16x16x32_bf16 v[40:43], v[104:107], v[156:159], v[40:43]
    s_add_u32 m0, s17, 960
    s_nop 0
    buffer_load_dwordx4 v112, s[32:35], s16 offen offset:64 lds
    v_mfma_f32_16x16x32_bf16 v[44:47], v[108:111], v[156:159], v[44:47]
    v_cvt_pk_bf16_f32 v69, v10, v11
    v_mfma_f32_16x16x32_bf16 v[48:51], v[104:107], v[188:191], v[48:51]
    v_cvt_pk_bf16_f32 v70, v12, v13
    v_mfma_f32_16x16x32_bf16 v[52:55], v[108:111], v[188:191], v[52:55]
    v_cvt_pk_bf16_f32 v71, v14, v15
    v_mfma_f32_16x16x32_bf16 v[56:59], v[104:107], v[220:223], v[56:59]
    v_cvt_pk_bf16_f32 v72, v16, v17
    v_mfma_f32_16x16x32_bf16 v[60:63], v[108:111], v[220:223], v[60:63]
    v_cvt_pk_bf16_f32 v73, v18, v19
    s_waitcnt lgkmcnt(0)
    v_mfma_f32_16x16x32_bf16 v[32:35], v[96:99], v[128:131], v[32:35]
    ds_read_b128 v[104:107], v115 offset:3072
    v_mfma_f32_16x16x32_bf16 v[36:39], v[100:103], v[128:131], v[36:39]
    ds_read_b128 v[108:111], v115 offset:11264
    v_mfma_f32_16x16x32_bf16 v[40:43], v[96:99], v[160:163], v[40:43]
    s_add_u32 m0, s17, 1920
    s_nop 0
    buffer_load_dwordx4 v112, s[32:35], s16 offen offset:128 lds
    v_mfma_f32_16x16x32_bf16 v[44:47], v[100:103], v[160:163], v[44:47]
    v_cvt_pk_bf16_f32 v74, v20, v21
    v_mfma_f32_16x16x32_bf16 v[48:51], v[96:99], v[192:195], v[48:51]
    v_cvt_pk_bf16_f32 v75, v22, v23
    v_mfma_f32_16x16x32_bf16 v[52:55], v[100:103], v[192:195], v[52:55]
    v_cvt_pk_bf16_f32 v76, v24, v25
    v_mfma_f32_16x16x32_bf16 v[56:59], v[96:99], v[224:227], v[56:59]
    v_cvt_pk_bf16_f32 v77, v26, v27
    v_mfma_f32_16x16x32_bf16 v[60:63], v[100:103], v[224:227], v[60:63]
    v_cvt_pk_bf16_f32 v78, v28, v29
    s_waitcnt lgkmcnt(0)
    v_mfma_f32_16x16x32_bf16 v[32:35], v[104:107], v[132:135], v[32:35]
    ds_read_b128 v[96:99], v115 offset:4096
    v_mfma_f32_16x16x32_bf16 v[36:39], v[108:111], v[132:135], v[36:39]
    ds_read_b128 v[100:103], v115 offset:12288
    v_mfma_f32_16x16x32_bf16 v[40:43], v[104:107], v[164:167], v[40:43]
    s_add_u32 m0, s17, 2880
    s_nop 0
    buffer_load_dwordx4 v112, s[32:35], s16 offen offset:192 lds
    v_mfma_f32_16x16x32_bf16 v[44:47], v[108:111], v[164:167], v[44:47]
    v_cvt_pk_bf16_f32 v79, v30, v31
    v_mfma_f32_16x16x32_bf16 v[48:51], v[104:107], v[196:199], v[48:51]
    v_mfma_f32_16x16x32_bf16 v[52:55], v[108:111], v[196:199], v[52:55]
    v_mfma_f32_16x16x32_bf16 v[56:59], v[104:107], v[228:231], v[56:59]
    v_mfma_f32_16x16x32_bf16 v[60:63], v[108:111], v[228:231], v[60:63]
    s_waitcnt lgkmcnt(0)
    v_mfma_f32_16x16x32_bf16 v[32:35], v[96:99], v[136:139], v[32:35]
    ds_read_b128 v[104:107], v115 offset:5120
    v_mfma_f32_16x16x32_bf16 v[36:39], v[100:103], v[136:139], v[36:39]
    ds_read_b128 v[108:111], v115 offset:13312
    v_mfma_f32_16x16x32_bf16 v[40:43], v[96:99], v[168:171], v[40:43]
    s_add_u32 s16, s16, 262144
    s_add_u32 s17, s17, 16384
    s_cmp_ge_u32 s17, 147456
    s_cselect_b32 s27, 65536, 0
    s_sub_u32 s17, s17, s27
    v_mfma_f32_16x16x32_bf16 v[44:47], v[100:103], v[168:171], v[44:47]
    v_mfma_f32_16x16x32_bf16 v[48:51], v[96:99], v[200:203], v[48:51]
    v_mfma_f32_16x16x32_bf16 v[52:55], v[100:103], v[200:203], v[52:55]
    v_mfma_f32_16x16x32_bf16 v[56:59], v[96:99], v[232:235], v[56:59]
    v_mfma_f32_16x16x32_bf16 v[60:63], v[100:103], v[232:235], v[60:63]
    s_waitcnt lgkmcnt(0)
    v_mfma_f32_16x16x32_bf16 v[32:35], v[104:107], v[140:143], v[32:35]
    ds_read_b128 v[96:99], v115 offset:6144
    v_mfma_f32_16x16x32_bf16 v[36:39], v[108:111], v[140:143], v[36:39]
    ds_read_b128 v[100:103], v115 offset:14336
    v_mfma_f32_16x16x32_bf16 v[40:43], v[104:107], v[172:175], v[40:43]
    v_mfma_f32_16x16x32_bf16 v[44:47], v[108:111], v[172:175], v[44:47]
    v_mfma_f32_16x16x32_bf16 v[48:51], v[104:107], v[204:207], v[48:51]
    v_mfma_f32_16x16x32_bf16 v[52:55], v[108:111], v[204:207], v[52:55]
    v_mfma_f32_16x16x32_bf16 v[56:59], v[104:107], v[236:239], v[56:59]
    v_mfma_f32_16x16x32_bf16 v[60:63], v[108:111], v[236:239], v[60:63]
    s_waitcnt lgkmcnt(0)
    v_mfma_f32_16x16x32_bf16 v[32:35], v[96:99], v[144:147], v[32:35]
    ds_read_b128 v[104:107], v115 offset:7168
    v_mfma_f32_16x16x32_bf16 v[36:39], v[100:103], v[144:147], v[36:39]
    ds_read_b128 v[108:111], v115 offset:15360
    v_mfma_f32_16x16x32_bf16 v[40:43], v[96:99], v[176:179], v[40:43]
    v_mfma_f32_16x16x32_bf16 v[44:47], v[100:103], v[176:179], v[44:47]
    v_mfma_f32_16x16x32_bf16 v[48:51], v[96:99], v[208:211], v[48:51]
    v_mfma_f32_16x16x32_bf16 v[52:55], v[100:103], v[208:211], v[52:55]
    v_mfma_f32_16x16x32_bf16 v[56:59], v[96:99], v[240:243], v[56:59]
    v_mfma_f32_16x16x32_bf16 v[60:63], v[100:103], v[240:243], v[60:63]
    v_add_u32 v115, 16384, v115
    v_add_u32 v113, -65536, v115
    v_cmp_le_u32 vcc, 147456, v115
    s_nop 1
    v_cndmask_b32 v115, v115, v113, vcc
    s_waitcnt vmcnt(8) lgkmcnt(0)
    s_barrier
    v_mfma_f32_16x16x32_bf16 v[32:35], v[104:107], v[148:151], v[32:35]
    ds_read_b128 v[96:99], v115 offset:0
    v_mfma_f32_16x16x32_bf16 v[36:39], v[108:111], v[148:151], v[36:39]
    ds_read_b128 v[100:103], v115 offset:8192
    v_mfma_f32_16x16x32_bf16 v[40:43], v[104:107], v[180:183], v[40:43]
    v_mfma_f32_16x16x32_bf16 v[44:47], v[108:111], v[180:183], v[44:47]
    v_mfma_f32_16x16x32_bf16 v[48:51], v[104:107], v[212:215], v[48:51]
    v_mfma_f32_16x16x32_bf16 v[52:55], v[108:111], v[212:215], v[52:55]
    v_mfma_f32_16x16x32_bf16 v[56:59], v[104:107], v[244:247], v[56:59]
    v_mfma_f32_16x16x32_bf16 v[60:63], v[108:111], v[244:247], v[60:63]
    s_add_u32 s15, s15, 1
    s_cmp_lt_u32 s15, 7
    s_cbranch_scc1 L_la_21
    v_cvt_pk_bf16_f32 v80, v32, v33
    v_cvt_pk_bf16_f32 v81, v34, v35
    v_cvt_pk_bf16_f32 v82, v36, v37
    v_cvt_pk_bf16_f32 v83, v38, v39
    v_cvt_pk_bf16_f32 v84, v40, v41
    v_cvt_pk_bf16_f32 v85, v42, v43
    v_cvt_pk_bf16_f32 v86, v44, v45
    v_cvt_pk_bf16_f32 v87, v46, v47
    v_cvt_pk_bf16_f32 v88, v48, v49
    v_cvt_pk_bf16_f32 v89, v50, v51
    v_cvt_pk_bf16_f32 v90, v52, v53
    v_cvt_pk_bf16_f32 v91, v54, v55
    v_cvt_pk_bf16_f32 v92, v56, v57
    v_cvt_pk_bf16_f32 v93, v58, v59
    v_cvt_pk_bf16_f32 v94, v60, v61
    v_cvt_pk_bf16_f32 v95, v62, v63
    s_branch L_lcm_23
L_lax_22:
    v_cmp_ne_u32 vcc, 0, v118
    s_cbranch_vccnz L_lok_32
    s_mov_b32 s20, 0x20000
    v_mov_b32 v10, 0
L_wd_33:
    global_load_dword v11, v10, s[40:41] offset:128 sc1
    s_waitcnt vmcnt(0)
    v_cmp_gt_u32 vcc, 1, v11
    s_cbranch_vccz L_wdd_34
    s_sleep 2
    s_sub_u32 s20, s20, 1
    s_cbranch_scc0 L_wd_33
    s_branch L_fin
L_wdd_34:
L_lok_32:
    v_and_b32 v20, 63, v119
    v_and_b32 v21, 15, v119
    v_bfe_u32 v22, v119, 4, 2
    v_lshlrev_b32 v101, 4, v20
    v_mov_b32 v100, 0x4444
    v_mov_b32 v1, 0xeeee
    v_and_b32 v2, 2, v21
    v_cmp_ne_u32 vcc, 0, v2
    s_nop 1
    v_cndmask_b32 v100, v100, v1, vcc
    s_lshl_b32 s24, s12, 11
    v_add_u32 v102, s24, v101
    v_lshrrev_b32 v4, 5, v20
    v_and_b32 v5, 31, v20
    s_lshl_b32 s26, s13, 6
    s_add_u32 s26, s26, 59769856
    s_mov_b32 s30, s26
    v_lshrrev_b32 v6, 2, v20
    v_lshrrev_b32 v7, 5, v20
    v_lshlrev_b32 v7, 1, v7
    v_and_b32 v113, 3, v20
    v_xor_b32 v7, v7, v113
    s_mov_b32 s27, 1792
    v_mul_lo_u32 v113, v6, s27
    v_lshl_add_u32 v113, v7, 4, v113
    s_lshr_b32 s25, s12, 1
    s_mul_i32 s25, s25, 896
    s_and_b32 s26, s12, 1
    s_mul_i32 s26, s26, 448
    s_add_u32 s25, s25, s26
    v_add_u32 v113, s25, v113
    s_mul_i32 s31, s12, 7168
    s_add_u32 s31, s31, 65536
    s_mov_b32 s17, 0
    s_mov_b32 s20, 0x20000
    v_lshlrev_b32 v14, 2, v20
    v_cmp_gt_u32 s[42:43], 7, v20
L_wf_35:
    buffer_load_dword v10, v14, s[4:7], s30 offen sc1
    s_waitcnt vmcnt(0)
    v_cmp_gt_u32 vcc, 1, v10
    s_nop 0
    s_and_b64 vcc, vcc, s[42:43]
    s_cbranch_scc0 L_wfd_36
    s_sleep 1
    s_sub_u32 s20, s20, 1
    s_cbranch_scc0 L_wf_35
    s_branch L_fin
L_wfd_36:
    s_barrier
    s_add_u32 m0, s31, 0
    s_nop 0
    buffer_load_dwordx4 v113, s[8:11], s17 offen offset:0 lds
    s_add_u32 m0, s31, 960
    s_nop 0
    buffer_load_dwordx4 v113, s[8:11], s17 offen offset:64 lds
    s_add_u32 m0, s31, 1920
    s_nop 0
    buffer_load_dwordx4 v113, s[8:11], s17 offen offset:128 lds
    s_add_u32 m0, s31, 2880
    s_nop 0
    buffer_load_dwordx4 v113, s[8:11], s17 offen offset:192 lds
    s_add_u32 m0, s31, 3840
    s_nop 0
    buffer_load_dwordx4 v113, s[8:11], s17 offen offset:256 lds
    s_add_u32 m0, s31, 4800
    s_nop 0
    buffer_load_dwordx4 v113, s[8:11], s17 offen offset:320 lds
    s_add_u32 m0, s31, 5760
    s_nop 0
    buffer_load_dwordx4 v113, s[8:11], s17 offen offset:384 lds
    s_add_u32 s17, s17, 28672
    s_xor_b32 s31, s31, 0x8000
    s_add_u32 m0, s31, 0
    s_nop 0
    buffer_load_dwordx4 v113, s[8:11], s17 offen offset:0 lds
    v_mov_b32 v17, 0
    global_load_dwordx2 v[18:19], v17, s[40:41] offset:0 sc1
    s_mul_i32 s24, s13, 401408
    s_mul_i32 s25, s12, 100352
    s_add_u32 s25, s25, s24
    s_mov_b32 s27, 106181136
    s_cmp_eq_u32 s12, 1
    s_cselect_b32 s27, 101733426, s27
    s_cmp_eq_u32 s12, 2
    s_cselect_b32 s27, 103944276, s27
    s_cmp_eq_u32 s12, 3
    s_cselect_b32 s27, 22295046, s27
    s_bfe_u32 s26, s27, 262144
    s_lshl_b32 s26, s26, 11
    s_add_u32 s26, s26, s25
    s_add_u32 s26, s26, 14336
    s_add_u32 s26, s26, 14336
    s_add_u32 s26, s26, 14336
    s_add_u32 s26, s26, 14336
    buffer_load_dwordx4 a[224:227], v101, s[4:7], s26 offen sc1
    buffer_load_dwordx4 a[228:231], v101, s[4:7], s26 offen offset:1024 sc1
    s_add_u32 s26, s26, 14336
    buffer_load_dwordx4 v[144:147], v101, s[4:7], s26 offen sc1
    buffer_load_dwordx4 v[148:151], v101, s[4:7], s26 offen offset:1024 sc1
    s_add_u32 s26, s26, 14336
    buffer_load_dwordx4 v[200:203], v101, s[4:7], s26 offen sc1
    buffer_load_dwordx4 v[204:207], v101, s[4:7], s26 offen offset:1024 sc1
    s_bfe_u32 s26, s27, 262148
    s_lshl_b32 s26, s26, 11
    s_add_u32 s26, s26, s25
    s_add_u32 s26, s26, 14336
    s_add_u32 s26, s26, 14336
    s_add_u32 s26, s26, 14336
    s_add_u32 s26, s26, 14336
    buffer_load_dwordx4 a[232:235], v101, s[4:7], s26 offen sc1
    buffer_load_dwordx4 a[236:239], v101, s[4:7], s26 offen offset:1024 sc1
    s_add_u32 s26, s26, 14336
    buffer_load_dwordx4 v[152:155], v101, s[4:7], s26 offen sc1
    buffer_load_dwordx4 v[156:159], v101, s[4:7], s26 offen offset:1024 sc1
    s_add_u32 s26, s26, 14336
    buffer_load_dwordx4 v[208:211], v101, s[4:7], s26 offen sc1
    buffer_load_dwordx4 v[212:215], v101, s[4:7], s26 offen offset:1024 sc1
    s_bfe_u32 s26, s27, 262152
    s_lshl_b32 s24, s26, 10
    v_add_u32 v103, s24, v101
    s_lshl_b32 s26, s26, 11
    s_add_u32 s26, s26, s25
    s_add_u32 s26, s26, 14336
    s_add_u32 s26, s26, 14336
    s_add_u32 s26, s26, 14336
    s_add_u32 s26, s26, 14336
    buffer_load_dwordx4 a[240:243], v101, s[4:7], s26 offen sc1
    buffer_load_dwordx4 a[244:247], v101, s[4:7], s26 offen offset:1024 sc1
    s_add_u32 s26, s26, 14336
    buffer_load_dwordx4 v[160:163], v101, s[4:7], s26 offen sc1
    buffer_load_dwordx4 v[164:167], v101, s[4:7], s26 offen offset:1024 sc1
    s_add_u32 s26, s26, 14336
    buffer_load_dwordx4 v[216:219], v101, s[4:7], s26 offen sc1
    buffer_load_dwordx4 v[220:223], v101, s[4:7], s26 offen offset:1024 sc1
    s_bfe_u32 s26, s27, 262156
    s_lshl_b32 s26, s26, 11
    s_add_u32 s26, s26, s25
    s_add_u32 s26, s26, 14336
    s_add_u32 s26, s26, 14336
    s_add_u32 s26, s26, 14336
    s_add_u32 s26, s26, 14336
    buffer_load_dwordx4 a[248:251], v101, s[4:7], s26 offen sc1
    buffer_load_dwordx4 a[252:255], v101, s[4:7], s26 offen offset:1024 sc1
    s_add_u32 s26, s26, 14336
    buffer_load_dwordx4 v[168:171], v101, s[4:7], s26 offen sc1
    buffer_load_dwordx4 v[172:175], v101, s[4:7], s26 offen offset:1024 sc1
    s_add_u32 s26, s26, 14336
    buffer_load_dwordx4 v[224:227], v101, s[4:7], s26 offen sc1
    buffer_load_dwordx4 v[228:231], v101, s[4:7], s26 offen offset:1024 sc1
    s_bfe_u32 s26, s27, 262160
    s_lshl_b32 s24, s26, 10
    v_add_u32 v104, s24, v101
    s_lshl_b32 s26, s26, 11
    s_add_u32 s26, s26, s25
    s_add_u32 s26, s26, 14336
    s_add_u32 s26, s26, 14336
    s_add_u32 s26, s26, 14336
    s_add_u32 s26, s26, 14336
    buffer_load_dwordx4 v[120:123], v101, s[4:7], s26 offen sc1
    buffer_load_dwordx4 v[124:127], v101, s[4:7], s26 offen offset:1024 sc1
    s_add_u32 s26, s26, 14336
    buffer_load_dwordx4 v[176:179], v101, s[4:7], s26 offen sc1
    buffer_load_dwordx4 v[180:183], v101, s[4:7], s26 offen offset:1024 sc1
    s_add_u32 s26, s26, 14336
    buffer_load_dwordx4 v[232:235], v101, s[4:7], s26 offen sc1
    buffer_load_dwordx4 v[236:239], v101, s[4:7], s26 offen offset:1024 sc1
    s_bfe_u32 s26, s27, 262164
    s_lshl_b32 s26, s26, 11
    s_add_u32 s26, s26, s25
    s_add_u32 s26, s26, 14336
    s_add_u32 s26, s26, 14336
    s_add_u32 s26, s26, 14336
    s_add_u32 s26, s26, 14336
    buffer_load_dwordx4 v[128:131], v101, s[4:7], s26 offen sc1
    buffer_load_dwordx4 v[132:135], v101, s[4:7], s26 offen offset:1024 sc1
    s_add_u32 s26, s26, 14336
    buffer_load_dwordx4 v[184:187], v101, s[4:7], s26 offen sc1
    buffer_load_dwordx4 v[188:191], v101, s[4:7], s26 offen offset:1024 sc1
    s_add_u32 s26, s26, 14336
    buffer_load_dwordx4 v[240:243], v101, s[4:7], s26 offen sc1
    buffer_load_dwordx4 v[244:247], v101, s[4:7], s26 offen offset:1024 sc1
    s_bfe_u32 s26, s27, 262168
    s_lshl_b32 s24, s26, 10
    v_add_u32 v105, s24, v101
    s_lshl_b32 s26, s26, 11
    s_add_u32 s26, s26, s25
    s_add_u32 s26, s26, 14336
    s_add_u32 s26, s26, 14336
    s_add_u32 s26, s26, 14336
    s_add_u32 s26, s26, 14336
    buffer_load_dwordx4 v[136:139], v101, s[4:7], s26 offen sc1
    buffer_load_dwordx4 v[140:143], v101, s[4:7], s26 offen offset:1024 sc1
    s_add_u32 s26, s26, 14336
    buffer_load_dwordx4 v[192:195], v101, s[4:7], s26 offen sc1
    buffer_load_dwordx4 v[196:199], v101, s[4:7], s26 offen offset:1024 sc1
    s_add_u32 s26, s26, 14336
    buffer_load_dwordx4 v[248:251], v101, s[4:7], s26 offen sc1
    buffer_load_dwordx4 v[252:255], v101, s[4:7], s26 offen offset:1024 sc1
    s_lshl_b32 s24, s12, 11
    s_add_u32 s25, s24, 8192
    v_lshrrev_b32 v6, 3, v21
    v_and_b32 v7, 3, v21
    v_lshl_add_u32 v6, v6, 2, v7
    v_lshlrev_b32 v106, 5, v6
    v_lshl_add_u32 v106, v22, 3, v106
    v_and_b32 v6, 4, v21
    v_add_u32 v106, v6, v106
    v_add_u32 v106, s25, v106
    v_lshlrev_b32 v107, 8, v22
    v_lshl_add_u32 v107, v21, 3, v107
    v_add_u32 v107, s25, v107
    s_mul_i32 s26, s12, 1792
    v_and_b32 v7, 1, v21
    v_lshrrev_b32 v6, 1, v22
    v_lshlrev_b32 v108, 8, v6
    v_bfe_u32 v6, v21, 1, 2
    v_lshl_add_u32 v6, v6, 2, v7
    v_lshl_add_u32 v108, v6, 4, v108
    v_and_b32 v6, 1, v22
    v_lshl_add_u32 v108, v6, 3, v108
    v_add_u32 v108, s26, v108
    v_bfe_u32 v6, v21, 1, 2
    v_lshl_add_u32 v6, v6, 2, v7
    v_lshlrev_b32 v117, 4, v6
    v_lshl_add_u32 v117, v22, 2, v117
    s_add_u32 s26, s26, 1536
    v_add_u32 v117, s26, v117
    s_lshr_b32 s25, s12, 1
    s_lshl_b32 s25, s25, 12
    s_and_b32 s26, s12, 1
    s_lshl_b32 s26, s26, 3
    s_add_u32 s25, s25, s26
    s_add_u32 s25, s25, 16384
    v_lshlrev_b32 v6, 10, v22
    v_add_u32 v6, s25, v6
    v_lshl_add_u32 v109, v21, 4, v6
    v_and_b32 v9, 8, v21
    v_xor_b32 v109, v9, v109
    v_lshrrev_b32 v9, 1, v21
    v_lshl_add_u32 v110, v9, 4, v6
    v_lshl_add_u32 v110, v7, 2, v110
    v_add_u32 v110, 256, v110
    v_and_b32 v8, 8, v5
    v_and_b32 v6, 3, v5
    v_lshl_add_u32 v8, v6, 1, v8
    v_bfe_u32 v6, v5, 2, 1
    v_add_u32 v8, v8, v6
    v_cmp_gt_u32 vcc, 16, v5
    s_nop 1
    v_cndmask_b32 v8, v5, v8, vcc
    v_mov_b32 v9, 28
    v_cmp_gt_u32 s[22:23], 20, v5
    s_nop 1
    v_cndmask_b32 v8, v9, v8, s[22:23]
    v_lshlrev_b32 v111, 9, v4
    v_lshl_add_u32 v111, v8, 4, v111
    s_lshl_b32 s25, s12, 10
    s_add_u32 s25, s25, 16384
    v_add_u32 v111, s25, v111
    v_bfe_u32 v7, v5, 3, 1
    v_lshlrev_b32 v7, 8, v7
    v_lshl_add_u32 v7, v6, 5, v7
    s_lshl_b32 s25, s12, 6
    v_add_u32 v7, s25, v7
    s_lshl_b32 s25, s12, 5
    s_add_u32 s25, s25, 512
    v_mov_b32 v9, s25
    v_cndmask_b32 v112, v9, v7, vcc
    v_lshl_add_u32 v112, v4, 4, v112
    v_and_b32 v6, 3, v5
    v_lshl_add_u32 v112, v6, 2, v112
    s_mul_i32 s25, s13, 640
    v_add_u32 v112, s25, v112
    v_mov_b32 v8, 1073741824
    v_cndmask_b32 v112, v8, v112, s[22:23]
    s_nop 0
    s_mul_i32 s25, s12, 14
    v_add_u32 v6, s25, v22
    v_lshrrev_b32 v7, 2, v6
    v_lshlrev_b32 v115, 10, v7
    v_lshl_add_u32 v115, v21, 6, v115
    v_and_b32 v6, 3, v6
    v_lshrrev_b32 v7, 3, v21
    v_lshlrev_b32 v7, 1, v7
    v_xor_b32 v6, v6, v7
    v_lshl_add_u32 v115, v6, 4, v115
    v_add_u32 v115, 65536, v115
    v_mov_b32 v12, 0
    v_mov_b32 v13, 0
    v_mov_b32 v14, 0
    v_mov_b32 v15, 0
    v_add_u32 v6, 94208, v101
    ds_write_b128 v6, v[12:15]
    ds_write_b128 v6, v[12:15] offset:32768
    s_mul_i32 s25, s12, 14
    s_add_u32 s25, s25, 12
    v_lshrrev_b32 v6, 1, v22
    v_add_u32 v6, s25, v6
    v_lshrrev_b32 v9, 2, v6
    v_lshlrev_b32 v116, 10, v9
    v_lshl_add_u32 v116, v21, 6, v116
    v_and_b32 v6, 3, v6
    v_xor_b32 v6, v6, v7
    v_lshl_add_u32 v116, v6, 4, v116
    v_and_b32 v6, 1, v22
    v_lshl_add_u32 v116, v6, 3, v116
    v_add_u32 v116, 65536, v116
    v_lshlrev_b32 v6, 2, v22
    v_sub_u32 v6, v21, v6
    v_mov_b32 v9, 0x3f80
    v_mov_b32 v10, 0x3f800000
    v_lshlrev_b32 v114, 3, v101
    v_min_u32 v114, 6016, v114
    v_cmp_eq_u32 vcc, 0, v6
    s_nop 1
    v_cndmask_b32 v78, 0, v9, vcc
    v_cmp_eq_u32 vcc, 1, v6
    s_nop 1
    v_cndmask_b32 v78, v78, v10, vcc
    v_cmp_eq_u32 vcc, 2, v6
    s_nop 1
    v_cndmask_b32 v79, 0, v9, vcc
    v_cmp_eq_u32 vcc, 3, v6
    s_nop 1
    v_cndmask_b32 v79, v79, v10, vcc
    v_mov_b32 v6, 0
    ds_write_b32 v106, v6 offset:1792
    ds_write_b32 v106, v6 offset:1536
    v_mov_b32 v8, 0xf0000000
    v_mov_b32 v9, v8
    v_lshlrev_b32 v6, 9, v21
    v_add_u32 v6, 16832, v6
    ds_write2_b64 v6, v[8:9], v[8:9] offset0:0 offset1:1
    s_mov_b32 s21, 0x42200000
    s_mov_b32 s34, 1035512379
    s_mov_b32 s35, 1035512379
    s_mov_b32 s30, 50339840
    s_lshl_b32 s29, s13, 15
    s_lshl_b32 s25, s12, 13
    s_add_u32 s29, s29, s25
    s_add_u32 s29, s29, 17825792
    v_mov_b32 v12, -1
    v_mov_b32 v13, -1
    v_mov_b32 v14, -1
    v_mov_b32 v15, -1
    s_mov_b64 exec, s[22:23]
    ds_write_b128 v111, v[12:15]
    ds_write_b128 v111, v[12:15] offset:4096
    s_mov_b64 exec, -1
    s_mov_b32 s20, 0x20000
    s_branch L_cme_39
L_cm_37:
    v_mov_b32 v17, 0
    global_load_dwordx2 v[18:19], v17, s[40:41] offset:0 sc1
L_cme_39:
    s_waitcnt vmcnt(0)
    v_readfirstlane_b32 s24, v18
    v_readfirstlane_b32 s26, v19
    s_and_b32 s25, s24, 255
    s_add_u32 s25, s25, s26
    s_cmp_ge_u32 s25, 48
    s_cbranch_scc1 L_cmd_38
    s_sleep 2
    s_sub_u32 s20, s20, 1
    s_cbranch_scc0 L_cm_37
    s_branch L_fin
L_cmd_38:
    s_lshl_b32 s25, s46, 5
    s_cmp_lg_u32 s24, s25
    s_cselect_b32 s46, 1, 0
    s_cmp_lg_u32 s12, 0
    s_cbranch_scc1 L_go_40
    v_mov_b32 v10, 0
    v_mov_b32 v11, 1
    s_mov_b64 exec, 1
    global_atomic_add v10, v11, s[40:41] offset:136
    s_mov_b64 exec, -1
L_go_40:
    s_lshl_b32 s24, s12, 11
    s_add_u32 s15, s24, 50331648
    s_add_u32 s16, s15, 1024
    s_cmp_eq_u32 s12, 3
    s_cselect_b32 s16, 50331648, s16
    s_mov_b32 s14, 0
    s_mov_b32 s24, 50339840
    s_mov_b32 s25, 1073741824
    s_cmp_eq_u32 s46, 0
    s_cselect_b32 s44, s24, s25
    s_cselect_b32 s45, s25, s24
    s_add_u32 s28, s15, 20480
    s_add_u32 s18, s16, 20480
    s_barrier
L_Stop_41:
    ds_read_b128 v[56:59], v115 offset:0
    ds_read_b128 v[60:63], v115 offset:1024
    ds_read_b128 v[64:67], v115 offset:14336
    ds_read_b128 v[68:71], v115 offset:15360
    ds_read_b128 v[72:75], v115 offset:2048
    ds_read_b64 v[76:77], v116 offset:0
    ds_read_b128 v[80:83], v115 offset:16384
    ds_read_b64 v[84:85], v116 offset:14336
    v_xor_b32 v115, 0x8000, v115
    v_xor_b32 v116, 0x8000, v116
    v_mov_b32 v28, 0
    v_mov_b32 v29, 0
    v_mov_b32 v30, 0
    v_mov_b32 v31, 0
    v_mov_b32 v32, 0
    v_mov_b32 v33, 0
    v_mov_b32 v34, 0
    v_mov_b32 v35, 0
    v_mov_b32 v36, 0
    v_mov_b32 v37, 0
    v_mov_b32 v38, 0
    v_mov_b32 v39, 0
    v_mov_b32 v40, 0
    v_mov_b32 v41, 0
    v_mov_b32 v42, 0
    v_mov_b32 v43, 0
    v_mov_b32 v44, 0
    v_mov_b32 v45, 0
    v_mov_b32 v46, 0
    v_mov_b32 v47, 0
    v_mov_b32 v48, 0
    v_mov_b32 v49, 0
    v_mov_b32 v50, 0
    v_mov_b32 v51, 0
    v_mov_b32 v52, 0
    v_mov_b32 v53, 0
    v_mov_b32 v54, 0
    v_mov_b32 v55, 0
    v_mov_b32 v88, 0
    v_mov_b32 v89, 0
    v_mov_b32 v90, 0
    v_mov_b32 v91, 0
    v_mov_b32 v92, 0
    v_mov_b32 v93, 0
    v_mov_b32 v94, 0
    v_mov_b32 v95, 0
    v_mov_b32 v96, 0
    v_mov_b32 v97, 0
    v_mov_b32 v98, 0
    v_mov_b32 v99, 0
    s_add_u32 m0, s31, 960
    s_nop 0
    buffer_load_dwordx4 v113, s[8:11], s17 offen offset:64 lds
    s_add_u32 m0, s31, 1920
    s_nop 0
    buffer_load_dwordx4 v113, s[8:11], s17 offen offset:128 lds
    s_add_u32 m0, s31, 2880
    s_nop 0
    buffer_load_dwordx4 v113, s[8:11], s17 offen offset:192 lds
    s_add_u32 m0, s31, 3840
    s_nop 0
    buffer_load_dwordx4 v113, s[8:11], s17 offen offset:256 lds
    s_add_u32 m0, s31, 4800
    s_nop 0
    buffer_load_dwordx4 v113, s[8:11], s17 offen offset:320 lds
    s_add_u32 m0, s31, 5760
    s_nop 0
    buffer_load_dwordx4 v113, s[8:11], s17 offen offset:384 lds
    s_waitcnt lgkmcnt(0)
    v_swap_b32 v57, v58
    v_swap_b32 v61, v62
    v_swap_b32 v65, v66
    v_swap_b32 v69, v70
    v_swap_b32 v73, v74
    v_swap_b32 v81, v82
    s_add_u32 s17, s17, 28672
    s_xor_b32 s31, s31, 0x8000
    s_mov_b32 s20, 0x40000
    buffer_load_dwordx4 v[0:3], v101, s[4:7], s15 offen sc1
    buffer_load_dwordx4 v[4:7], v101, s[4:7], s16 offen sc1
    v_mov_b32 v119, v119
    s_nop 2
    v_mov_b32 v119, v119
    s_nop 2
    v_mov_b32 v119, v119
    s_nop 2
    v_mov_b32 v119, v119
    s_nop 2
    v_mov_b32 v119, v119
    s_nop 2
    v_mov_b32 v119, v119
    s_nop 2
L_mp_46:
    buffer_load_dwordx4 v[0:3], v101, s[4:7], s15 offen sc1
    buffer_load_dwordx4 v[4:7], v101, s[4:7], s16 offen sc1
    s_sub_u32 s20, s20, 1
    s_cbranch_scc1 L_fin
    s_cmp_eq_u32 s13, 0
    s_waitcnt vmcnt(3)
    v_max3_u32 v118, v0, v1, v2
    v_max_u32 v118, v118, v3
    s_waitcnt vmcnt(2)
    v_max3_u32 v118, v118, v4, v5
    v_max3_u32 v118, v118, v6, v7
    v_cmp_eq_u32 vcc, -1, v118
    ds_write_b128 v102, v[0:3]
    s_cbranch_vccnz L_mp_46
    v_smfmac_f32_16x16x64_bf16 v[28:31], v[0:3], a[0:7], v100
    ds_write_b128 v102, v[4:7] offset:1024
    v_smfmac_f32_16x16x64_bf16 v[32:35], v[0:3], a[56:63], v100
    v_smfmac_f32_16x16x64_bf16 v[36:39], v[0:3], a[112:119], v100
    v_smfmac_f32_16x16x64_bf16 v[40:43], v[0:3], a[168:175], v100
    s_cbranch_scc1 L_Spub_44
L_Spr_45:
    v_smfmac_f32_16x16x64_bf16 v[44:47], v[0:3], a[224:231], v100
    v_smfmac_f32_16x16x64_bf16 v[48:51], v[0:3], v[144:151], v100
    v_smfmac_f32_16x16x64_bf16 v[52:55], v[0:3], v[200:207], v100
    v_smfmac_f32_16x16x64_bf16 v[28:31], v[4:7], a[8:15], v100
    s_waitcnt lgkmcnt(0)
    s_barrier
    ds_read_b128 v[8:11], v103
    ds_read_b128 v[12:15], v103 offset:1024
    v_smfmac_f32_16x16x64_bf16 v[32:35], v[4:7], a[64:71], v100
    ds_read_b128 v[16:19], v104
    v_smfmac_f32_16x16x64_bf16 v[36:39], v[4:7], a[120:127], v100
    ds_read_b128 v[20:23], v104 offset:1024
    v_smfmac_f32_16x16x64_bf16 v[40:43], v[4:7], a[176:183], v100
    ds_read_b128 v[24:27], v105
    v_smfmac_f32_16x16x64_bf16 v[44:47], v[4:7], a[232:239], v100
    v_smfmac_f32_16x16x64_bf16 v[48:51], v[4:7], v[152:159], v100
    v_smfmac_f32_16x16x64_bf16 v[52:55], v[4:7], v[208:215], v100
    buffer_load_dword v119, v114, s[4:7], s29 offen sc1
    s_waitcnt lgkmcnt(4)
    v_smfmac_f32_16x16x64_bf16 v[28:31], v[8:11], a[16:23], v100
    s_waitcnt lgkmcnt(3)
    v_smfmac_f32_16x16x64_bf16 v[28:31], v[12:15], a[24:31], v100
    s_waitcnt lgkmcnt(2)
    v_smfmac_f32_16x16x64_bf16 v[28:31], v[16:19], a[32:39], v100
    s_waitcnt lgkmcnt(1)
    v_smfmac_f32_16x16x64_bf16 v[28:31], v[20:23], a[40:47], v100
    s_waitcnt lgkmcnt(0)
    v_smfmac_f32_16x16x64_bf16 v[28:31], v[24:27], a[48:55], v100
    v_smfmac_f32_16x16x64_bf16 v[32:35], v[8:11], a[72:79], v100
    v_smfmac_f32_16x16x64_bf16 v[32:35], v[12:15], a[80:87], v100
    v_add_f32 v28, v28, v30
    v_smfmac_f32_16x16x64_bf16 v[32:35], v[16:19], a[88:95], v100
    v_add_f32 v29, v29, v31
    v_smfmac_f32_16x16x64_bf16 v[32:35], v[20:23], a[96:103], v100
    v_cvt_pk_bf16_f32 v28, v28, v29
    v_smfmac_f32_16x16x64_bf16 v[32:35], v[24:27], a[104:111], v100
    ds_write_b32 v106, v28 offset:0
    v_smfmac_f32_16x16x64_bf16 v[36:39], v[8:11], a[128:135], v100
    ds_read2_b32 v[86:87], v117 offset0:0 offset1:8
    v_smfmac_f32_16x16x64_bf16 v[36:39], v[12:15], a[136:143], v100
    v_add_f32 v32, v32, v34
    v_add_f32 v33, v33, v35
    v_smfmac_f32_16x16x64_bf16 v[36:39], v[16:19], a[144:151], v100
    v_cvt_pk_bf16_f32 v32, v32, v33
    v_smfmac_f32_16x16x64_bf16 v[36:39], v[20:23], a[152:159], v100
    ds_write_b32 v106, v32 offset:256
    v_smfmac_f32_16x16x64_bf16 v[36:39], v[24:27], a[160:167], v100
    ds_read2_b64 v[28:31], v108 offset0:0 offset1:4
    v_smfmac_f32_16x16x64_bf16 v[40:43], v[8:11], a[184:191], v100
    ds_read2_b64 v[32:35], v108 offset0:64 offset1:68
    v_smfmac_f32_16x16x64_bf16 v[40:43], v[12:15], a[192:199], v100
    v_add_f32 v36, v36, v38
    v_smfmac_f32_16x16x64_bf16 v[40:43], v[16:19], a[200:207], v100
    v_add_f32 v37, v37, v39
    v_smfmac_f32_16x16x64_bf16 v[40:43], v[20:23], a[208:215], v100
    v_cvt_pk_bf16_f32 v36, v36, v37
    v_smfmac_f32_16x16x64_bf16 v[40:43], v[24:27], a[216:223], v100
    ds_write_b32 v106, v36 offset:512
    v_smfmac_f32_16x16x64_bf16 v[44:47], v[8:11], a[240:247], v100
    v_smfmac_f32_16x16x64_bf16 v[44:47], v[12:15], a[248:255], v100
    v_add_f32 v40, v40, v42
    v_add_f32 v41, v41, v43
    v_smfmac_f32_16x16x64_bf16 v[44:47], v[16:19], v[120:127], v100
    v_cvt_pk_bf16_f32 v40, v40, v41
    v_smfmac_f32_16x16x64_bf16 v[44:47], v[20:23], v[128:135], v100
    ds_write_b32 v106, v40 offset:768
    v_smfmac_f32_16x16x64_bf16 v[44:47], v[24:27], v[136:143], v100
    ds_read2_b64 v[36:39], v108 offset0:128 offset1:132
    v_smfmac_f32_16x16x64_bf16 v[48:51], v[8:11], v[160:167], v100
    ds_read2_b64 v[40:43], v108 offset0:192 offset1:196
    v_smfmac_f32_16x16x64_bf16 v[48:51], v[12:15], v[168:175], v100
    v_add_f32 v44, v44, v46
    v_add_f32 v45, v45, v47
    v_smfmac_f32_16x16x64_bf16 v[48:51], v[16:19], v[176:183], v100
    v_cvt_pk_bf16_f32 v44, v44, v45
    v_smfmac_f32_16x16x64_bf16 v[48:51], v[20:23], v[184:191], v100
    ds_write_b32 v106, v44 offset:1024
    v_smfmac_f32_16x16x64_bf16 v[48:51], v[24:27], v[192:199], v100
    ds_read_b64_tr_b16 v[44:45], v107 offset:0
    v_smfmac_f32_16x16x64_bf16 v[52:55], v[8:11], v[216:223], v100
    ds_read_b64_tr_b16 v[46:47], v107 offset:128
    v_smfmac_f32_16x16x64_bf16 v[52:55], v[12:15], v[224:231], v100
    v_add_f32 v48, v48, v50
    v_add_f32 v49, v49, v51
    v_smfmac_f32_16x16x64_bf16 v[52:55], v[16:19], v[232:239], v100
    v_cvt_pk_bf16_f32 v48, v48, v49
    v_smfmac_f32_16x16x64_bf16 v[52:55], v[20:23], v[240:247], v100
    ds_write_b32 v106, v48 offset:1280
    v_smfmac_f32_16x16x64_bf16 v[52:55], v[24:27], v[248:255], v100
    ds_read_b64_tr_b16 v[48:49], v107 offset:1024
    ds_read_b64_tr_b16 v[50:51], v107 offset:1152
    s_waitcnt lgkmcnt(3)
    v_smfmac_f32_16x16x64_bf16 v[88:91], v[44:47], v[56:63], v100
    v_smfmac_f32_16x16x64_bf16 v[92:95], v[44:47], v[64:71], v100
    v_cvt_pk_bf16_f32 v52, v52, v53
    v_cvt_pk_bf16_f32 v53, v54, v55
    v_smfmac_f32_16x16x64_bf16 v[96:99], v[44:47], v[28:35], v100
    s_nop 0
    v_mfma_f32_16x16x16_bf16 v[8:11], v[52:53], v[78:79], 0
    s_waitcnt lgkmcnt(0)
    v_smfmac_f32_16x16x64_bf16 v[96:99], v[48:51], v[36:43], v100
    v_smfmac_f32_16x16x64_bf16 v[88:91], v[48:51], v[72:79], v100
    v_cvt_pk_bf16_f32 v8, v8, v9
    v_cvt_pk_bf16_f32 v9, v10, v11
    v_smfmac_f32_16x16x64_bf16 v[92:95], v[48:51], v[80:87], v100
    s_nop 0
    v_mfma_f32_16x16x16_bf16 v[96:99], v[8:9], v[86:87], v[96:99]
    v_mfma_f32_16x16x16_bf16 v[88:91], v[8:9], v[76:77], v[88:91]
    v_mfma_f32_16x16x16_bf16 v[92:95], v[8:9], v[84:85], v[92:95]
    v_add_f32 v96, v96, v98
    v_add_f32 v97, v97, v99
    ds_write2_b32 v110, v96, v97 offset0:0 offset1:128
    s_nop 0
    v_add_f32 v28, v88, v90
    v_add_f32 v30, v89, v91
    s_nop 1
    v_add_f32 v29, v92, v94
    v_add_f32 v31, v93, v95
    ds_write2_b64 v109, v[28:29], v[30:31] offset0:0 offset1:64
    s_barrier
L_Sagain_48:
    ds_read_b128 v[34:37], v111
    ds_read_b128 v[38:41], v111 offset:4096
    s_add_u32 m0, s31, 0
    v_mov_b32 v119, v119
    buffer_load_dwordx4 v113, s[8:11], s17 offen offset:0 lds
    v_mov_b32 v119, v119
    s_nop 2
    s_waitcnt lgkmcnt(1)
    v_pk_add_f32 v[32:33], v[34:35], v[36:37]
    v_pk_mul_f32 v[32:33], v[32:33], s[34:35]
    s_waitcnt lgkmcnt(0)
    v_pk_add_f32 v[42:43], v[38:39], v[40:41]
    v_pk_fma_f32 v[32:33], v[42:43], s[34:35], v[32:33]
    v_exp_f32 v44, v32
    v_exp_f32 v45, v33
    v_add_f32 v48, |v32|, |v33|
    v_add_f32 v46, v44, v45
    v_cmp_nge_f32 vcc, s21, v48
    s_nop 0
    v_add_f32_dpp v46, v46, v46 quad_perm:[1,0,3,2] row_mask:0xf bank_mask:0xf
    s_nop 1
    v_add_f32_dpp v46, v46, v46 quad_perm:[2,3,0,1] row_mask:0xf bank_mask:0xf
    s_nop 1
    v_add_f32_dpp v46, v46, v46 row_half_mirror row_mask:0xf bank_mask:0xf
    s_and_b64 vcc, vcc, s[22:23]
    s_cbranch_scc1 L_Sslow_42
    v_add_f32_dpp v46, v46, v46 row_mirror row_mask:0xf bank_mask:0xf
    v_mov_b32 v47, v46
    s_nop 1
    v_permlane16_swap_b32 v46, v47
    v_add_f32 v46, v46, v47
L_Sback_43:
    v_rcp_f32 v46, v46
    s_nop 0
    v_mul_f32 v44, v44, v46
    v_mul_f32 v45, v45, v46
    v_cvt_pk_bf16_f32 v44, |v44|, |v45|
    buffer_store_dword v44, v112, s[4:7], s44 offen
    buffer_store_dword v44, v112, s[4:7], s45 offen sc1
    v_mov_b32 v32, -1
    v_mov_b32 v33, -1
    v_mov_b32 v34, -1
    v_mov_b32 v35, -1
    s_mov_b64 exec, s[22:23]
    ds_write_b128 v111, v[32:35]
    ds_write_b128 v111, v[32:35] offset:4096
    s_mov_b64 exec, -1
    s_barrier
    s_add_u32 s15, s15, 69632
    s_add_u32 s16, s16, 69632
    s_add_u32 s30, s30, 69632
    s_add_u32 s44, s44, 69632
    s_add_u32 s45, s45, 69632
    s_add_u32 s28, s28, 69632
    s_add_u32 s18, s18, 69632
    s_add_u32 s29, s29, 524288
    s_add_u32 s14, s14, 1
    s_cmp_lt_u32 s14, 63
    s_cbranch_scc1 L_Stop_41
    s_cmp_ge_u32 s13, 1
    s_cbranch_scc1 L_fin
    s_mov_b32 s20, 0x20000
L_ps_49:
    buffer_load_dwordx4 v[0:3], v101, s[4:7], s15 offen sc1
    buffer_load_dwordx4 v[4:7], v101, s[4:7], s16 offen sc1
    s_waitcnt vmcnt(0)
    v_max_u32 v8, v0, v1
    v_max3_u32 v8, v8, v2, v3
    v_max3_u32 v8, v8, v4, v5
    v_max3_u32 v8, v8, v6, v7
    v_cmp_eq_u32 vcc, -1, v8
    s_cbranch_vccz L_psd_50
    s_sleep 0
    s_sub_u32 s20, s20, 1
    s_cbranch_scc0 L_ps_49
    s_branch L_fin
L_psd_50:
    buffer_store_dwordx4 v[0:3], v101, s[4:7], s28 offen sc1
    buffer_store_dwordx4 v[4:7], v101, s[4:7], s18 offen sc1
    s_branch L_fin
L_Sslow_42:
    s_add_u32 s70, s70, 1
    v_max3_u32 v42, v34, v35, v36
    v_max3_u32 v42, v42, v37, v38
    v_max3_u32 v42, v42, v39, v40
    v_max_u32 v42, v42, v41
    v_cmp_eq_u32 vcc, -1, v42
    s_sub_u32 s20, s20, 1
    s_cbranch_scc1 L_fin
    s_and_b64 vcc, vcc, s[22:23]
    s_cbranch_scc1 L_Sagain_48
    v_max_f32 v46, v32, v33
    s_nop 1
    v_max_f32_dpp v46, v46, v46 quad_perm:[1,0,3,2] row_mask:0xf bank_mask:0xf
    s_nop 1
    v_max_f32_dpp v46, v46, v46 quad_perm:[2,3,0,1] row_mask:0xf bank_mask:0xf
    s_nop 1
    v_max_f32_dpp v46, v46, v46 row_half_mirror row_mask:0xf bank_mask:0xf
    s_nop 1
    v_max_f32_dpp v46, v46, v46 row_mirror row_mask:0xf bank_mask:0xf
    v_mov_b32 v47, v46
    s_nop 1
    v_permlane16_swap_b32 v46, v47
    v_max_f32 v46, v46, v47
    v_sub_f32 v32, v32, v46
    v_sub_f32 v33, v33, v46
    v_exp_f32 v44, v32
    v_exp_f32 v45, v33
    s_nop 0
    v_add_f32 v46, v44, v45
    s_nop 1
    v_add_f32_dpp v46, v46, v46 quad_perm:[1,0,3,2] row_mask:0xf bank_mask:0xf
    s_nop 1
    v_add_f32_dpp v46, v46, v46 quad_perm:[2,3,0,1] row_mask:0xf bank_mask:0xf
    s_nop 1
    v_add_f32_dpp v46, v46, v46 row_half_mirror row_mask:0xf bank_mask:0xf
    s_nop 1
    v_add_f32_dpp v46, v46, v46 row_mirror row_mask:0xf bank_mask:0xf
    v_mov_b32 v47, v46
    s_nop 1
    v_permlane16_swap_b32 v46, v47
    v_add_f32 v46, v46, v47
    s_branch L_Sback_43
L_Spub_44:
    buffer_store_dwordx4 v[0:3], v101, s[4:7], s28 offen sc1
    buffer_store_dwordx4 v[4:7], v101, s[4:7], s18 offen sc1
    s_branch L_Spr_45
L_V:
    v_and_b32 v20, 63, v119
    v_and_b32 v21, 15, v119
    v_bfe_u32 v22, v119, 4, 2
    s_load_dwordx2 s[32:33], s[0:1], 48
    s_load_dwordx2 s[36:37], s[0:1], 56
    s_mov_b32 s34, 3670016
    s_mov_b32 s35, 0x20000
    s_mov_b32 s38, 3670016
    s_mov_b32 s39, 0x20000
    s_and_b32 s14, s13, 15
    s_mul_i32 s24, s3, s3
    s_lshl_b32 s24, s24, 16
    s_lshl_b32 s46, s3, 8
    s_add_u32 s46, s46, s24
    s_add_u32 s46, s46, 1
    s_cmp_lg_u32 s12, 0
    s_cbranch_scc1 L_la0_51
    v_mov_b32 v6, 0
    v_mov_b32 v7, s46
    s_mov_b64 exec, 1
    global_atomic_add v6, v7, s[40:41] offset:0
    s_mov_b64 exec, -1
L_la0_51:
    v_lshrrev_b32 v6, 2, v20
    v_lshlrev_b32 v6, 13, v6
    v_and_b32 v7, 3, v20
    v_lshl_add_u32 v6, v7, 7, v6
    s_lshl_b32 s25, s14, 9
    s_mul_i32 s24, s12, 917504
    s_add_u32 s24, s24, s25
    s_add_u32 s24, s24, 262144
    s_add_u32 s26, s24, 131072
    s_lshl_b32 s27, s12, 17
    s_add_u32 s25, s25, s27
    s_add_u32 s25, s25, 262144
    s_waitcnt lgkmcnt(0)
    buffer_load_dword v116, v6, s[36:39], s24 offen
    buffer_load_dword v116, v6, s[36:39], s26 offen
    buffer_load_dword v116, v6, s[32:35], s25 offen
    s_add_u32 s25, s25, 524288
    buffer_load_dword v116, v6, s[32:35], s25 offen
    s_add_u32 s25, s25, 524288
    buffer_load_dword v116, v6, s[32:35], s25 offen
    s_add_u32 s25, s25, 524288
    buffer_load_dword v116, v6, s[32:35], s25 offen
    s_add_u32 s25, s25, 524288
    buffer_load_dword v116, v6, s[32:35], s25 offen
    s_add_u32 s25, s25, 524288
    v_lshlrev_b32 v6, 7, v20
    s_mul_i32 s24, s14, 3584
    v_min_u32 v6, 3456, v6
    buffer_load_dword v116, v6, s[8:11], s24 offen
    s_mov_b32 s20, 0x20000
    v_mov_b32 v10, 0
L_wd_52:
    global_load_dword v11, v10, s[40:41] offset:128 sc1
    s_waitcnt vmcnt(0)
    v_cmp_gt_u32 vcc, 1, v11
    s_cbranch_vccz L_wdd_53
    s_sleep 2
    s_sub_u32 s20, s20, 1
    s_cbranch_scc0 L_wd_52
    s_branch L_fin
L_wdd_53:
    v_and_b32 v20, 63, v119
    v_and_b32 v21, 15, v119
    v_bfe_u32 v22, v119, 4, 2
    v_lshlrev_b32 v101, 4, v20
    v_mov_b32 v100, 0x4444
    v_mov_b32 v1, 0xeeee
    v_and_b32 v2, 2, v21
    v_cmp_ne_u32 vcc, 0, v2
    s_nop 1
    v_cndmask_b32 v100, v100, v1, vcc
    s_lshl_b32 s24, s12, 11
    v_add_u32 v102, s24, v101
    v_lshrrev_b32 v4, 5, v20
    v_and_b32 v5, 31, v20
    s_lshl_b32 s24, s12, 11
    s_add_u32 s25, s24, 8192
    v_lshlrev_b32 v106, 4, v21
    v_lshl_add_u32 v106, v22, 2, v106
    v_add_u32 v106, s25, v106
    v_mul_u32_u24 v107, 448, v22
    v_lshl_add_u32 v107, v21, 4, v107
    v_add_u32 v107, s25, v107
    s_mul_i32 s25, s12, 2560
    v_mul_u32_u24 v6, 640, v22
    v_add_u32 v6, s25, v6
    v_lshl_add_u32 v108, v21, 4, v6
    v_lshrrev_b32 v7, 2, v21
    v_and_b32 v9, 1, v21
    v_lshl_add_u32 v7, v7, 1, v9
    v_lshl_add_u32 v110, v7, 4, v6
    v_mov_b32 v8, 1073741824
    v_and_b32 v9, 2, v21
    v_cmp_eq_u32 vcc, 0, v9
    s_nop 1
    v_cndmask_b32 v110, v8, v110, vcc
    s_lshr_b32 s25, s12, 1
    s_lshl_b32 s25, s25, 12
    s_and_b32 s26, s12, 1
    s_lshl_b32 s26, s26, 3
    s_add_u32 s25, s25, s26
    s_add_u32 s25, s25, 16384
    v_lshlrev_b32 v6, 10, v22
    v_add_u32 v6, s25, v6
    v_add_u32 v7, 26, v21
    v_cmp_gt_u32 vcc, 14, v21
    s_nop 1
    v_cndmask_b32 v7, v7, v21, vcc
    v_lshrrev_b32 v9, 1, v7
    v_lshl_add_u32 v109, v9, 4, v6
    v_and_b32 v9, 1, v7
    v_lshl_add_u32 v109, v9, 2, v109
    v_lshlrev_b32 v111, 9, v4
    v_lshl_add_u32 v111, v21, 4, v111
    s_lshl_b32 s25, s12, 10
    s_add_u32 s25, s25, 16384
    v_add_u32 v111, s25, v111
    s_sub_u32 s25, s13, 16
    s_mul_i32 s26, s25, 28
    v_lshlrev_b32 v6, 1, v5
    v_add_u32 v6, s26, v6
    v_lshrrev_b32 v7, 4, v6
    v_lshlrev_b32 v112, 8, v7
    v_and_b32 v9, 2, v6
    v_add_u32 v7, v9, v4
    v_lshl_add_u32 v112, v7, 4, v112
    v_and_b32 v7, 12, v6
    v_add_u32 v112, v7, v112
    s_lshl_b32 s26, s12, 6
    v_add_u32 v112, s26, v112
    v_cmp_gt_u32 vcc, 14, v5
    s_nop 1
    v_cndmask_b32 v112, v8, v112, vcc
    s_mov_b64 s[22:23], vcc
    s_lshl_b32 s18, s25, 15
    s_lshl_b32 s26, s12, 13
    s_add_u32 s18, s18, s26
    s_add_u32 s18, s18, 16777216
    s_add_u32 s19, s18, 4096
    s_mov_b32 s30, 50339840
    s_mov_b32 s28, 1073741824
    s_lshl_b32 s35, s25, 2
    s_add_u32 s35, s35, s12
    s_lshl_b32 s35, s35, 5
    s_add_u32 s35, s35, 59770880
    v_and_b32 v117, 7, v20
    v_lshlrev_b32 v117, 2, v117
    v_mov_b32 v116, 0
    s_mov_b32 s34, 0
    s_sub_u32 s27, s13, 16
    s_mov_b32 s17, 0
    s_mul_i32 s25, s27, 640
    s_add_u32 s25, s25, 139264
    v_lshlrev_b32 v6, 6, v20
    v_add_u32 v113, s25, v6
    s_mul_i32 s25, s27, 448
    s_add_u32 s25, s25, 200064
    v_add_u32 v7, s25, v6
    v_cmp_gt_u32 vcc, 10, v20
    s_nop 1
    v_cndmask_b32 v113, v7, v113, vcc
    v_cmp_gt_u32 vcc, 17, v119
    s_nop 1
    v_cndmask_b32 v113, v8, v113, vcc
    s_mul_i32 s25, s27, 1792
    s_add_u32 s25, s25, 86016
    s_mul_i32 s26, s12, 448
    s_add_u32 s25, s25, s26
    v_add_u32 v115, s25, v6
    v_cmp_gt_u32 vcc, 7, v20
    s_nop 1
    v_cndmask_b32 v115, v8, v115, vcc
    v_mov_b32 v12, -1
    v_mov_b32 v13, -1
    v_mov_b32 v14, -1
    v_mov_b32 v15, -1
    s_mov_b64 exec, s[22:23]
    ds_write_b128 v111, v[12:15]
    ds_write_b128 v111, v[12:15] offset:4096
    s_mov_b64 exec, -1
    s_cmp_lg_u32 s12, 0
    s_cbranch_scc1 L_w0_54
    s_mov_b32 s20, 0x20000
    v_lshlrev_b32 v14, 4, v20
    v_cmp_gt_u32 s[42:43], 56, v20
    s_mov_b32 s27, 59768832
L_wf_55:
    buffer_load_dwordx4 v[10:13], v14, s[4:7], s27 offen sc1
    s_waitcnt vmcnt(0)
    v_min3_u32 v10, v10, v11, v12
    v_min_u32 v10, v10, v13
    v_cmp_gt_u32 vcc, 1, v10
    s_nop 0
    s_and_b64 vcc, vcc, s[42:43]
    s_cbranch_scc0 L_wfd_56
    s_sleep 4
    s_sub_u32 s20, s20, 1
    s_cbranch_scc0 L_wf_55
    s_branch L_fin
L_wfd_56:
L_w0_54:
    s_barrier
    v_mov_b32 v17, 0
    global_load_dwordx2 v[18:19], v17, s[40:41] offset:0 sc1
    s_mul_i32 s24, s13, 401408
    s_mul_i32 s25, s12, 100352
    s_add_u32 s25, s25, s24
    s_mov_b32 s27, 106181136
    s_cmp_eq_u32 s12, 1
    s_cselect_b32 s27, 101733426, s27
    s_cmp_eq_u32 s12, 2
    s_cselect_b32 s27, 103944276, s27
    s_cmp_eq_u32 s12, 3
    s_cselect_b32 s27, 22295046, s27
    s_bfe_u32 s26, s27, 262144
    s_lshl_b32 s26, s26, 11
    s_add_u32 s26, s26, s25
    buffer_load_dwordx4 a[0:3], v101, s[4:7], s26 offen sc1
    buffer_load_dwordx4 a[4:7], v101, s[4:7], s26 offen offset:1024 sc1
    s_add_u32 s26, s26, 14336
    buffer_load_dwordx4 a[56:59], v101, s[4:7], s26 offen sc1
    buffer_load_dwordx4 a[60:63], v101, s[4:7], s26 offen offset:1024 sc1
    s_add_u32 s26, s26, 14336
    buffer_load_dwordx4 a[112:115], v101, s[4:7], s26 offen sc1
    buffer_load_dwordx4 a[116:119], v101, s[4:7], s26 offen offset:1024 sc1
    s_add_u32 s26, s26, 14336
    buffer_load_dwordx4 a[168:171], v101, s[4:7], s26 offen sc1
    buffer_load_dwordx4 a[172:175], v101, s[4:7], s26 offen offset:1024 sc1
    s_add_u32 s26, s26, 14336
    buffer_load_dwordx4 a[224:227], v101, s[4:7], s26 offen sc1
    buffer_load_dwordx4 a[228:231], v101, s[4:7], s26 offen offset:1024 sc1
    s_add_u32 s26, s26, 14336
    buffer_load_dwordx4 v[144:147], v101, s[4:7], s26 offen sc1
    buffer_load_dwordx4 v[148:151], v101, s[4:7], s26 offen offset:1024 sc1
    s_add_u32 s26, s26, 14336
    buffer_load_dwordx4 v[200:203], v101, s[4:7], s26 offen sc1
    buffer_load_dwordx4 v[204:207], v101, s[4:7], s26 offen offset:1024 sc1
    s_bfe_u32 s26, s27, 262148
    s_lshl_b32 s26, s26, 11
    s_add_u32 s26, s26, s25
    buffer_load_dwordx4 a[8:11], v101, s[4:7], s26 offen sc1
    buffer_load_dwordx4 a[12:15], v101, s[4:7], s26 offen offset:1024 sc1
    s_add_u32 s26, s26, 14336
    buffer_load_dwordx4 a[64:67], v101, s[4:7], s26 offen sc1
    buffer_load_dwordx4 a[68:71], v101, s[4:7], s26 offen offset:1024 sc1
    s_add_u32 s26, s26, 14336
    buffer_load_dwordx4 a[120:123], v101, s[4:7], s26 offen sc1
    buffer_load_dwordx4 a[124:127], v101, s[4:7], s26 offen offset:1024 sc1
    s_add_u32 s26, s26, 14336
    buffer_load_dwordx4 a[176:179], v101, s[4:7], s26 offen sc1
    buffer_load_dwordx4 a[180:183], v101, s[4:7], s26 offen offset:1024 sc1
    s_add_u32 s26, s26, 14336
    buffer_load_dwordx4 a[232:235], v101, s[4:7], s26 offen sc1
    buffer_load_dwordx4 a[236:239], v101, s[4:7], s26 offen offset:1024 sc1
    s_add_u32 s26, s26, 14336
    buffer_load_dwordx4 v[152:155], v101, s[4:7], s26 offen sc1
    buffer_load_dwordx4 v[156:159], v101, s[4:7], s26 offen offset:1024 sc1
    s_add_u32 s26, s26, 14336
    buffer_load_dwordx4 v[208:211], v101, s[4:7], s26 offen sc1
    buffer_load_dwordx4 v[212:215], v101, s[4:7], s26 offen offset:1024 sc1
    s_bfe_u32 s26, s27, 262152
    s_lshl_b32 s24, s26, 10
    v_add_u32 v103, s24, v101
    s_lshl_b32 s26, s26, 11
    s_add_u32 s26, s26, s25
    buffer_load_dwordx4 a[16:19], v101, s[4:7], s26 offen sc1
    buffer_load_dwordx4 a[20:23], v101, s[4:7], s26 offen offset:1024 sc1
    s_add_u32 s26, s26, 14336
    buffer_load_dwordx4 a[72:75], v101, s[4:7], s26 offen sc1
    buffer_load_dwordx4 a[76:79], v101, s[4:7], s26 offen offset:1024 sc1
    s_add_u32 s26, s26, 14336
    buffer_load_dwordx4 a[128:131], v101, s[4:7], s26 offen sc1
    buffer_load_dwordx4 a[132:135], v101, s[4:7], s26 offen offset:1024 sc1
    s_add_u32 s26, s26, 14336
    buffer_load_dwordx4 a[184:187], v101, s[4:7], s26 offen sc1
    buffer_load_dwordx4 a[188:191], v101, s[4:7], s26 offen offset:1024 sc1
    s_add_u32 s26, s26, 14336
    buffer_load_dwordx4 a[240:243], v101, s[4:7], s26 offen sc1
    buffer_load_dwordx4 a[244:247], v101, s[4:7], s26 offen offset:1024 sc1
    s_add_u32 s26, s26, 14336
    buffer_load_dwordx4 v[160:163], v101, s[4:7], s26 offen sc1
    buffer_load_dwordx4 v[164:167], v101, s[4:7], s26 offen offset:1024 sc1
    s_add_u32 s26, s26, 14336
    buffer_load_dwordx4 v[216:219], v101, s[4:7], s26 offen sc1
    buffer_load_dwordx4 v[220:223], v101, s[4:7], s26 offen offset:1024 sc1
    s_bfe_u32 s26, s27, 262156
    s_lshl_b32 s26, s26, 11
    s_add_u32 s26, s26, s25
    buffer_load_dwordx4 a[24:27], v101, s[4:7], s26 offen sc1
    buffer_load_dwordx4 a[28:31], v101, s[4:7], s26 offen offset:1024 sc1
    s_add_u32 s26, s26, 14336
    buffer_load_dwordx4 a[80:83], v101, s[4:7], s26 offen sc1
    buffer_load_dwordx4 a[84:87], v101, s[4:7], s26 offen offset:1024 sc1
    s_add_u32 s26, s26, 14336
    buffer_load_dwordx4 a[136:139], v101, s[4:7], s26 offen sc1
    buffer_load_dwordx4 a[140:143], v101, s[4:7], s26 offen offset:1024 sc1
    s_add_u32 s26, s26, 14336
    buffer_load_dwordx4 a[192:195], v101, s[4:7], s26 offen sc1
    buffer_load_dwordx4 a[196:199], v101, s[4:7], s26 offen offset:1024 sc1
    s_add_u32 s26, s26, 14336
    buffer_load_dwordx4 a[248:251], v101, s[4:7], s26 offen sc1
    buffer_load_dwordx4 a[252:255], v101, s[4:7], s26 offen offset:1024 sc1
    s_add_u32 s26, s26, 14336
    buffer_load_dwordx4 v[168:171], v101, s[4:7], s26 offen sc1
    buffer_load_dwordx4 v[172:175], v101, s[4:7], s26 offen offset:1024 sc1
    s_add_u32 s26, s26, 14336
    buffer_load_dwordx4 v[224:227], v101, s[4:7], s26 offen sc1
    buffer_load_dwordx4 v[228:231], v101, s[4:7], s26 offen offset:1024 sc1
    s_bfe_u32 s26, s27, 262160
    s_lshl_b32 s24, s26, 10
    v_add_u32 v104, s24, v101
    s_lshl_b32 s26, s26, 11
    s_add_u32 s26, s26, s25
    buffer_load_dwordx4 a[32:35], v101, s[4:7], s26 offen sc1
    buffer_load_dwordx4 a[36:39], v101, s[4:7], s26 offen offset:1024 sc1
    s_add_u32 s26, s26, 14336
    buffer_load_dwordx4 a[88:91], v101, s[4:7], s26 offen sc1
    buffer_load_dwordx4 a[92:95], v101, s[4:7], s26 offen offset:1024 sc1
    s_add_u32 s26, s26, 14336
    buffer_load_dwordx4 a[144:147], v101, s[4:7], s26 offen sc1
    buffer_load_dwordx4 a[148:151], v101, s[4:7], s26 offen offset:1024 sc1
    s_add_u32 s26, s26, 14336
    buffer_load_dwordx4 a[200:203], v101, s[4:7], s26 offen sc1
    buffer_load_dwordx4 a[204:207], v101, s[4:7], s26 offen offset:1024 sc1
    s_add_u32 s26, s26, 14336
    buffer_load_dwordx4 v[120:123], v101, s[4:7], s26 offen sc1
    buffer_load_dwordx4 v[124:127], v101, s[4:7], s26 offen offset:1024 sc1
    s_add_u32 s26, s26, 14336
    buffer_load_dwordx4 v[176:179], v101, s[4:7], s26 offen sc1
    buffer_load_dwordx4 v[180:183], v101, s[4:7], s26 offen offset:1024 sc1
    s_add_u32 s26, s26, 14336
    buffer_load_dwordx4 v[232:235], v101, s[4:7], s26 offen sc1
    buffer_load_dwordx4 v[236:239], v101, s[4:7], s26 offen offset:1024 sc1
    s_bfe_u32 s26, s27, 262164
    s_lshl_b32 s26, s26, 11
    s_add_u32 s26, s26, s25
    buffer_load_dwordx4 a[40:43], v101, s[4:7], s26 offen sc1
    buffer_load_dwordx4 a[44:47], v101, s[4:7], s26 offen offset:1024 sc1
    s_add_u32 s26, s26, 14336
    buffer_load_dwordx4 a[96:99], v101, s[4:7], s26 offen sc1
    buffer_load_dwordx4 a[100:103], v101, s[4:7], s26 offen offset:1024 sc1
    s_add_u32 s26, s26, 14336
    buffer_load_dwordx4 a[152:155], v101, s[4:7], s26 offen sc1
    buffer_load_dwordx4 a[156:159], v101, s[4:7], s26 offen offset:1024 sc1
    s_add_u32 s26, s26, 14336
    buffer_load_dwordx4 a[208:211], v101, s[4:7], s26 offen sc1
    buffer_load_dwordx4 a[212:215], v101, s[4:7], s26 offen offset:1024 sc1
    s_add_u32 s26, s26, 14336
    buffer_load_dwordx4 v[128:131], v101, s[4:7], s26 offen sc1
    buffer_load_dwordx4 v[132:135], v101, s[4:7], s26 offen offset:1024 sc1
    s_add_u32 s26, s26, 14336
    buffer_load_dwordx4 v[184:187], v101, s[4:7], s26 offen sc1
    buffer_load_dwordx4 v[188:191], v101, s[4:7], s26 offen offset:1024 sc1
    s_add_u32 s26, s26, 14336
    buffer_load_dwordx4 v[240:243], v101, s[4:7], s26 offen sc1
    buffer_load_dwordx4 v[244:247], v101, s[4:7], s26 offen offset:1024 sc1
    s_bfe_u32 s26, s27, 262168
    s_lshl_b32 s24, s26, 10
    v_add_u32 v105, s24, v101
    s_lshl_b32 s26, s26, 11
    s_add_u32 s26, s26, s25
    buffer_load_dwordx4 a[48:51], v101, s[4:7], s26 offen sc1
    buffer_load_dwordx4 a[52:55], v101, s[4:7], s26 offen offset:1024 sc1
    s_add_u32 s26, s26, 14336
    buffer_load_dwordx4 a[104:107], v101, s[4:7], s26 offen sc1
    buffer_load_dwordx4 a[108:111], v101, s[4:7], s26 offen offset:1024 sc1
    s_add_u32 s26, s26, 14336
    buffer_load_dwordx4 a[160:163], v101, s[4:7], s26 offen sc1
    buffer_load_dwordx4 a[164:167], v101, s[4:7], s26 offen offset:1024 sc1
    s_add_u32 s26, s26, 14336
    buffer_load_dwordx4 a[216:219], v101, s[4:7], s26 offen sc1
    buffer_load_dwordx4 a[220:223], v101, s[4:7], s26 offen offset:1024 sc1
    s_add_u32 s26, s26, 14336
    buffer_load_dwordx4 v[136:139], v101, s[4:7], s26 offen sc1
    buffer_load_dwordx4 v[140:143], v101, s[4:7], s26 offen offset:1024 sc1
    s_add_u32 s26, s26, 14336
    buffer_load_dwordx4 v[192:195], v101, s[4:7], s26 offen sc1
    buffer_load_dwordx4 v[196:199], v101, s[4:7], s26 offen offset:1024 sc1
    s_add_u32 s26, s26, 14336
    buffer_load_dwordx4 v[248:251], v101, s[4:7], s26 offen sc1
    buffer_load_dwordx4 v[252:255], v101, s[4:7], s26 offen offset:1024 sc1
    s_mov_b32 s20, 0x20000
    s_branch L_cme_59
L_cm_57:
    v_mov_b32 v17, 0
    global_load_dwordx2 v[18:19], v17, s[40:41] offset:0 sc1
L_cme_59:
    s_waitcnt vmcnt(0)
    v_readfirstlane_b32 s24, v18
    v_readfirstlane_b32 s26, v19
    s_and_b32 s25, s24, 255
    s_add_u32 s25, s25, s26
    s_cmp_ge_u32 s25, 48
    s_cbranch_scc1 L_cmd_58
    s_sleep 2
    s_sub_u32 s20, s20, 1
    s_cbranch_scc0 L_cm_57
    s_branch L_fin
L_cmd_58:
    s_lshl_b32 s25, s46, 5
    s_cmp_lg_u32 s24, s25
    s_cselect_b32 s46, 1, 0
    s_cmp_lg_u32 s12, 0
    s_cbranch_scc1 L_go_60
    v_mov_b32 v10, 0
    v_mov_b32 v11, 1
    s_mov_b64 exec, 1
    global_atomic_add v10, v11, s[40:41] offset:136
    s_mov_b64 exec, -1
L_go_60:
    s_lshl_b32 s24, s12, 11
    s_add_u32 s15, s24, 50331648
    s_add_u32 s16, s15, 1024
    s_cmp_eq_u32 s12, 3
    s_cselect_b32 s16, 50331648, s16
    s_mov_b32 s14, 0
    s_mov_b32 s24, 50401280
    s_mov_b32 s25, 1073741824
    s_cmp_eq_u32 s46, 0
    s_cselect_b32 s44, s24, s25
    s_cselect_b32 s45, s25, s24
    s_add_u32 s29, s15, 20480
    s_add_u32 s31, s16, 20480
    s_cmp_eq_u32 s13, 16
    s_cselect_b32 s29, s29, 1073741824
    s_cmp_eq_u32 s13, 17
    s_cselect_b32 s31, s31, 1073741824
L_Vtop_61:
    s_cmp_lt_u32 s14, s34
    s_cbranch_scc0 L_Vychk_63
L_Vyok_62:
    v_mov_b32 v28, 0
    v_mov_b32 v29, 0
    v_mov_b32 v30, 0
    v_mov_b32 v31, 0
    v_mov_b32 v32, 0
    v_mov_b32 v33, 0
    v_mov_b32 v34, 0
    v_mov_b32 v35, 0
    v_mov_b32 v36, 0
    v_mov_b32 v37, 0
    v_mov_b32 v38, 0
    v_mov_b32 v39, 0
    v_mov_b32 v40, 0
    v_mov_b32 v41, 0
    v_mov_b32 v42, 0
    v_mov_b32 v43, 0
    v_mov_b32 v44, 0
    v_mov_b32 v45, 0
    v_mov_b32 v46, 0
    v_mov_b32 v47, 0
    v_mov_b32 v48, 0
    v_mov_b32 v49, 0
    v_mov_b32 v50, 0
    v_mov_b32 v51, 0
    v_mov_b32 v52, 0
    v_mov_b32 v53, 0
    v_mov_b32 v54, 0
    v_mov_b32 v55, 0
    s_mov_b32 s20, 0x40000
L_mp_64:
    buffer_load_dwordx4 v[0:3], v101, s[4:7], s15 offen sc1
    buffer_load_dwordx4 v[4:7], v101, s[4:7], s16 offen sc1
    s_sub_u32 s20, s20, 1
    s_cbranch_scc1 L_fin
    s_cmp_eq_u32 s13, 0
    v_mov_b32 v119, v119
    s_nop 2
    v_mov_b32 v119, v119
    s_nop 2
    v_mov_b32 v119, v119
    s_nop 2
    v_mov_b32 v119, v119
    s_nop 2
    v_mov_b32 v119, v119
    s_nop 2
    v_mov_b32 v119, v119
    s_nop 2
    v_mov_b32 v119, v119
    s_nop 2
    v_mov_b32 v119, v119
    s_nop 2
    s_waitcnt vmcnt(1)
    v_max3_u32 v118, v0, v1, v2
    v_max_u32 v118, v118, v3
    s_waitcnt vmcnt(0)
    v_max3_u32 v118, v118, v4, v5
    v_max3_u32 v118, v118, v6, v7
    v_cmp_eq_u32 vcc, -1, v118
    ds_write_b128 v102, v[0:3]
    s_cbranch_vccnz L_mp_64
    v_smfmac_f32_16x16x64_bf16 v[28:31], v[0:3], a[0:7], v100
    ds_write_b128 v102, v[4:7] offset:1024
    v_smfmac_f32_16x16x64_bf16 v[32:35], v[0:3], a[56:63], v100
    buffer_load_dwordx4 v[84:87], v101, s[4:7], s19 offen offset:3072 sc1
    v_smfmac_f32_16x16x64_bf16 v[36:39], v[0:3], a[112:119], v100
    buffer_load_dwordx4 v[80:83], v101, s[4:7], s19 offen offset:2048 sc1
    v_smfmac_f32_16x16x64_bf16 v[40:43], v[0:3], a[168:175], v100
    buffer_load_dwordx4 v[76:79], v101, s[4:7], s19 offen offset:1024 sc1
    v_smfmac_f32_16x16x64_bf16 v[44:47], v[0:3], a[224:231], v100
    buffer_load_dwordx4 v[72:75], v101, s[4:7], s19 offen offset:0 sc1
    v_smfmac_f32_16x16x64_bf16 v[48:51], v[0:3], v[144:151], v100
    buffer_load_dwordx4 v[68:71], v101, s[4:7], s18 offen offset:3072 sc1
    v_smfmac_f32_16x16x64_bf16 v[52:55], v[0:3], v[200:207], v100
    buffer_load_dwordx4 v[64:67], v101, s[4:7], s18 offen offset:2048 sc1
    v_smfmac_f32_16x16x64_bf16 v[28:31], v[4:7], a[8:15], v100
    s_waitcnt lgkmcnt(0)
    s_barrier
    ds_read_b128 v[8:11], v103
    ds_read_b128 v[12:15], v103 offset:1024
    v_smfmac_f32_16x16x64_bf16 v[32:35], v[4:7], a[64:71], v100
    ds_read_b128 v[16:19], v104
    v_smfmac_f32_16x16x64_bf16 v[36:39], v[4:7], a[120:127], v100
    ds_read_b128 v[20:23], v104 offset:1024
    v_smfmac_f32_16x16x64_bf16 v[40:43], v[4:7], a[176:183], v100
    ds_read_b128 v[24:27], v105
    v_smfmac_f32_16x16x64_bf16 v[44:47], v[4:7], a[232:239], v100
    buffer_load_dwordx4 v[60:63], v101, s[4:7], s18 offen offset:1024 sc1
    v_smfmac_f32_16x16x64_bf16 v[48:51], v[4:7], v[152:159], v100
    buffer_load_dwordx4 v[56:59], v101, s[4:7], s18 offen offset:0 sc1
    v_smfmac_f32_16x16x64_bf16 v[52:55], v[4:7], v[208:215], v100
    s_add_u32 s24, s14, 3
    s_cmp_ge_u32 s24, s34
    s_cselect_b32 s24, s35, 1073741824
    buffer_load_dword v116, v117, s[4:7], s24 offen sc1
    s_waitcnt lgkmcnt(4)
    v_smfmac_f32_16x16x64_bf16 v[28:31], v[8:11], a[16:23], v100
    s_waitcnt lgkmcnt(3)
    v_smfmac_f32_16x16x64_bf16 v[28:31], v[12:15], a[24:31], v100
    s_waitcnt lgkmcnt(2)
    v_smfmac_f32_16x16x64_bf16 v[28:31], v[16:19], a[32:39], v100
    s_waitcnt lgkmcnt(1)
    v_smfmac_f32_16x16x64_bf16 v[28:31], v[20:23], a[40:47], v100
    s_waitcnt lgkmcnt(0)
    v_smfmac_f32_16x16x64_bf16 v[28:31], v[24:27], a[48:55], v100
    v_smfmac_f32_16x16x64_bf16 v[32:35], v[8:11], a[72:79], v100
    v_smfmac_f32_16x16x64_bf16 v[32:35], v[12:15], a[80:87], v100
    v_add_f32 v28, v28, v30
    v_smfmac_f32_16x16x64_bf16 v[32:35], v[16:19], a[88:95], v100
    v_add_f32 v29, v29, v31
    v_smfmac_f32_16x16x64_bf16 v[32:35], v[20:23], a[96:103], v100
    v_cvt_pk_bf16_f32 v28, v28, v29
    v_smfmac_f32_16x16x64_bf16 v[32:35], v[24:27], a[104:111], v100
    ds_write_b32 v106, v28 offset:0
    v_smfmac_f32_16x16x64_bf16 v[36:39], v[8:11], a[128:135], v100
    v_smfmac_f32_16x16x64_bf16 v[36:39], v[12:15], a[136:143], v100
    v_add_f32 v32, v32, v34
    v_smfmac_f32_16x16x64_bf16 v[36:39], v[16:19], a[144:151], v100
    v_add_f32 v33, v33, v35
    v_smfmac_f32_16x16x64_bf16 v[36:39], v[20:23], a[152:159], v100
    v_cvt_pk_bf16_f32 v32, v32, v33
    v_smfmac_f32_16x16x64_bf16 v[36:39], v[24:27], a[160:167], v100
    ds_write_b32 v106, v32 offset:256
    v_smfmac_f32_16x16x64_bf16 v[40:43], v[8:11], a[184:191], v100
    v_smfmac_f32_16x16x64_bf16 v[40:43], v[12:15], a[192:199], v100
    v_add_f32 v36, v36, v38
    v_smfmac_f32_16x16x64_bf16 v[40:43], v[16:19], a[200:207], v100
    v_add_f32 v37, v37, v39
    v_smfmac_f32_16x16x64_bf16 v[40:43], v[20:23], a[208:215], v100
    v_cvt_pk_bf16_f32 v36, v36, v37
    v_smfmac_f32_16x16x64_bf16 v[40:43], v[24:27], a[216:223], v100
    ds_write_b32 v106, v36 offset:512
    v_smfmac_f32_16x16x64_bf16 v[44:47], v[8:11], a[240:247], v100
    v_smfmac_f32_16x16x64_bf16 v[44:47], v[12:15], a[248:255], v100
    v_add_f32 v40, v40, v42
    v_smfmac_f32_16x16x64_bf16 v[44:47], v[16:19], v[120:127], v100
    v_add_f32 v41, v41, v43
    v_smfmac_f32_16x16x64_bf16 v[44:47], v[20:23], v[128:135], v100
    v_cvt_pk_bf16_f32 v40, v40, v41
    v_smfmac_f32_16x16x64_bf16 v[44:47], v[24:27], v[136:143], v100
    ds_write_b32 v106, v40 offset:768
    v_smfmac_f32_16x16x64_bf16 v[48:51], v[8:11], v[160:167], v100
    v_smfmac_f32_16x16x64_bf16 v[48:51], v[12:15], v[168:175], v100
    v_add_f32 v44, v44, v46
    v_add_f32 v45, v45, v47
    v_smfmac_f32_16x16x64_bf16 v[48:51], v[16:19], v[176:183], v100
    v_cvt_pk_bf16_f32 v44, v44, v45
    v_smfmac_f32_16x16x64_bf16 v[48:51], v[20:23], v[184:191], v100
    ds_write_b32 v106, v44 offset:1024
    v_smfmac_f32_16x16x64_bf16 v[48:51], v[24:27], v[192:199], v100
    buffer_load_dwordx4 v[28:31], v110, s[4:7], s30 offen offset:512 sc1
    v_smfmac_f32_16x16x64_bf16 v[52:55], v[8:11], v[216:223], v100
    buffer_load_dwordx4 v[32:35], v108, s[4:7], s30 offen sc1
    v_smfmac_f32_16x16x64_bf16 v[52:55], v[12:15], v[224:231], v100
    buffer_load_dwordx4 v[36:39], v108, s[4:7], s30 offen offset:256 sc1
    v_smfmac_f32_16x16x64_bf16 v[52:55], v[16:19], v[232:239], v100
    v_add_f32 v48, v48, v50
    v_smfmac_f32_16x16x64_bf16 v[52:55], v[20:23], v[240:247], v100
    v_add_f32 v49, v49, v51
    v_smfmac_f32_16x16x64_bf16 v[52:55], v[24:27], v[248:255], v100
    v_cvt_pk_bf16_f32 v48, v48, v49
    ds_write_b32 v106, v48 offset:1280
    s_nop 5
    v_add_f32 v52, v52, v54
    v_add_f32 v53, v53, v55
    v_cvt_pk_bf16_f32 v52, v52, v53
    ds_write_b32 v106, v52 offset:1536
    ds_read_b128 v[88:91], v107
    ds_read_b128 v[92:95], v107 offset:224
    s_mov_b32 s20, 0x40000
L_pp_66:
    buffer_load_dwordx4 v[28:31], v110, s[4:7], s30 offen offset:512 sc1
    buffer_load_dwordx4 v[32:35], v108, s[4:7], s30 offen sc1
    buffer_load_dwordx4 v[36:39], v108, s[4:7], s30 offen offset:256 sc1
    s_sub_u32 s20, s20, 1
    s_cbranch_scc1 L_fin
    s_waitcnt vmcnt(5) lgkmcnt(0)
    v_max3_u32 v118, v28, v29, v30
    v_max_u32 v118, v118, v31
    s_waitcnt vmcnt(4)
    v_max3_u32 v118, v118, v32, v33
    v_max3_u32 v118, v118, v34, v35
    s_waitcnt vmcnt(3)
    v_max3_u32 v118, v118, v36, v37
    v_max3_u32 v118, v118, v38, v39
    v_cmp_eq_u32 vcc, -1, v118
    v_mfma_f32_16x16x32_bf16 v[8:11], v[28:31], v[88:91], 0
    v_mfma_f32_16x16x32_bf16 v[12:15], v[28:31], v[92:95], 0
    s_cbranch_vccnz L_pp_66
    v_smfmac_f32_16x16x64_bf16 v[8:11], v[32:35], v[56:63], v100
    v_smfmac_f32_16x16x64_bf16 v[12:15], v[32:35], v[64:71], v100
    v_smfmac_f32_16x16x64_bf16 v[8:11], v[36:39], v[72:79], v100
    v_smfmac_f32_16x16x64_bf16 v[12:15], v[36:39], v[80:87], v100
    s_nop 3
    v_add_f32 v8, v8, v10
    v_add_f32 v9, v9, v11
    ds_write2_b32 v109, v8, v9 offset0:0 offset1:128
    s_nop 0
    v_add_f32 v12, v12, v14
    v_add_f32 v13, v13, v15
    ds_write2_b32 v109, v12, v13 offset0:28 offset1:156
    s_barrier
L_Vagain_67:
    ds_read_b128 v[42:45], v111
    ds_read_b128 v[46:49], v111 offset:4096
    v_mov_b32 v119, v119
    s_nop 2
    v_mov_b32 v119, v119
    s_nop 2
    v_mov_b32 v119, v119
    s_nop 2
    s_waitcnt lgkmcnt(1)
    v_pk_add_f32 v[40:41], v[42:43], v[44:45]
    s_waitcnt lgkmcnt(0)
    v_pk_add_f32 v[50:51], v[46:47], v[48:49]
    v_pk_add_f32 v[40:41], v[40:41], v[50:51]
    v_cmp_o_f32 vcc, v40, v41
    v_cvt_pk_bf16_f32 v114, v40, v41
    s_nop 0
    v_cndmask_b32 v114, -1, v114, vcc
    buffer_store_dword v114, v112, s[4:7], s44 offen
    buffer_store_dword v114, v112, s[4:7], s45 offen sc1
    s_andn2_b64 vcc, s[22:23], vcc
    s_cbranch_scc1 L_Vchk_68
L_Vgo_69:
    v_lshlrev_b32 v118, 3, v101
    v_max_u32 v118, 6144, v118
    s_add_u32 s24, s18, 1048576
    s_waitcnt vmcnt(2)
    s_barrier
    buffer_load_dword v119, v113, s[4:7], s30 offen sc1
    buffer_load_dword v119, v115, s[8:11], s17 offen
    buffer_load_dword v119, v118, s[4:7], s24 offen sc1
    s_add_u32 s17, s17, 28672
    v_mov_b32 v40, -1
    v_mov_b32 v41, -1
    v_mov_b32 v42, -1
    v_mov_b32 v43, -1
    s_mov_b64 exec, s[22:23]
    ds_write_b128 v111, v[40:43]
    ds_write_b128 v111, v[40:43] offset:4096
    s_mov_b64 exec, -1
    s_add_u32 s15, s15, 69632
    s_add_u32 s16, s16, 69632
    s_add_u32 s30, s30, 69632
    s_add_u32 s44, s44, 69632
    s_add_u32 s45, s45, 69632
    s_add_u32 s18, s18, 524288
    s_add_u32 s19, s19, 524288
    s_add_u32 s28, s30, 12288
    s_add_u32 s29, s29, 69632
    s_add_u32 s31, s31, 69632
    s_add_u32 s14, s14, 1
    s_cmp_lt_u32 s14, 63
    s_cbranch_scc1 L_Vtop_61
    s_branch L_fin
L_Vychk_63:
    s_mov_b32 s20, 0x20000
L_Vyl_70:
    s_mov_b32 s34, 1000
    v_readlane_b32 s24, v116, 0
    s_nop 0
    s_mul_i32 s24, s24, 6
    s_add_u32 s24, s24, 0
    s_min_u32 s34, s34, s24
    v_readlane_b32 s24, v116, 1
    s_nop 0
    s_mul_i32 s24, s24, 6
    s_add_u32 s24, s24, 1
    s_min_u32 s34, s34, s24
    v_readlane_b32 s24, v116, 2
    s_nop 0
    s_mul_i32 s24, s24, 6
    s_add_u32 s24, s24, 2
    s_min_u32 s34, s34, s24
    v_readlane_b32 s24, v116, 3
    s_nop 0
    s_mul_i32 s24, s24, 6
    s_add_u32 s24, s24, 3
    s_min_u32 s34, s34, s24
    v_readlane_b32 s24, v116, 4
    s_nop 0
    s_mul_i32 s24, s24, 6
    s_add_u32 s24, s24, 4
    s_min_u32 s34, s34, s24
    v_readlane_b32 s24, v116, 5
    s_nop 0
    s_mul_i32 s24, s24, 6
    s_add_u32 s24, s24, 5
    s_min_u32 s34, s34, s24
    s_cmp_lt_u32 s14, s34
    s_cbranch_scc1 L_Vyok_62
    buffer_load_dword v116, v117, s[4:7], s35 offen sc1
    s_waitcnt vmcnt(0)
    s_sub_u32 s20, s20, 1
    s_cbranch_scc0 L_Vyl_70
    s_branch L_fin
L_Vchk_68:
    s_waitcnt vmcnt(0)
    s_add_u32 s70, s70, 1
    v_max3_u32 v50, v42, v43, v44
    v_max3_u32 v50, v50, v45, v46
    v_max3_u32 v50, v50, v47, v48
    v_max_u32 v50, v50, v49
    v_cmp_eq_u32 vcc, -1, v50
    s_sub_u32 s20, s20, 1
    s_cbranch_scc1 L_fin
    s_and_b64 vcc, vcc, s[22:23]
    s_cbranch_scc1 L_Vagain_67
    v_cvt_pk_bf16_f32 v114, v40, v41
    v_min_u32 v114, -2, v114
    buffer_store_dword v114, v112, s[4:7], s44 offen
    buffer_store_dword v114, v112, s[4:7], s45 offen sc1
    s_branch L_Vgo_69
L_O:
    v_and_b32 v20, 63, v119
    v_and_b32 v21, 15, v119
    v_bfe_u32 v22, v119, 4, 2
    v_lshlrev_b32 v101, 4, v20
    v_mov_b32 v100, 0x4444
    v_mov_b32 v1, 0xeeee
    v_and_b32 v2, 2, v21
    v_cmp_ne_u32 vcc, 0, v2
    s_nop 1
    v_cndmask_b32 v100, v100, v1, vcc
    s_sub_u32 s24, s13, 32
    s_mul_i32 s17, s24, 10923
    s_lshr_b32 s17, s17, 16
    s_mul_i32 s25, s17, 6
    s_sub_u32 s18, s24, s25
    v_mov_b32 v104, 0
    v_lshrrev_b32 v6, 2, v20
    v_lshrrev_b32 v7, 5, v20
    v_lshlrev_b32 v7, 1, v7
    v_and_b32 v102, 3, v20
    v_xor_b32 v7, v7, v102
    s_mov_b32 s27, 1792
    v_mul_lo_u32 v102, v6, s27
    v_lshl_add_u32 v102, v7, 4, v102
    v_lshrrev_b32 v6, 3, v21
    v_lshlrev_b32 v6, 1, v6
    v_xor_b32 v6, v6, v22
    v_lshlrev_b32 v103, 6, v21
    v_lshl_add_u32 v103, v6, 4, v103
    s_lshr_b32 s24, s12, 1
    s_mul_i32 s24, s24, 896
    s_and_b32 s25, s12, 1
    s_mul_i32 s25, s25, 448
    s_add_u32 s24, s24, s25
    v_add_u32 v102, s24, v102
    s_mul_i32 s16, s12, 7168
    s_mov_b32 s14, s18
    s_mul_i32 s15, s14, 28672
    s_add_u32 m0, s16, 0
    s_nop 0
    buffer_load_dwordx4 v102, s[8:11], s15 offen offset:0 lds
    s_add_u32 m0, s16, 960
    s_nop 0
    buffer_load_dwordx4 v102, s[8:11], s15 offen offset:64 lds
    s_add_u32 m0, s16, 1920
    s_nop 0
    buffer_load_dwordx4 v102, s[8:11], s15 offen offset:128 lds
    s_add_u32 m0, s16, 2880
    s_nop 0
    buffer_load_dwordx4 v102, s[8:11], s15 offen offset:192 lds
    s_add_u32 m0, s16, 3840
    s_nop 0
    buffer_load_dwordx4 v102, s[8:11], s15 offen offset:256 lds
    s_add_u32 m0, s16, 4800
    s_nop 0
    buffer_load_dwordx4 v102, s[8:11], s15 offen offset:320 lds
    s_add_u32 m0, s16, 5760
    s_nop 0
    buffer_load_dwordx4 v102, s[8:11], s15 offen offset:384 lds
    v_lshrrev_b32 v10, 1, v22
    v_lshlrev_b32 v10, 12, v10
    v_and_b32 v11, 1, v22
    v_lshl_add_u32 v10, v11, 8, v10
    v_add_u32 v6, 0, v21
    v_mul_u32_u24 v7, 4682, v6
    v_lshrrev_b32 v7, 16, v7
    v_mul_u32_u24 v8, 14, v7
    v_sub_u32 v6, v6, v8
    v_lshl_add_u32 v6, v6, 4, v10
    v_and_b32 v8, 1, v7
    v_lshl_add_u32 v6, v8, 11, v6
    v_bfe_u32 v8, v7, 1, 1
    v_lshl_add_u32 v6, v8, 9, v6
    v_lshrrev_b32 v8, 2, v7
    v_lshl_add_u32 v80, v8, 10, v6
    v_add_u32 v6, 16, v21
    v_mul_u32_u24 v7, 4682, v6
    v_lshrrev_b32 v7, 16, v7
    v_mul_u32_u24 v8, 14, v7
    v_sub_u32 v6, v6, v8
    v_lshl_add_u32 v6, v6, 4, v10
    v_and_b32 v8, 1, v7
    v_lshl_add_u32 v6, v8, 11, v6
    v_bfe_u32 v8, v7, 1, 1
    v_lshl_add_u32 v6, v8, 9, v6
    v_lshrrev_b32 v8, 2, v7
    v_lshl_add_u32 v81, v8, 10, v6
    v_add_u32 v6, 32, v21
    v_mul_u32_u24 v7, 4682, v6
    v_lshrrev_b32 v7, 16, v7
    v_mul_u32_u24 v8, 14, v7
    v_sub_u32 v6, v6, v8
    v_lshl_add_u32 v6, v6, 4, v10
    v_and_b32 v8, 1, v7
    v_lshl_add_u32 v6, v8, 11, v6
    v_bfe_u32 v8, v7, 1, 1
    v_lshl_add_u32 v6, v8, 9, v6
    v_lshrrev_b32 v8, 2, v7
    v_lshl_add_u32 v82, v8, 10, v6
    v_add_u32 v6, 48, v21
    v_mul_u32_u24 v7, 4682, v6
    v_lshrrev_b32 v7, 16, v7
    v_mul_u32_u24 v8, 14, v7
    v_sub_u32 v6, v6, v8
    v_lshl_add_u32 v6, v6, 4, v10
    v_and_b32 v8, 1, v7
    v_lshl_add_u32 v6, v8, 11, v6
    v_bfe_u32 v8, v7, 1, 1
    v_lshl_add_u32 v6, v8, 9, v6
    v_lshrrev_b32 v8, 2, v7
    v_lshl_add_u32 v83, v8, 10, v6
    v_add_u32 v6, 64, v21
    v_mul_u32_u24 v7, 4682, v6
    v_lshrrev_b32 v7, 16, v7
    v_mul_u32_u24 v8, 14, v7
    v_sub_u32 v6, v6, v8
    v_lshl_add_u32 v6, v6, 4, v10
    v_and_b32 v8, 1, v7
    v_lshl_add_u32 v6, v8, 11, v6
    v_bfe_u32 v8, v7, 1, 1
    v_lshl_add_u32 v6, v8, 9, v6
    v_lshrrev_b32 v8, 2, v7
    v_lshl_add_u32 v84, v8, 10, v6
    v_add_u32 v6, 80, v21
    v_mul_u32_u24 v7, 4682, v6
    v_lshrrev_b32 v7, 16, v7
    v_mul_u32_u24 v8, 14, v7
    v_sub_u32 v6, v6, v8
    v_lshl_add_u32 v6, v6, 4, v10
    v_and_b32 v8, 1, v7
    v_lshl_add_u32 v6, v8, 11, v6
    v_bfe_u32 v8, v7, 1, 1
    v_lshl_add_u32 v6, v8, 9, v6
    v_lshrrev_b32 v8, 2, v7
    v_lshl_add_u32 v85, v8, 10, v6
    v_add_u32 v6, 96, v21
    v_mul_u32_u24 v7, 4682, v6
    v_lshrrev_b32 v7, 16, v7
    v_mul_u32_u24 v8, 14, v7
    v_sub_u32 v6, v6, v8
    v_lshl_add_u32 v6, v6, 4, v10
    v_and_b32 v8, 1, v7
    v_lshl_add_u32 v6, v8, 11, v6
    v_bfe_u32 v8, v7, 1, 1
    v_lshl_add_u32 v6, v8, 9, v6
    v_lshrrev_b32 v8, 2, v7
    v_lshl_add_u32 v86, v8, 10, v6
    v_mov_b32 v8, 1073741824
    s_lshl_b32 s24, s12, 11
    s_add_u32 s24, s24, 98304
    v_lshlrev_b32 v106, 4, v21
    v_lshl_add_u32 v106, v22, 2, v106
    v_add_u32 v106, s24, v106
    v_mul_u32_u24 v105, 448, v22
    v_lshl_add_u32 v105, v21, 4, v105
    v_add_u32 v105, s24, v105
    s_mul_i32 s24, s12, 10240
    v_lshrrev_b32 v6, 1, v22
    v_mul_u32_u24 v107, 2560, v6
    v_lshl_add_u32 v107, v11, 8, v107
    v_lshl_add_u32 v107, v21, 4, v107
    v_add_u32 v107, s24, v107
    v_mul_u32_u24 v108, 2560, v22
    v_lshl_add_u32 v108, v21, 4, v108
    v_add_u32 v108, s24, v108
    v_lshlrev_b32 v109, 3, v21
    v_mul_u32_u24 v6, 1792, v21
    v_lshl_add_u32 v6, v22, 3, v6
    s_lshr_b32 s24, s12, 1
    s_mul_i32 s24, s24, 896
    s_and_b32 s25, s12, 1
    s_mul_i32 s25, s25, 28
    s_add_u32 s24, s24, s25
    s_mul_i32 s25, s17, 56
    s_add_u32 s24, s24, s25
    v_add_u32 v6, s24, v6
    v_cmp_gt_u32 vcc, 3, v22
    s_nop 1
    v_cndmask_b32 v110, v8, v6, vcc
    v_cndmask_b32 v111, v6, v8, vcc
    v_add_u32 v112, 106496, v101
    v_mov_b32 v119, v20
    s_mov_b32 s20, 0x20000
    v_mov_b32 v10, 0
L_wd_71:
    global_load_dword v11, v10, s[40:41] offset:128 sc1
    s_waitcnt vmcnt(0)
    v_cmp_gt_u32 vcc, 1, v11
    s_cbranch_vccz L_wdd_72
    s_sleep 2
    s_sub_u32 s20, s20, 1
    s_cbranch_scc0 L_wd_71
    s_branch L_fin
L_wdd_72:
    s_cmp_lg_u32 s12, 0
    s_cbranch_scc1 L_w0_73
    s_mov_b32 s20, 0x20000
    v_lshlrev_b32 v14, 4, v20
    v_cmp_gt_u32 s[42:43], 56, v20
    s_mov_b32 s27, 59768832
L_wf_74:
    buffer_load_dwordx4 v[10:13], v14, s[4:7], s27 offen sc1
    s_waitcnt vmcnt(0)
    v_min3_u32 v10, v10, v11, v12
    v_min_u32 v10, v10, v13
    v_cmp_gt_u32 vcc, 1, v10
    s_nop 0
    s_and_b64 vcc, vcc, s[42:43]
    s_cbranch_scc0 L_wfd_75
    s_sleep 4
    s_sub_u32 s20, s20, 1
    s_cbranch_scc0 L_wf_74
    s_branch L_fin
L_wfd_75:
L_w0_73:
    s_barrier
    s_add_u32 s24, s17, 16
    s_mul_i32 s24, s24, 401408
    s_mul_i32 s25, s12, 100352
    s_add_u32 s25, s25, s24
    s_mov_b32 s24, 0
L_lw_76:
    s_cmp_lt_u32 0, s18
    s_cselect_b32 s27, 1, 0
    s_cmp_lg_u32 s27, s24
    s_cbranch_scc1 L_lws_77
    s_add_u32 s26, s25, 0
    buffer_load_dwordx4 a[0:3], v101, s[4:7], s26 offen sc1
    buffer_load_dwordx4 a[4:7], v101, s[4:7], s26 offen offset:1024 sc1
    s_add_u32 s26, s26, 14336
    buffer_load_dwordx4 a[56:59], v101, s[4:7], s26 offen sc1
    buffer_load_dwordx4 a[60:63], v101, s[4:7], s26 offen offset:1024 sc1
    s_add_u32 s26, s26, 14336
    buffer_load_dwordx4 a[112:115], v101, s[4:7], s26 offen sc1
    buffer_load_dwordx4 a[116:119], v101, s[4:7], s26 offen offset:1024 sc1
    s_add_u32 s26, s26, 14336
    buffer_load_dwordx4 a[168:171], v101, s[4:7], s26 offen sc1
    buffer_load_dwordx4 a[172:175], v101, s[4:7], s26 offen offset:1024 sc1
    s_add_u32 s26, s26, 14336
    buffer_load_dwordx4 a[224:227], v101, s[4:7], s26 offen sc1
    buffer_load_dwordx4 a[228:231], v101, s[4:7], s26 offen offset:1024 sc1
    s_add_u32 s26, s26, 14336
    buffer_load_dwordx4 v[144:147], v101, s[4:7], s26 offen sc1
    buffer_load_dwordx4 v[148:151], v101, s[4:7], s26 offen offset:1024 sc1
    s_add_u32 s26, s26, 14336
    buffer_load_dwordx4 v[200:203], v101, s[4:7], s26 offen sc1
    buffer_load_dwordx4 v[204:207], v101, s[4:7], s26 offen offset:1024 sc1
L_lws_77:
    s_cmp_lt_u32 1, s18
    s_cselect_b32 s27, 1, 0
    s_cmp_lg_u32 s27, s24
    s_cbranch_scc1 L_lws_78
    s_add_u32 s26, s25, 2048
    buffer_load_dwordx4 a[8:11], v101, s[4:7], s26 offen sc1
    buffer_load_dwordx4 a[12:15], v101, s[4:7], s26 offen offset:1024 sc1
    s_add_u32 s26, s26, 14336
    buffer_load_dwordx4 a[64:67], v101, s[4:7], s26 offen sc1
    buffer_load_dwordx4 a[68:71], v101, s[4:7], s26 offen offset:1024 sc1
    s_add_u32 s26, s26, 14336
    buffer_load_dwordx4 a[120:123], v101, s[4:7], s26 offen sc1
    buffer_load_dwordx4 a[124:127], v101, s[4:7], s26 offen offset:1024 sc1
    s_add_u32 s26, s26, 14336
    buffer_load_dwordx4 a[176:179], v101, s[4:7], s26 offen sc1
    buffer_load_dwordx4 a[180:183], v101, s[4:7], s26 offen offset:1024 sc1
    s_add_u32 s26, s26, 14336
    buffer_load_dwordx4 a[232:235], v101, s[4:7], s26 offen sc1
    buffer_load_dwordx4 a[236:239], v101, s[4:7], s26 offen offset:1024 sc1
    s_add_u32 s26, s26, 14336
    buffer_load_dwordx4 v[152:155], v101, s[4:7], s26 offen sc1
    buffer_load_dwordx4 v[156:159], v101, s[4:7], s26 offen offset:1024 sc1
    s_add_u32 s26, s26, 14336
    buffer_load_dwordx4 v[208:211], v101, s[4:7], s26 offen sc1
    buffer_load_dwordx4 v[212:215], v101, s[4:7], s26 offen offset:1024 sc1
L_lws_78:
    s_cmp_lt_u32 2, s18
    s_cselect_b32 s27, 1, 0
    s_cmp_lg_u32 s27, s24
    s_cbranch_scc1 L_lws_79
    s_add_u32 s26, s25, 4096
    buffer_load_dwordx4 a[16:19], v101, s[4:7], s26 offen sc1
    buffer_load_dwordx4 a[20:23], v101, s[4:7], s26 offen offset:1024 sc1
    s_add_u32 s26, s26, 14336
    buffer_load_dwordx4 a[72:75], v101, s[4:7], s26 offen sc1
    buffer_load_dwordx4 a[76:79], v101, s[4:7], s26 offen offset:1024 sc1
    s_add_u32 s26, s26, 14336
    buffer_load_dwordx4 a[128:131], v101, s[4:7], s26 offen sc1
    buffer_load_dwordx4 a[132:135], v101, s[4:7], s26 offen offset:1024 sc1
    s_add_u32 s26, s26, 14336
    buffer_load_dwordx4 a[184:187], v101, s[4:7], s26 offen sc1
    buffer_load_dwordx4 a[188:191], v101, s[4:7], s26 offen offset:1024 sc1
    s_add_u32 s26, s26, 14336
    buffer_load_dwordx4 a[240:243], v101, s[4:7], s26 offen sc1
    buffer_load_dwordx4 a[244:247], v101, s[4:7], s26 offen offset:1024 sc1
    s_add_u32 s26, s26, 14336
    buffer_load_dwordx4 v[160:163], v101, s[4:7], s26 offen sc1
    buffer_load_dwordx4 v[164:167], v101, s[4:7], s26 offen offset:1024 sc1
    s_add_u32 s26, s26, 14336
    buffer_load_dwordx4 v[216:219], v101, s[4:7], s26 offen sc1
    buffer_load_dwordx4 v[220:223], v101, s[4:7], s26 offen offset:1024 sc1
L_lws_79:
    s_cmp_lt_u32 3, s18
    s_cselect_b32 s27, 1, 0
    s_cmp_lg_u32 s27, s24
    s_cbranch_scc1 L_lws_80
    s_add_u32 s26, s25, 6144
    buffer_load_dwordx4 a[24:27], v101, s[4:7], s26 offen sc1
    buffer_load_dwordx4 a[28:31], v101, s[4:7], s26 offen offset:1024 sc1
    s_add_u32 s26, s26, 14336
    buffer_load_dwordx4 a[80:83], v101, s[4:7], s26 offen sc1
    buffer_load_dwordx4 a[84:87], v101, s[4:7], s26 offen offset:1024 sc1
    s_add_u32 s26, s26, 14336
    buffer_load_dwordx4 a[136:139], v101, s[4:7], s26 offen sc1
    buffer_load_dwordx4 a[140:143], v101, s[4:7], s26 offen offset:1024 sc1
    s_add_u32 s26, s26, 14336
    buffer_load_dwordx4 a[192:195], v101, s[4:7], s26 offen sc1
    buffer_load_dwordx4 a[196:199], v101, s[4:7], s26 offen offset:1024 sc1
    s_add_u32 s26, s26, 14336
    buffer_load_dwordx4 a[248:251], v101, s[4:7], s26 offen sc1
    buffer_load_dwordx4 a[252:255], v101, s[4:7], s26 offen offset:1024 sc1
    s_add_u32 s26, s26, 14336
    buffer_load_dwordx4 v[168:171], v101, s[4:7], s26 offen sc1
    buffer_load_dwordx4 v[172:175], v101, s[4:7], s26 offen offset:1024 sc1
    s_add_u32 s26, s26, 14336
    buffer_load_dwordx4 v[224:227], v101, s[4:7], s26 offen sc1
    buffer_load_dwordx4 v[228:231], v101, s[4:7], s26 offen offset:1024 sc1
L_lws_80:
    s_cmp_lt_u32 4, s18
    s_cselect_b32 s27, 1, 0
    s_cmp_lg_u32 s27, s24
    s_cbranch_scc1 L_lws_81
    s_add_u32 s26, s25, 8192
    buffer_load_dwordx4 a[32:35], v101, s[4:7], s26 offen sc1
    buffer_load_dwordx4 a[36:39], v101, s[4:7], s26 offen offset:1024 sc1
    s_add_u32 s26, s26, 14336
    buffer_load_dwordx4 a[88:91], v101, s[4:7], s26 offen sc1
    buffer_load_dwordx4 a[92:95], v101, s[4:7], s26 offen offset:1024 sc1
    s_add_u32 s26, s26, 14336
    buffer_load_dwordx4 a[144:147], v101, s[4:7], s26 offen sc1
    buffer_load_dwordx4 a[148:151], v101, s[4:7], s26 offen offset:1024 sc1
    s_add_u32 s26, s26, 14336
    buffer_load_dwordx4 a[200:203], v101, s[4:7], s26 offen sc1
    buffer_load_dwordx4 a[204:207], v101, s[4:7], s26 offen offset:1024 sc1
    s_add_u32 s26, s26, 14336
    buffer_load_dwordx4 v[120:123], v101, s[4:7], s26 offen sc1
    buffer_load_dwordx4 v[124:127], v101, s[4:7], s26 offen offset:1024 sc1
    s_add_u32 s26, s26, 14336
    buffer_load_dwordx4 v[176:179], v101, s[4:7], s26 offen sc1
    buffer_load_dwordx4 v[180:183], v101, s[4:7], s26 offen offset:1024 sc1
    s_add_u32 s26, s26, 14336
    buffer_load_dwordx4 v[232:235], v101, s[4:7], s26 offen sc1
    buffer_load_dwordx4 v[236:239], v101, s[4:7], s26 offen offset:1024 sc1
L_lws_81:
    s_cmp_lt_u32 5, s18
    s_cselect_b32 s27, 1, 0
    s_cmp_lg_u32 s27, s24
    s_cbranch_scc1 L_lws_82
    s_add_u32 s26, s25, 10240
    buffer_load_dwordx4 a[40:43], v101, s[4:7], s26 offen sc1
    buffer_load_dwordx4 a[44:47], v101, s[4:7], s26 offen offset:1024 sc1
    s_add_u32 s26, s26, 14336
    buffer_load_dwordx4 a[96:99], v101, s[4:7], s26 offen sc1
    buffer_load_dwordx4 a[100:103], v101, s[4:7], s26 offen offset:1024 sc1
    s_add_u32 s26, s26, 14336
    buffer_load_dwordx4 a[152:155], v101, s[4:7], s26 offen sc1
    buffer_load_dwordx4 a[156:159], v101, s[4:7], s26 offen offset:1024 sc1
    s_add_u32 s26, s26, 14336
    buffer_load_dwordx4 a[208:211], v101, s[4:7], s26 offen sc1
    buffer_load_dwordx4 a[212:215], v101, s[4:7], s26 offen offset:1024 sc1
    s_add_u32 s26, s26, 14336
    buffer_load_dwordx4 v[128:131], v101, s[4:7], s26 offen sc1
    buffer_load_dwordx4 v[132:135], v101, s[4:7], s26 offen offset:1024 sc1
    s_add_u32 s26, s26, 14336
    buffer_load_dwordx4 v[184:187], v101, s[4:7], s26 offen sc1
    buffer_load_dwordx4 v[188:191], v101, s[4:7], s26 offen offset:1024 sc1
    s_add_u32 s26, s26, 14336
    buffer_load_dwordx4 v[240:243], v101, s[4:7], s26 offen sc1
    buffer_load_dwordx4 v[244:247], v101, s[4:7], s26 offen offset:1024 sc1
L_lws_82:
    s_cmp_lt_u32 6, s18
    s_cselect_b32 s27, 1, 0
    s_cmp_lg_u32 s27, s24
    s_cbranch_scc1 L_lws_83
    s_add_u32 s26, s25, 12288
    buffer_load_dwordx4 a[48:51], v101, s[4:7], s26 offen sc1
    buffer_load_dwordx4 a[52:55], v101, s[4:7], s26 offen offset:1024 sc1
    s_add_u32 s26, s26, 14336
    buffer_load_dwordx4 a[104:107], v101, s[4:7], s26 offen sc1
    buffer_load_dwordx4 a[108:111], v101, s[4:7], s26 offen offset:1024 sc1
    s_add_u32 s26, s26, 14336
    buffer_load_dwordx4 a[160:163], v101, s[4:7], s26 offen sc1
    buffer_load_dwordx4 a[164:167], v101, s[4:7], s26 offen offset:1024 sc1
    s_add_u32 s26, s26, 14336
    buffer_load_dwordx4 a[216:219], v101, s[4:7], s26 offen sc1
    buffer_load_dwordx4 a[220:223], v101, s[4:7], s26 offen offset:1024 sc1
    s_add_u32 s26, s26, 14336
    buffer_load_dwordx4 v[136:139], v101, s[4:7], s26 offen sc1
    buffer_load_dwordx4 v[140:143], v101, s[4:7], s26 offen offset:1024 sc1
    s_add_u32 s26, s26, 14336
    buffer_load_dwordx4 v[192:195], v101, s[4:7], s26 offen sc1
    buffer_load_dwordx4 v[196:199], v101, s[4:7], s26 offen offset:1024 sc1
    s_add_u32 s26, s26, 14336
    buffer_load_dwordx4 v[248:251], v101, s[4:7], s26 offen sc1
    buffer_load_dwordx4 v[252:255], v101, s[4:7], s26 offen offset:1024 sc1
L_lws_83:
    s_add_u32 s24, s24, 1
    s_cmp_lt_u32 s24, 2
    s_cbranch_scc1 L_lw_76
    s_lshl_b32 s30, s17, 2
    s_add_u32 s30, s30, s12
    s_lshl_b32 s29, s30, 13
    s_add_u32 s29, s29, 16777216
    s_lshl_b32 s30, s30, 5
    s_lshl_b32 s24, s18, 2
    s_add_u32 s30, s30, s24
    s_add_u32 s30, s30, 59770880
    s_mov_b32 s19, 0
    s_waitcnt vmcnt(0)
L_O1_84:
    s_waitcnt vmcnt(7)
    s_barrier
    s_xor_b32 s16, s16, 0x8000
    s_add_u32 s28, s14, 6
    s_mul_i32 s15, s28, 28672
    s_add_u32 m0, s16, 0
    s_nop 0
    buffer_load_dwordx4 v102, s[8:11], s15 offen offset:0 lds
    s_add_u32 m0, s16, 960
    s_nop 0
    buffer_load_dwordx4 v102, s[8:11], s15 offen offset:64 lds
    s_add_u32 m0, s16, 1920
    s_nop 0
    buffer_load_dwordx4 v102, s[8:11], s15 offen offset:128 lds
    s_add_u32 m0, s16, 2880
    s_nop 0
    buffer_load_dwordx4 v102, s[8:11], s15 offen offset:192 lds
    s_add_u32 m0, s16, 3840
    s_nop 0
    buffer_load_dwordx4 v102, s[8:11], s15 offen offset:256 lds
    s_add_u32 m0, s16, 4800
    s_nop 0
    buffer_load_dwordx4 v102, s[8:11], s15 offen offset:320 lds
    s_add_u32 m0, s16, 5760
    s_nop 0
    buffer_load_dwordx4 v102, s[8:11], s15 offen offset:384 lds
    ds_read_b128 v[56:59], v103 offset:0
    ds_read_b128 v[60:63], v103 offset:14336
    s_waitcnt lgkmcnt(0)
    v_mfma_f32_16x16x32_bf16 v[0:3], v[56:59], a[0:3], 0
    v_mfma_f32_16x16x32_bf16 v[28:31], v[60:63], a[0:3], 0
    v_mfma_f32_16x16x32_bf16 v[4:7], v[56:59], a[56:59], 0
    ds_read_b128 v[64:67], v103 offset:1024
    v_mfma_f32_16x16x32_bf16 v[32:35], v[60:63], a[56:59], 0
    ds_read_b128 v[68:71], v103 offset:15360
    v_mfma_f32_16x16x32_bf16 v[8:11], v[56:59], a[112:115], 0
    v_mfma_f32_16x16x32_bf16 v[36:39], v[60:63], a[112:115], 0
    v_mfma_f32_16x16x32_bf16 v[12:15], v[56:59], a[168:171], 0
    v_mfma_f32_16x16x32_bf16 v[40:43], v[60:63], a[168:171], 0
    v_mfma_f32_16x16x32_bf16 v[16:19], v[56:59], a[224:227], 0
    v_mfma_f32_16x16x32_bf16 v[44:47], v[60:63], a[224:227], 0
    v_mfma_f32_16x16x32_bf16 v[20:23], v[56:59], v[144:147], 0
    v_mfma_f32_16x16x32_bf16 v[48:51], v[60:63], v[144:147], 0
    v_mfma_f32_16x16x32_bf16 v[24:27], v[56:59], v[200:203], 0
    v_mfma_f32_16x16x32_bf16 v[52:55], v[60:63], v[200:203], 0
    s_waitcnt lgkmcnt(0)
    v_mfma_f32_16x16x32_bf16 v[0:3], v[64:67], a[4:7], v[0:3]
    v_mfma_f32_16x16x32_bf16 v[28:31], v[68:71], a[4:7], v[28:31]
    v_mfma_f32_16x16x32_bf16 v[4:7], v[64:67], a[60:63], v[4:7]
    ds_read_b128 v[56:59], v103 offset:2048
    v_mfma_f32_16x16x32_bf16 v[32:35], v[68:71], a[60:63], v[32:35]
    ds_read_b128 v[60:63], v103 offset:16384
    v_mfma_f32_16x16x32_bf16 v[8:11], v[64:67], a[116:119], v[8:11]
    v_mfma_f32_16x16x32_bf16 v[36:39], v[68:71], a[116:119], v[36:39]
    v_mfma_f32_16x16x32_bf16 v[12:15], v[64:67], a[172:175], v[12:15]
    v_mfma_f32_16x16x32_bf16 v[40:43], v[68:71], a[172:175], v[40:43]
    v_mfma_f32_16x16x32_bf16 v[16:19], v[64:67], a[228:231], v[16:19]
    v_mfma_f32_16x16x32_bf16 v[44:47], v[68:71], a[228:231], v[44:47]
    v_mfma_f32_16x16x32_bf16 v[20:23], v[64:67], v[148:151], v[20:23]
    v_mfma_f32_16x16x32_bf16 v[48:51], v[68:71], v[148:151], v[48:51]
    v_mfma_f32_16x16x32_bf16 v[24:27], v[64:67], v[204:207], v[24:27]
    v_mfma_f32_16x16x32_bf16 v[52:55], v[68:71], v[204:207], v[52:55]
    s_waitcnt lgkmcnt(0)
    v_mfma_f32_16x16x32_bf16 v[0:3], v[56:59], a[8:11], v[0:3]
    v_mfma_f32_16x16x32_bf16 v[28:31], v[60:63], a[8:11], v[28:31]
    v_mfma_f32_16x16x32_bf16 v[4:7], v[56:59], a[64:67], v[4:7]
    ds_read_b128 v[64:67], v103 offset:3072
    v_mfma_f32_16x16x32_bf16 v[32:35], v[60:63], a[64:67], v[32:35]
    ds_read_b128 v[68:71], v103 offset:17408
    v_mfma_f32_16x16x32_bf16 v[8:11], v[56:59], a[120:123], v[8:11]
    v_mfma_f32_16x16x32_bf16 v[36:39], v[60:63], a[120:123], v[36:39]
    v_mfma_f32_16x16x32_bf16 v[12:15], v[56:59], a[176:179], v[12:15]
    v_mfma_f32_16x16x32_bf16 v[40:43], v[60:63], a[176:179], v[40:43]
    v_mfma_f32_16x16x32_bf16 v[16:19], v[56:59], a[232:235], v[16:19]
    v_mfma_f32_16x16x32_bf16 v[44:47], v[60:63], a[232:235], v[44:47]
    v_mfma_f32_16x16x32_bf16 v[20:23], v[56:59], v[152:155], v[20:23]
    v_mfma_f32_16x16x32_bf16 v[48:51], v[60:63], v[152:155], v[48:51]
    v_mfma_f32_16x16x32_bf16 v[24:27], v[56:59], v[208:211], v[24:27]
    v_mfma_f32_16x16x32_bf16 v[52:55], v[60:63], v[208:211], v[52:55]
    s_waitcnt lgkmcnt(0)
    v_mfma_f32_16x16x32_bf16 v[0:3], v[64:67], a[12:15], v[0:3]
    v_mfma_f32_16x16x32_bf16 v[28:31], v[68:71], a[12:15], v[28:31]
    v_mfma_f32_16x16x32_bf16 v[4:7], v[64:67], a[68:71], v[4:7]
    ds_read_b128 v[56:59], v103 offset:4096
    v_mfma_f32_16x16x32_bf16 v[32:35], v[68:71], a[68:71], v[32:35]
    ds_read_b128 v[60:63], v103 offset:18432
    v_mfma_f32_16x16x32_bf16 v[8:11], v[64:67], a[124:127], v[8:11]
    v_mfma_f32_16x16x32_bf16 v[36:39], v[68:71], a[124:127], v[36:39]
    v_mfma_f32_16x16x32_bf16 v[12:15], v[64:67], a[180:183], v[12:15]
    v_mfma_f32_16x16x32_bf16 v[40:43], v[68:71], a[180:183], v[40:43]
    v_mfma_f32_16x16x32_bf16 v[16:19], v[64:67], a[236:239], v[16:19]
    v_mfma_f32_16x16x32_bf16 v[44:47], v[68:71], a[236:239], v[44:47]
    v_mfma_f32_16x16x32_bf16 v[20:23], v[64:67], v[156:159], v[20:23]
    v_mfma_f32_16x16x32_bf16 v[48:51], v[68:71], v[156:159], v[48:51]
    v_mfma_f32_16x16x32_bf16 v[24:27], v[64:67], v[212:215], v[24:27]
    v_mfma_f32_16x16x32_bf16 v[52:55], v[68:71], v[212:215], v[52:55]
    s_waitcnt lgkmcnt(0)
    v_mfma_f32_16x16x32_bf16 v[0:3], v[56:59], a[16:19], v[0:3]
    v_mfma_f32_16x16x32_bf16 v[28:31], v[60:63], a[16:19], v[28:31]
    v_mfma_f32_16x16x32_bf16 v[4:7], v[56:59], a[72:75], v[4:7]
    ds_read_b128 v[64:67], v103 offset:5120
    v_mfma_f32_16x16x32_bf16 v[32:35], v[60:63], a[72:75], v[32:35]
    ds_read_b128 v[68:71], v103 offset:19456
    v_mfma_f32_16x16x32_bf16 v[8:11], v[56:59], a[128:131], v[8:11]
    v_mfma_f32_16x16x32_bf16 v[36:39], v[60:63], a[128:131], v[36:39]
    v_mfma_f32_16x16x32_bf16 v[12:15], v[56:59], a[184:187], v[12:15]
    v_mfma_f32_16x16x32_bf16 v[40:43], v[60:63], a[184:187], v[40:43]
    v_mfma_f32_16x16x32_bf16 v[16:19], v[56:59], a[240:243], v[16:19]
    v_mfma_f32_16x16x32_bf16 v[44:47], v[60:63], a[240:243], v[44:47]
    v_mfma_f32_16x16x32_bf16 v[20:23], v[56:59], v[160:163], v[20:23]
    v_mfma_f32_16x16x32_bf16 v[48:51], v[60:63], v[160:163], v[48:51]
    v_mfma_f32_16x16x32_bf16 v[24:27], v[56:59], v[216:219], v[24:27]
    v_mfma_f32_16x16x32_bf16 v[52:55], v[60:63], v[216:219], v[52:55]
    s_waitcnt lgkmcnt(0)
    v_mfma_f32_16x16x32_bf16 v[0:3], v[64:67], a[20:23], v[0:3]
    v_mfma_f32_16x16x32_bf16 v[28:31], v[68:71], a[20:23], v[28:31]
    v_mfma_f32_16x16x32_bf16 v[4:7], v[64:67], a[76:79], v[4:7]
    ds_read_b128 v[56:59], v103 offset:6144
    v_mfma_f32_16x16x32_bf16 v[32:35], v[68:71], a[76:79], v[32:35]
    ds_read_b128 v[60:63], v103 offset:20480
    v_mfma_f32_16x16x32_bf16 v[8:11], v[64:67], a[132:135], v[8:11]
    v_mfma_f32_16x16x32_bf16 v[36:39], v[68:71], a[132:135], v[36:39]
    v_mfma_f32_16x16x32_bf16 v[12:15], v[64:67], a[188:191], v[12:15]
    v_mfma_f32_16x16x32_bf16 v[40:43], v[68:71], a[188:191], v[40:43]
    v_mfma_f32_16x16x32_bf16 v[16:19], v[64:67], a[244:247], v[16:19]
    v_mfma_f32_16x16x32_bf16 v[44:47], v[68:71], a[244:247], v[44:47]
    v_mfma_f32_16x16x32_bf16 v[20:23], v[64:67], v[164:167], v[20:23]
    v_mfma_f32_16x16x32_bf16 v[48:51], v[68:71], v[164:167], v[48:51]
    v_mfma_f32_16x16x32_bf16 v[24:27], v[64:67], v[220:223], v[24:27]
    v_mfma_f32_16x16x32_bf16 v[52:55], v[68:71], v[220:223], v[52:55]
    s_waitcnt lgkmcnt(0)
    v_mfma_f32_16x16x32_bf16 v[0:3], v[56:59], a[24:27], v[0:3]
    v_mfma_f32_16x16x32_bf16 v[28:31], v[60:63], a[24:27], v[28:31]
    v_mfma_f32_16x16x32_bf16 v[4:7], v[56:59], a[80:83], v[4:7]
    ds_read_b128 v[64:67], v103 offset:7168
    v_mfma_f32_16x16x32_bf16 v[32:35], v[60:63], a[80:83], v[32:35]
    ds_read_b128 v[68:71], v103 offset:21504
    v_mfma_f32_16x16x32_bf16 v[8:11], v[56:59], a[136:139], v[8:11]
    v_mfma_f32_16x16x32_bf16 v[36:39], v[60:63], a[136:139], v[36:39]
    v_mfma_f32_16x16x32_bf16 v[12:15], v[56:59], a[192:195], v[12:15]
    v_mfma_f32_16x16x32_bf16 v[40:43], v[60:63], a[192:195], v[40:43]
    v_mfma_f32_16x16x32_bf16 v[16:19], v[56:59], a[248:251], v[16:19]
    v_mfma_f32_16x16x32_bf16 v[44:47], v[60:63], a[248:251], v[44:47]
    v_mfma_f32_16x16x32_bf16 v[20:23], v[56:59], v[168:171], v[20:23]
    v_mfma_f32_16x16x32_bf16 v[48:51], v[60:63], v[168:171], v[48:51]
    v_mfma_f32_16x16x32_bf16 v[24:27], v[56:59], v[224:227], v[24:27]
    v_mfma_f32_16x16x32_bf16 v[52:55], v[60:63], v[224:227], v[52:55]
    s_waitcnt lgkmcnt(0)
    v_mfma_f32_16x16x32_bf16 v[0:3], v[64:67], a[28:31], v[0:3]
    v_mfma_f32_16x16x32_bf16 v[28:31], v[68:71], a[28:31], v[28:31]
    v_mfma_f32_16x16x32_bf16 v[4:7], v[64:67], a[84:87], v[4:7]
    ds_read_b128 v[56:59], v103 offset:8192
    v_mfma_f32_16x16x32_bf16 v[32:35], v[68:71], a[84:87], v[32:35]
    ds_read_b128 v[60:63], v103 offset:22528
    v_mfma_f32_16x16x32_bf16 v[8:11], v[64:67], a[140:143], v[8:11]
    v_mfma_f32_16x16x32_bf16 v[36:39], v[68:71], a[140:143], v[36:39]
    v_mfma_f32_16x16x32_bf16 v[12:15], v[64:67], a[196:199], v[12:15]
    v_mfma_f32_16x16x32_bf16 v[40:43], v[68:71], a[196:199], v[40:43]
    v_mfma_f32_16x16x32_bf16 v[16:19], v[64:67], a[252:255], v[16:19]
    v_mfma_f32_16x16x32_bf16 v[44:47], v[68:71], a[252:255], v[44:47]
    v_mfma_f32_16x16x32_bf16 v[20:23], v[64:67], v[172:175], v[20:23]
    v_mfma_f32_16x16x32_bf16 v[48:51], v[68:71], v[172:175], v[48:51]
    v_mfma_f32_16x16x32_bf16 v[24:27], v[64:67], v[228:231], v[24:27]
    v_mfma_f32_16x16x32_bf16 v[52:55], v[68:71], v[228:231], v[52:55]
    s_waitcnt lgkmcnt(0)
    v_mfma_f32_16x16x32_bf16 v[0:3], v[56:59], a[32:35], v[0:3]
    v_mfma_f32_16x16x32_bf16 v[28:31], v[60:63], a[32:35], v[28:31]
    v_mfma_f32_16x16x32_bf16 v[4:7], v[56:59], a[88:91], v[4:7]
    ds_read_b128 v[64:67], v103 offset:9216
    v_mfma_f32_16x16x32_bf16 v[32:35], v[60:63], a[88:91], v[32:35]
    ds_read_b128 v[68:71], v103 offset:23552
    v_mfma_f32_16x16x32_bf16 v[8:11], v[56:59], a[144:147], v[8:11]
    v_mfma_f32_16x16x32_bf16 v[36:39], v[60:63], a[144:147], v[36:39]
    v_mfma_f32_16x16x32_bf16 v[12:15], v[56:59], a[200:203], v[12:15]
    v_mfma_f32_16x16x32_bf16 v[40:43], v[60:63], a[200:203], v[40:43]
    v_mfma_f32_16x16x32_bf16 v[16:19], v[56:59], v[120:123], v[16:19]
    v_mfma_f32_16x16x32_bf16 v[44:47], v[60:63], v[120:123], v[44:47]
    v_mfma_f32_16x16x32_bf16 v[20:23], v[56:59], v[176:179], v[20:23]
    v_mfma_f32_16x16x32_bf16 v[48:51], v[60:63], v[176:179], v[48:51]
    v_mfma_f32_16x16x32_bf16 v[24:27], v[56:59], v[232:235], v[24:27]
    v_mfma_f32_16x16x32_bf16 v[52:55], v[60:63], v[232:235], v[52:55]
    s_waitcnt vmcnt(7)
    v_mov_b32 v72, s19
    s_mov_b64 exec, 1
    buffer_store_dword v72, v104, s[4:7], s30 offen sc1
    s_mov_b64 exec, -1
    s_waitcnt lgkmcnt(0)
    v_mfma_f32_16x16x32_bf16 v[0:3], v[64:67], a[36:39], v[0:3]
    v_mfma_f32_16x16x32_bf16 v[28:31], v[68:71], a[36:39], v[28:31]
    v_mfma_f32_16x16x32_bf16 v[4:7], v[64:67], a[92:95], v[4:7]
    ds_read_b128 v[56:59], v103 offset:10240
    v_mfma_f32_16x16x32_bf16 v[32:35], v[68:71], a[92:95], v[32:35]
    ds_read_b128 v[60:63], v103 offset:24576
    v_mfma_f32_16x16x32_bf16 v[8:11], v[64:67], a[148:151], v[8:11]
    v_mfma_f32_16x16x32_bf16 v[36:39], v[68:71], a[148:151], v[36:39]
    v_mfma_f32_16x16x32_bf16 v[12:15], v[64:67], a[204:207], v[12:15]
    v_mfma_f32_16x16x32_bf16 v[40:43], v[68:71], a[204:207], v[40:43]
    v_mfma_f32_16x16x32_bf16 v[16:19], v[64:67], v[124:127], v[16:19]
    v_mfma_f32_16x16x32_bf16 v[44:47], v[68:71], v[124:127], v[44:47]
    v_mfma_f32_16x16x32_bf16 v[20:23], v[64:67], v[180:183], v[20:23]
    v_mfma_f32_16x16x32_bf16 v[48:51], v[68:71], v[180:183], v[48:51]
    v_mfma_f32_16x16x32_bf16 v[24:27], v[64:67], v[236:239], v[24:27]
    v_mfma_f32_16x16x32_bf16 v[52:55], v[68:71], v[236:239], v[52:55]
    s_waitcnt lgkmcnt(0)
    v_mfma_f32_16x16x32_bf16 v[0:3], v[56:59], a[40:43], v[0:3]
    v_mfma_f32_16x16x32_bf16 v[28:31], v[60:63], a[40:43], v[28:31]
    v_mfma_f32_16x16x32_bf16 v[4:7], v[56:59], a[96:99], v[4:7]
    ds_read_b128 v[64:67], v103 offset:11264
    v_mfma_f32_16x16x32_bf16 v[32:35], v[60:63], a[96:99], v[32:35]
    ds_read_b128 v[68:71], v103 offset:25600
    v_mfma_f32_16x16x32_bf16 v[8:11], v[56:59], a[152:155], v[8:11]
    v_mfma_f32_16x16x32_bf16 v[36:39], v[60:63], a[152:155], v[36:39]
    v_mfma_f32_16x16x32_bf16 v[12:15], v[56:59], a[208:211], v[12:15]
    v_mfma_f32_16x16x32_bf16 v[40:43], v[60:63], a[208:211], v[40:43]
    v_mfma_f32_16x16x32_bf16 v[16:19], v[56:59], v[128:131], v[16:19]
    v_mfma_f32_16x16x32_bf16 v[44:47], v[60:63], v[128:131], v[44:47]
    v_mfma_f32_16x16x32_bf16 v[20:23], v[56:59], v[184:187], v[20:23]
    v_mfma_f32_16x16x32_bf16 v[48:51], v[60:63], v[184:187], v[48:51]
    v_mfma_f32_16x16x32_bf16 v[24:27], v[56:59], v[240:243], v[24:27]
    v_mfma_f32_16x16x32_bf16 v[52:55], v[60:63], v[240:243], v[52:55]
    s_waitcnt lgkmcnt(0)
    v_mfma_f32_16x16x32_bf16 v[0:3], v[64:67], a[44:47], v[0:3]
    v_mfma_f32_16x16x32_bf16 v[28:31], v[68:71], a[44:47], v[28:31]
    v_mfma_f32_16x16x32_bf16 v[4:7], v[64:67], a[100:103], v[4:7]
    ds_read_b128 v[56:59], v103 offset:12288
    v_mfma_f32_16x16x32_bf16 v[32:35], v[68:71], a[100:103], v[32:35]
    ds_read_b128 v[60:63], v103 offset:26624
    v_mfma_f32_16x16x32_bf16 v[8:11], v[64:67], a[156:159], v[8:11]
    v_mfma_f32_16x16x32_bf16 v[36:39], v[68:71], a[156:159], v[36:39]
    v_mfma_f32_16x16x32_bf16 v[12:15], v[64:67], a[212:215], v[12:15]
    v_mfma_f32_16x16x32_bf16 v[40:43], v[68:71], a[212:215], v[40:43]
    v_mfma_f32_16x16x32_bf16 v[16:19], v[64:67], v[132:135], v[16:19]
    v_mfma_f32_16x16x32_bf16 v[44:47], v[68:71], v[132:135], v[44:47]
    v_mfma_f32_16x16x32_bf16 v[20:23], v[64:67], v[188:191], v[20:23]
    v_mfma_f32_16x16x32_bf16 v[48:51], v[68:71], v[188:191], v[48:51]
    v_mfma_f32_16x16x32_bf16 v[24:27], v[64:67], v[244:247], v[24:27]
    v_mfma_f32_16x16x32_bf16 v[52:55], v[68:71], v[244:247], v[52:55]
    s_waitcnt lgkmcnt(0)
    v_mfma_f32_16x16x32_bf16 v[0:3], v[56:59], a[48:51], v[0:3]
    v_mfma_f32_16x16x32_bf16 v[28:31], v[60:63], a[48:51], v[28:31]
    v_mfma_f32_16x16x32_bf16 v[4:7], v[56:59], a[104:107], v[4:7]
    ds_read_b128 v[64:67], v103 offset:13312
    v_mfma_f32_16x16x32_bf16 v[32:35], v[60:63], a[104:107], v[32:35]
    ds_read_b128 v[68:71], v103 offset:27648
    v_mfma_f32_16x16x32_bf16 v[8:11], v[56:59], a[160:163], v[8:11]
    v_mfma_f32_16x16x32_bf16 v[36:39], v[60:63], a[160:163], v[36:39]
    v_mfma_f32_16x16x32_bf16 v[12:15], v[56:59], a[216:219], v[12:15]
    v_mfma_f32_16x16x32_bf16 v[40:43], v[60:63], a[216:219], v[40:43]
    v_mfma_f32_16x16x32_bf16 v[16:19], v[56:59], v[136:139], v[16:19]
    v_mfma_f32_16x16x32_bf16 v[44:47], v[60:63], v[136:139], v[44:47]
    v_mfma_f32_16x16x32_bf16 v[20:23], v[56:59], v[192:195], v[20:23]
    v_mfma_f32_16x16x32_bf16 v[48:51], v[60:63], v[192:195], v[48:51]
    v_mfma_f32_16x16x32_bf16 v[24:27], v[56:59], v[248:251], v[24:27]
    v_mfma_f32_16x16x32_bf16 v[52:55], v[60:63], v[248:251], v[52:55]
    s_waitcnt lgkmcnt(0)
    v_mfma_f32_16x16x32_bf16 v[0:3], v[64:67], a[52:55], v[0:3]
    v_mfma_f32_16x16x32_bf16 v[28:31], v[68:71], a[52:55], v[28:31]
    v_mfma_f32_16x16x32_bf16 v[4:7], v[64:67], a[108:111], v[4:7]
    v_mfma_f32_16x16x32_bf16 v[32:35], v[68:71], a[108:111], v[32:35]
    v_mfma_f32_16x16x32_bf16 v[8:11], v[64:67], a[164:167], v[8:11]
    v_mfma_f32_16x16x32_bf16 v[36:39], v[68:71], a[164:167], v[36:39]
    v_mfma_f32_16x16x32_bf16 v[12:15], v[64:67], a[220:223], v[12:15]
    v_mfma_f32_16x16x32_bf16 v[40:43], v[68:71], a[220:223], v[40:43]
    v_mfma_f32_16x16x32_bf16 v[16:19], v[64:67], v[140:143], v[16:19]
    v_mfma_f32_16x16x32_bf16 v[44:47], v[68:71], v[140:143], v[44:47]
    v_mfma_f32_16x16x32_bf16 v[20:23], v[64:67], v[196:199], v[20:23]
    v_mfma_f32_16x16x32_bf16 v[48:51], v[68:71], v[196:199], v[48:51]
    v_mfma_f32_16x16x32_bf16 v[24:27], v[64:67], v[252:255], v[24:27]
    v_mfma_f32_16x16x32_bf16 v[52:55], v[68:71], v[252:255], v[52:55]
    v_xor_b32 v103, 0x8000, v103
    s_lshl_b32 s24, s14, 19
    s_add_u32 s24, s24, s29
    v_cvt_pk_bf16_f32 v72, v0, v28
    v_cvt_pk_bf16_f32 v73, v1, v29
    v_cvt_pk_bf16_f32 v74, v2, v30
    v_cvt_pk_bf16_f32 v75, v3, v31
    buffer_store_dwordx4 v[72:75], v80, s[4:7], s24 offen sc1
    v_cvt_pk_bf16_f32 v76, v4, v32
    v_cvt_pk_bf16_f32 v77, v5, v33
    v_cvt_pk_bf16_f32 v78, v6, v34
    v_cvt_pk_bf16_f32 v79, v7, v35
    buffer_store_dwordx4 v[76:79], v81, s[4:7], s24 offen sc1
    v_cvt_pk_bf16_f32 v72, v8, v36
    v_cvt_pk_bf16_f32 v73, v9, v37
    v_cvt_pk_bf16_f32 v74, v10, v38
    v_cvt_pk_bf16_f32 v75, v11, v39
    buffer_store_dwordx4 v[72:75], v82, s[4:7], s24 offen sc1
    v_cvt_pk_bf16_f32 v76, v12, v40
    v_cvt_pk_bf16_f32 v77, v13, v41
    v_cvt_pk_bf16_f32 v78, v14, v42
    v_cvt_pk_bf16_f32 v79, v15, v43
    buffer_store_dwordx4 v[76:79], v83, s[4:7], s24 offen sc1
    v_cvt_pk_bf16_f32 v72, v16, v44
    v_cvt_pk_bf16_f32 v73, v17, v45
    v_cvt_pk_bf16_f32 v74, v18, v46
    v_cvt_pk_bf16_f32 v75, v19, v47
    buffer_store_dwordx4 v[72:75], v84, s[4:7], s24 offen sc1
    v_cvt_pk_bf16_f32 v76, v20, v48
    v_cvt_pk_bf16_f32 v77, v21, v49
    v_cvt_pk_bf16_f32 v78, v22, v50
    v_cvt_pk_bf16_f32 v79, v23, v51
    buffer_store_dwordx4 v[76:79], v85, s[4:7], s24 offen sc1
    v_cvt_pk_bf16_f32 v72, v24, v52
    v_cvt_pk_bf16_f32 v73, v25, v53
    v_cvt_pk_bf16_f32 v74, v26, v54
    v_cvt_pk_bf16_f32 v75, v27, v55
    buffer_store_dwordx4 v[72:75], v86, s[4:7], s24 offen sc1
    s_add_u32 s19, s19, 1
    s_cmp_lg_u32 s19, 1
    s_cbranch_scc1 L_Ong_85
    s_waitcnt vmcnt(0)
    v_mov_b32 v72, s19
    s_mov_b64 exec, 1
    buffer_store_dword v72, v104, s[4:7], s30 offen sc1
    s_mov_b64 exec, -1
    s_cmp_lg_u32 s12, 0
    s_cbranch_scc1 L_g_86
    s_mov_b32 s20, 0x20000
    v_mov_b32 v10, 0
L_wd_87:
    global_load_dword v11, v10, s[40:41] offset:136 sc1
    s_waitcnt vmcnt(0)
    v_cmp_gt_u32 vcc, 32, v11
    s_cbranch_vccz L_wdd_88
    s_sleep 16
    s_sub_u32 s20, s20, 1
    s_cbranch_scc0 L_wd_87
    s_branch L_fin
L_wdd_88:
L_g_86:
    s_barrier
L_Ong_85:
    s_mov_b32 s14, s28
    s_cmp_lt_u32 s14, 64
    s_cbranch_scc1 L_O1_84
    s_waitcnt vmcnt(0)
    v_mov_b32 v72, s19
    s_mov_b64 exec, 1
    buffer_store_dword v72, v104, s[4:7], s30 offen sc1
    s_mov_b64 exec, -1
    v_and_b32 v21, 15, v119
    v_lshrrev_b32 v22, 4, v119
    s_load_dwordx2 s[32:33], s[0:1], 24
    s_mov_b32 s34, 401408
    s_mov_b32 s35, 0x20000
    s_waitcnt lgkmcnt(0)
    v_mul_u32_u24 v6, 3584, v22
    v_lshl_add_u32 v6, v21, 1, v6
    v_mov_b32 v8, 1073741824
    v_cmp_gt_u32 vcc, 3, v22
    s_nop 1
    v_cndmask_b32 v7, v8, v6, vcc
    s_mul_i32 s24, s12, 100352
    s_mul_i32 s25, s17, 56
    s_add_u32 s24, s24, s25
    s_lshl_b32 s21, s12, 13
    s_add_u32 s21, s21, 65536
    v_add_u32 v9, s21, v101
    s_add_u32 s25, s24, 0
    buffer_load_ushort v24, v6, s[32:35], s25 offen offset:0
    buffer_load_ushort v56, v6, s[32:35], s25 offen offset:896
    buffer_load_ushort v25, v6, s[32:35], s25 offen offset:1792
    buffer_load_ushort v57, v6, s[32:35], s25 offen offset:2688
    buffer_load_ushort v40, v6, s[32:35], s25 offen offset:28
    buffer_load_ushort v72, v6, s[32:35], s25 offen offset:924
    buffer_load_ushort v41, v6, s[32:35], s25 offen offset:1820
    buffer_load_ushort v73, v6, s[32:35], s25 offen offset:2716
    s_add_u32 s25, s24, 14336
    buffer_load_ushort v26, v7, s[32:35], s25 offen offset:0
    buffer_load_ushort v58, v7, s[32:35], s25 offen offset:896
    buffer_load_ushort v27, v7, s[32:35], s25 offen offset:1792
    buffer_load_ushort v59, v7, s[32:35], s25 offen offset:2688
    buffer_load_ushort v42, v7, s[32:35], s25 offen offset:28
    buffer_load_ushort v74, v7, s[32:35], s25 offen offset:924
    buffer_load_ushort v43, v7, s[32:35], s25 offen offset:1820
    buffer_load_ushort v75, v7, s[32:35], s25 offen offset:2716
    s_add_u32 s25, s24, 25088
    buffer_load_ushort v28, v6, s[32:35], s25 offen offset:0
    buffer_load_ushort v60, v6, s[32:35], s25 offen offset:896
    buffer_load_ushort v29, v6, s[32:35], s25 offen offset:1792
    buffer_load_ushort v61, v6, s[32:35], s25 offen offset:2688
    buffer_load_ushort v44, v6, s[32:35], s25 offen offset:28
    buffer_load_ushort v76, v6, s[32:35], s25 offen offset:924
    buffer_load_ushort v45, v6, s[32:35], s25 offen offset:1820
    buffer_load_ushort v77, v6, s[32:35], s25 offen offset:2716
    s_add_u32 s25, s24, 39424
    buffer_load_ushort v30, v7, s[32:35], s25 offen offset:0
    buffer_load_ushort v62, v7, s[32:35], s25 offen offset:896
    buffer_load_ushort v31, v7, s[32:35], s25 offen offset:1792
    buffer_load_ushort v63, v7, s[32:35], s25 offen offset:2688
    buffer_load_ushort v46, v7, s[32:35], s25 offen offset:28
    buffer_load_ushort v78, v7, s[32:35], s25 offen offset:924
    buffer_load_ushort v47, v7, s[32:35], s25 offen offset:1820
    buffer_load_ushort v79, v7, s[32:35], s25 offen offset:2716
    s_waitcnt vmcnt(0)
    s_add_u32 s25, s24, 50176
    buffer_load_ushort v32, v6, s[32:35], s25 offen offset:0
    buffer_load_ushort v64, v6, s[32:35], s25 offen offset:896
    buffer_load_ushort v33, v6, s[32:35], s25 offen offset:1792
    buffer_load_ushort v65, v6, s[32:35], s25 offen offset:2688
    buffer_load_ushort v48, v6, s[32:35], s25 offen offset:28
    buffer_load_ushort v80, v6, s[32:35], s25 offen offset:924
    buffer_load_ushort v49, v6, s[32:35], s25 offen offset:1820
    buffer_load_ushort v81, v6, s[32:35], s25 offen offset:2716
    s_add_u32 s25, s24, 64512
    buffer_load_ushort v34, v7, s[32:35], s25 offen offset:0
    buffer_load_ushort v66, v7, s[32:35], s25 offen offset:896
    buffer_load_ushort v35, v7, s[32:35], s25 offen offset:1792
    buffer_load_ushort v67, v7, s[32:35], s25 offen offset:2688
    buffer_load_ushort v50, v7, s[32:35], s25 offen offset:28
    buffer_load_ushort v82, v7, s[32:35], s25 offen offset:924
    buffer_load_ushort v51, v7, s[32:35], s25 offen offset:1820
    buffer_load_ushort v83, v7, s[32:35], s25 offen offset:2716
    s_add_u32 s25, s24, 75264
    buffer_load_ushort v36, v6, s[32:35], s25 offen offset:0
    buffer_load_ushort v68, v6, s[32:35], s25 offen offset:896
    buffer_load_ushort v37, v6, s[32:35], s25 offen offset:1792
    buffer_load_ushort v69, v6, s[32:35], s25 offen offset:2688
    buffer_load_ushort v52, v6, s[32:35], s25 offen offset:28
    buffer_load_ushort v84, v6, s[32:35], s25 offen offset:924
    buffer_load_ushort v53, v6, s[32:35], s25 offen offset:1820
    buffer_load_ushort v85, v6, s[32:35], s25 offen offset:2716
    s_add_u32 s25, s24, 89600
    buffer_load_ushort v38, v7, s[32:35], s25 offen offset:0
    buffer_load_ushort v70, v7, s[32:35], s25 offen offset:896
    buffer_load_ushort v39, v7, s[32:35], s25 offen offset:1792
    buffer_load_ushort v71, v7, s[32:35], s25 offen offset:2688
    buffer_load_ushort v54, v7, s[32:35], s25 offen offset:28
    buffer_load_ushort v86, v7, s[32:35], s25 offen offset:924
    buffer_load_ushort v55, v7, s[32:35], s25 offen offset:1820
    buffer_load_ushort v87, v7, s[32:35], s25 offen offset:2716
    s_waitcnt vmcnt(0)
    v_lshl_or_b32 v24, v56, 16, v24
    v_lshl_or_b32 v25, v57, 16, v25
    v_lshl_or_b32 v26, v58, 16, v26
    v_lshl_or_b32 v27, v59, 16, v27
    v_lshl_or_b32 v28, v60, 16, v28
    v_lshl_or_b32 v29, v61, 16, v29
    v_lshl_or_b32 v30, v62, 16, v30
    v_lshl_or_b32 v31, v63, 16, v31
    v_lshl_or_b32 v32, v64, 16, v32
    v_lshl_or_b32 v33, v65, 16, v33
    v_lshl_or_b32 v34, v66, 16, v34
    v_lshl_or_b32 v35, v67, 16, v35
    v_lshl_or_b32 v36, v68, 16, v36
    v_lshl_or_b32 v37, v69, 16, v37
    v_lshl_or_b32 v38, v70, 16, v38
    v_lshl_or_b32 v39, v71, 16, v39
    v_lshl_or_b32 v40, v72, 16, v40
    v_lshl_or_b32 v41, v73, 16, v41
    v_lshl_or_b32 v42, v74, 16, v42
    v_lshl_or_b32 v43, v75, 16, v43
    v_lshl_or_b32 v44, v76, 16, v44
    v_lshl_or_b32 v45, v77, 16, v45
    v_lshl_or_b32 v46, v78, 16, v46
    v_lshl_or_b32 v47, v79, 16, v47
    v_lshl_or_b32 v48, v80, 16, v48
    v_lshl_or_b32 v49, v81, 16, v49
    v_lshl_or_b32 v50, v82, 16, v50
    v_lshl_or_b32 v51, v83, 16, v51
    v_lshl_or_b32 v52, v84, 16, v52
    v_lshl_or_b32 v53, v85, 16, v53
    v_lshl_or_b32 v54, v86, 16, v54
    v_lshl_or_b32 v55, v87, 16, v55
    ds_write_b128 v9, v[24:27] offset:0
    ds_write_b128 v9, v[28:31] offset:1024
    ds_write_b128 v9, v[32:35] offset:2048
    ds_write_b128 v9, v[36:39] offset:3072
    ds_write_b128 v9, v[40:43] offset:4096
    ds_write_b128 v9, v[44:47] offset:5120
    ds_write_b128 v9, v[48:51] offset:6144
    ds_write_b128 v9, v[52:55] offset:7168
    s_load_dwordx2 s[32:33], s[0:1], 96
    s_mov_b32 s34, 1835008
    s_mov_b32 s35, 0x20000
    s_waitcnt lgkmcnt(0)
    s_mov_b32 s20, 0x20000
    v_mov_b32 v10, 0
L_wd_89:
    global_load_dword v11, v10, s[40:41] offset:4 sc1
    s_waitcnt vmcnt(0)
    v_cmp_gt_u32 vcc, 16, v11
    s_cbranch_vccz L_wdd_90
    s_sleep 2
    s_sub_u32 s20, s20, 1
    s_cbranch_scc0 L_wd_89
    s_branch L_fin
L_wdd_90:
    s_mov_b32 s20, 0x20000
    v_mov_b32 v10, 0
L_wd_91:
    global_load_dword v11, v10, s[40:41] offset:132 sc1
    s_waitcnt vmcnt(0)
    v_cmp_gt_u32 vcc, 64, v11
    s_cbranch_vccz L_wdd_92
    s_sleep 2
    s_sub_u32 s20, s20, 1
    s_cbranch_scc0 L_wd_91
    s_branch L_fin
L_wdd_92:
    s_mov_b32 s14, s18
L_O2_93:
    s_lshr_b32 s24, s14, 2
    s_lshl_b32 s24, s24, 6
    s_add_u32 s21, s24, 59773952
    s_and_b32 s22, s14, 3
    s_add_u32 s22, s22, 1
    s_mov_b32 s20, 0x20000
    v_lshlrev_b32 v118, 2, v119
    v_cmp_gt_u32 s[42:43], 16, v119
L_wf_94:
    buffer_load_dword v114, v118, s[4:7], s21 offen sc1
    s_waitcnt vmcnt(0)
    v_cmp_gt_u32 vcc, s22, v114
    s_nop 0
    s_and_b64 vcc, vcc, s[42:43]
    s_cbranch_scc0 L_wfd_95
    s_sleep 8
    s_sub_u32 s20, s20, 1
    s_cbranch_scc0 L_wf_94
    s_branch L_fin
L_wfd_95:
    s_lshl_b32 s21, s14, 15
    s_lshl_b32 s24, s12, 13
    s_add_u32 s21, s21, s24
    s_add_u32 s21, s21, 56623104
    s_add_u32 s22, s21, 4096
    s_lshl_b32 s31, s14, 7
    s_add_u32 s31, s31, 58720256
    s_lshl_b32 s24, s12, 13
    s_add_u32 s24, s24, 65536
    v_add_u32 v114, s24, v101
    buffer_load_dwordx4 v[0:3], v101, s[4:7], s21 offen offset:0 sc1
    buffer_load_dwordx4 v[4:7], v101, s[4:7], s21 offen offset:1024 sc1
    buffer_load_dwordx4 v[8:11], v101, s[4:7], s21 offen offset:2048 sc1
    buffer_load_dwordx4 v[12:15], v101, s[4:7], s21 offen offset:3072 sc1
    buffer_load_dwordx4 v[16:19], v101, s[4:7], s22 offen offset:0 sc1
    buffer_load_dwordx4 v[20:23], v101, s[4:7], s22 offen offset:1024 sc1
    buffer_load_dwordx4 v[24:27], v101, s[4:7], s22 offen offset:2048 sc1
    buffer_load_dwordx4 v[28:31], v101, s[4:7], s22 offen offset:3072 sc1
    buffer_load_dwordx2 v[96:97], v109, s[4:7], s31 offen sc1
    ds_read_b128 v[56:59], v114 offset:0
    ds_read_b128 v[60:63], v114 offset:1024
    ds_read_b128 v[64:67], v114 offset:2048
    ds_read_b128 v[68:71], v114 offset:3072
    ds_read_b128 v[72:75], v114 offset:4096
    ds_read_b128 v[76:79], v114 offset:5120
    ds_read_b128 v[80:83], v114 offset:6144
    ds_read_b128 v[84:87], v114 offset:7168
    s_waitcnt vmcnt(0) lgkmcnt(0)
    v_mfma_f32_16x16x32_bf16 v[40:43], v[56:59], v[0:3], 0
    v_mfma_f32_16x16x32_bf16 v[44:47], v[72:75], v[0:3], 0
    v_mfma_f32_16x16x32_bf16 v[48:51], v[56:59], v[4:7], 0
    v_mfma_f32_16x16x32_bf16 v[52:55], v[72:75], v[4:7], 0
    v_mfma_f32_16x16x32_bf16 v[40:43], v[60:63], v[8:11], v[40:43]
    v_mfma_f32_16x16x32_bf16 v[44:47], v[76:79], v[8:11], v[44:47]
    v_mfma_f32_16x16x32_bf16 v[48:51], v[60:63], v[12:15], v[48:51]
    v_mfma_f32_16x16x32_bf16 v[52:55], v[76:79], v[12:15], v[52:55]
    v_mfma_f32_16x16x32_bf16 v[40:43], v[64:67], v[16:19], v[40:43]
    v_mfma_f32_16x16x32_bf16 v[44:47], v[80:83], v[16:19], v[44:47]
    v_mfma_f32_16x16x32_bf16 v[48:51], v[64:67], v[20:23], v[48:51]
    v_mfma_f32_16x16x32_bf16 v[52:55], v[80:83], v[20:23], v[52:55]
    v_mfma_f32_16x16x32_bf16 v[40:43], v[68:71], v[24:27], v[40:43]
    v_mfma_f32_16x16x32_bf16 v[44:47], v[84:87], v[24:27], v[44:47]
    v_mfma_f32_16x16x32_bf16 v[48:51], v[68:71], v[28:31], v[48:51]
    v_mfma_f32_16x16x32_bf16 v[52:55], v[84:87], v[28:31], v[52:55]
    s_lshl_b32 s21, s14, 19
    s_add_u32 s21, s21, s29
    s_add_u32 s22, s21, 4096
    s_lshl_b32 s24, s12, 12
    v_add_u32 v114, s24, v112
    v_mul_f32 v40, v96, v40
    v_mul_f32 v41, v96, v41
    v_mul_f32 v42, v96, v42
    v_mul_f32 v43, v96, v43
    ds_write_b128 v114, v[40:43] offset:0
    v_mul_f32 v44, v96, v44
    v_mul_f32 v45, v96, v45
    v_mul_f32 v46, v96, v46
    v_mul_f32 v47, v96, v47
    ds_write_b128 v114, v[44:47] offset:1024
    v_mul_f32 v48, v97, v48
    v_mul_f32 v49, v97, v49
    v_mul_f32 v50, v97, v50
    v_mul_f32 v51, v97, v51
    ds_write_b128 v114, v[48:51] offset:2048
    v_mul_f32 v52, v97, v52
    v_mul_f32 v53, v97, v53
    v_mul_f32 v54, v97, v54
    v_mul_f32 v55, v97, v55
    ds_write_b128 v114, v[52:55] offset:3072
    buffer_load_dwordx4 v[56:59], v101, s[4:7], s21 offen offset:0 sc1
    buffer_load_dwordx4 v[60:63], v101, s[4:7], s21 offen offset:1024 sc1
    buffer_load_dwordx4 v[64:67], v101, s[4:7], s21 offen offset:2048 sc1
    buffer_load_dwordx4 v[68:71], v101, s[4:7], s21 offen offset:3072 sc1
    buffer_load_dwordx4 v[72:75], v101, s[4:7], s22 offen offset:0 sc1
    buffer_load_dwordx4 v[76:79], v101, s[4:7], s22 offen offset:1024 sc1
    buffer_load_dwordx4 v[80:83], v101, s[4:7], s22 offen offset:2048 sc1
    buffer_load_dwordx4 v[84:87], v101, s[4:7], s22 offen offset:3072 sc1
    v_sub_f32 v96, 1.0, v96
    v_sub_f32 v97, 1.0, v97
    s_mul_i32 s28, s14, 69632
    s_add_u32 s21, s28, 50352128
    s_add_u32 s22, s21, 4096
    s_mov_b32 s20, 0x20000
L_ps_96:
    buffer_load_dwordx4 v[0:3], v101, s[4:7], s21 offen offset:0 sc1
    buffer_load_dwordx4 v[4:7], v101, s[4:7], s21 offen offset:1024 sc1
    buffer_load_dwordx4 v[8:11], v101, s[4:7], s21 offen offset:2048 sc1
    buffer_load_dwordx4 v[12:15], v101, s[4:7], s21 offen offset:3072 sc1
    buffer_load_dwordx4 v[16:19], v101, s[4:7], s22 offen offset:0 sc1
    buffer_load_dwordx4 v[20:23], v101, s[4:7], s22 offen offset:1024 sc1
    buffer_load_dwordx4 v[24:27], v101, s[4:7], s22 offen offset:2048 sc1
    s_waitcnt vmcnt(0)
    v_max_u32 v115, v0, v1
    v_max3_u32 v115, v115, v2, v3
    v_max3_u32 v115, v115, v4, v5
    v_max3_u32 v115, v115, v6, v7
    v_max3_u32 v115, v115, v8, v9
    v_max3_u32 v115, v115, v10, v11
    v_max3_u32 v115, v115, v12, v13
    v_max3_u32 v115, v115, v14, v15
    v_max3_u32 v115, v115, v16, v17
    v_max3_u32 v115, v115, v18, v19
    v_max3_u32 v115, v115, v20, v21
    v_max3_u32 v115, v115, v22, v23
    v_max3_u32 v115, v115, v24, v25
    v_max3_u32 v115, v115, v26, v27
    v_cmp_eq_u32 vcc, -1, v115
    s_cbranch_vccz L_psd_97
    s_sleep 4
    s_sub_u32 s20, s20, 1
    s_cbranch_scc0 L_ps_96
    s_branch L_fin
L_psd_97:
    v_mov_b32 v28, 0
    v_mov_b32 v29, 0
    v_mov_b32 v30, 0
    v_mov_b32 v31, 0
    s_nop 1
    v_smfmac_f32_16x16x64_bf16 v[28:31], v[0:3], a[0:7], v100
    v_smfmac_f32_16x16x64_bf16 v[28:31], v[4:7], a[8:15], v100
    v_smfmac_f32_16x16x64_bf16 v[28:31], v[8:11], a[16:23], v100
    v_smfmac_f32_16x16x64_bf16 v[28:31], v[12:15], a[24:31], v100
    v_smfmac_f32_16x16x64_bf16 v[28:31], v[16:19], a[32:39], v100
    v_smfmac_f32_16x16x64_bf16 v[28:31], v[20:23], a[40:47], v100
    v_smfmac_f32_16x16x64_bf16 v[28:31], v[24:27], a[48:55], v100
    v_mov_b32 v32, 0
    v_mov_b32 v33, 0
    v_mov_b32 v34, 0
    v_mov_b32 v35, 0
    s_nop 1
    v_smfmac_f32_16x16x64_bf16 v[32:35], v[0:3], a[56:63], v100
    v_smfmac_f32_16x16x64_bf16 v[32:35], v[4:7], a[64:71], v100
    v_smfmac_f32_16x16x64_bf16 v[32:35], v[8:11], a[72:79], v100
    v_add_f32 v28, v28, v30
    v_smfmac_f32_16x16x64_bf16 v[32:35], v[12:15], a[80:87], v100
    v_add_f32 v29, v29, v31
    v_smfmac_f32_16x16x64_bf16 v[32:35], v[16:19], a[88:95], v100
    v_cvt_pk_bf16_f32 v28, v28, v29
    v_smfmac_f32_16x16x64_bf16 v[32:35], v[20:23], a[96:103], v100
    ds_write_b32 v106, v28 offset:0
    v_smfmac_f32_16x16x64_bf16 v[32:35], v[24:27], a[104:111], v100
    v_mov_b32 v36, 0
    v_mov_b32 v37, 0
    v_mov_b32 v38, 0
    v_mov_b32 v39, 0
    s_nop 1
    v_smfmac_f32_16x16x64_bf16 v[36:39], v[0:3], a[112:119], v100
    v_smfmac_f32_16x16x64_bf16 v[36:39], v[4:7], a[120:127], v100
    v_smfmac_f32_16x16x64_bf16 v[36:39], v[8:11], a[128:135], v100
    v_add_f32 v32, v32, v34
    v_smfmac_f32_16x16x64_bf16 v[36:39], v[12:15], a[136:143], v100
    v_add_f32 v33, v33, v35
    v_smfmac_f32_16x16x64_bf16 v[36:39], v[16:19], a[144:151], v100
    v_cvt_pk_bf16_f32 v32, v32, v33
    v_smfmac_f32_16x16x64_bf16 v[36:39], v[20:23], a[152:159], v100
    ds_write_b32 v106, v32 offset:256
    v_smfmac_f32_16x16x64_bf16 v[36:39], v[24:27], a[160:167], v100
    v_mov_b32 v28, 0
    v_mov_b32 v29, 0
    v_mov_b32 v30, 0
    v_mov_b32 v31, 0
    s_nop 1
    v_smfmac_f32_16x16x64_bf16 v[28:31], v[0:3], a[168:175], v100
    v_smfmac_f32_16x16x64_bf16 v[28:31], v[4:7], a[176:183], v100
    v_smfmac_f32_16x16x64_bf16 v[28:31], v[8:11], a[184:191], v100
    v_add_f32 v36, v36, v38
    v_smfmac_f32_16x16x64_bf16 v[28:31], v[12:15], a[192:199], v100
    v_add_f32 v37, v37, v39
    v_smfmac_f32_16x16x64_bf16 v[28:31], v[16:19], a[200:207], v100
    v_cvt_pk_bf16_f32 v36, v36, v37
    v_smfmac_f32_16x16x64_bf16 v[28:31], v[20:23], a[208:215], v100
    ds_write_b32 v106, v36 offset:512
    v_smfmac_f32_16x16x64_bf16 v[28:31], v[24:27], a[216:223], v100
    v_mov_b32 v32, 0
    v_mov_b32 v33, 0
    v_mov_b32 v34, 0
    v_mov_b32 v35, 0
    s_nop 1
    v_smfmac_f32_16x16x64_bf16 v[32:35], v[0:3], a[224:231], v100
    v_smfmac_f32_16x16x64_bf16 v[32:35], v[4:7], a[232:239], v100
    v_smfmac_f32_16x16x64_bf16 v[32:35], v[8:11], a[240:247], v100
    v_add_f32 v28, v28, v30
    v_smfmac_f32_16x16x64_bf16 v[32:35], v[12:15], a[248:255], v100
    v_add_f32 v29, v29, v31
    v_smfmac_f32_16x16x64_bf16 v[32:35], v[16:19], v[120:127], v100
    v_cvt_pk_bf16_f32 v28, v28, v29
    v_smfmac_f32_16x16x64_bf16 v[32:35], v[20:23], v[128:135], v100
    ds_write_b32 v106, v28 offset:768
    v_smfmac_f32_16x16x64_bf16 v[32:35], v[24:27], v[136:143], v100
    v_mov_b32 v36, 0
    v_mov_b32 v37, 0
    v_mov_b32 v38, 0
    v_mov_b32 v39, 0
    s_nop 1
    v_smfmac_f32_16x16x64_bf16 v[36:39], v[0:3], v[144:151], v100
    v_smfmac_f32_16x16x64_bf16 v[36:39], v[4:7], v[152:159], v100
    v_smfmac_f32_16x16x64_bf16 v[36:39], v[8:11], v[160:167], v100
    v_add_f32 v32, v32, v34
    v_smfmac_f32_16x16x64_bf16 v[36:39], v[12:15], v[168:175], v100
    v_add_f32 v33, v33, v35
    v_smfmac_f32_16x16x64_bf16 v[36:39], v[16:19], v[176:183], v100
    v_cvt_pk_bf16_f32 v32, v32, v33
    v_smfmac_f32_16x16x64_bf16 v[36:39], v[20:23], v[184:191], v100
    ds_write_b32 v106, v32 offset:1024
    v_smfmac_f32_16x16x64_bf16 v[36:39], v[24:27], v[192:199], v100
    v_mov_b32 v28, 0
    v_mov_b32 v29, 0
    v_mov_b32 v30, 0
    v_mov_b32 v31, 0
    s_nop 1
    v_smfmac_f32_16x16x64_bf16 v[28:31], v[0:3], v[200:207], v100
    v_smfmac_f32_16x16x64_bf16 v[28:31], v[4:7], v[208:215], v100
    v_smfmac_f32_16x16x64_bf16 v[28:31], v[8:11], v[216:223], v100
    v_add_f32 v36, v36, v38
    v_smfmac_f32_16x16x64_bf16 v[28:31], v[12:15], v[224:231], v100
    v_add_f32 v37, v37, v39
    v_smfmac_f32_16x16x64_bf16 v[28:31], v[16:19], v[232:239], v100
    v_cvt_pk_bf16_f32 v36, v36, v37
    v_smfmac_f32_16x16x64_bf16 v[28:31], v[20:23], v[240:247], v100
    ds_write_b32 v106, v36 offset:1280
    v_smfmac_f32_16x16x64_bf16 v[28:31], v[24:27], v[248:255], v100
    s_nop 7
    v_add_f32 v28, v28, v30
    v_add_f32 v29, v29, v31
    v_cvt_pk_bf16_f32 v28, v28, v29
    ds_write_b32 v106, v28 offset:1536
    ds_read_b128 v[88:91], v105
    ds_read_b128 v[92:95], v105 offset:224
    s_add_u32 s21, s28, 50360320
    s_add_u32 s22, s21, 5120
    s_mov_b32 s20, 0x20000
L_ps_98:
    buffer_load_dwordx4 v[0:3], v108, s[4:7], s21 offen offset:1024 sc1
    buffer_load_dwordx4 v[4:7], v107, s[4:7], s21 offen offset:0 sc1
    buffer_load_dwordx4 v[8:11], v107, s[4:7], s22 offen offset:0 sc1
    buffer_load_dwordx4 v[12:15], v107, s[4:7], s21 offen offset:512 sc1
    buffer_load_dwordx4 v[16:19], v107, s[4:7], s22 offen offset:512 sc1
    buffer_load_dwordx4 v[20:23], v108, s[4:7], s21 offen offset:2304 sc1
    buffer_load_dwordx4 v[24:27], v107, s[4:7], s21 offen offset:1280 sc1
    buffer_load_dwordx4 v[28:31], v107, s[4:7], s22 offen offset:1280 sc1
    buffer_load_dwordx4 v[32:35], v107, s[4:7], s21 offen offset:1792 sc1
    buffer_load_dwordx4 v[36:39], v107, s[4:7], s22 offen offset:1792 sc1
    s_waitcnt vmcnt(0)
    v_max_u32 v115, v0, v1
    v_max3_u32 v115, v115, v2, v3
    v_max3_u32 v115, v115, v4, v5
    v_max3_u32 v115, v115, v6, v7
    v_max3_u32 v115, v115, v8, v9
    v_max3_u32 v115, v115, v10, v11
    v_max3_u32 v115, v115, v12, v13
    v_max3_u32 v115, v115, v14, v15
    v_max3_u32 v115, v115, v16, v17
    v_max3_u32 v115, v115, v18, v19
    v_max3_u32 v115, v115, v20, v21
    v_max3_u32 v115, v115, v22, v23
    v_max3_u32 v115, v115, v24, v25
    v_max3_u32 v115, v115, v26, v27
    v_max3_u32 v115, v115, v28, v29
    v_max3_u32 v115, v115, v30, v31
    v_max3_u32 v115, v115, v32, v33
    v_max3_u32 v115, v115, v34, v35
    v_max3_u32 v115, v115, v36, v37
    v_max3_u32 v115, v115, v38, v39
    v_cmp_eq_u32 vcc, -1, v115
    s_cbranch_vccz L_psd_99
    s_sleep 1
    s_sub_u32 s20, s20, 1
    s_cbranch_scc0 L_ps_98
    s_branch L_fin
L_psd_99:
    s_waitcnt lgkmcnt(0)
    v_mfma_f32_16x16x32_bf16 v[40:43], v[88:91], v[0:3], 0
    v_mfma_f32_16x16x32_bf16 v[44:47], v[92:95], v[0:3], 0
    v_mfma_f32_16x16x32_bf16 v[48:51], v[88:91], v[20:23], 0
    v_mfma_f32_16x16x32_bf16 v[52:55], v[92:95], v[20:23], 0
    v_mfma_f32_16x16x32_bf16 v[40:43], v[56:59], v[4:7], v[40:43]
    v_mfma_f32_16x16x32_bf16 v[44:47], v[64:67], v[4:7], v[44:47]
    v_mfma_f32_16x16x32_bf16 v[48:51], v[56:59], v[24:27], v[48:51]
    v_mfma_f32_16x16x32_bf16 v[52:55], v[64:67], v[24:27], v[52:55]
    v_mfma_f32_16x16x32_bf16 v[40:43], v[60:63], v[8:11], v[40:43]
    v_mfma_f32_16x16x32_bf16 v[44:47], v[68:71], v[8:11], v[44:47]
    v_mfma_f32_16x16x32_bf16 v[48:51], v[60:63], v[28:31], v[48:51]
    v_mfma_f32_16x16x32_bf16 v[52:55], v[68:71], v[28:31], v[52:55]
    v_mfma_f32_16x16x32_bf16 v[40:43], v[72:75], v[12:15], v[40:43]
    v_mfma_f32_16x16x32_bf16 v[44:47], v[80:83], v[12:15], v[44:47]
    v_mfma_f32_16x16x32_bf16 v[48:51], v[72:75], v[32:35], v[48:51]
    v_mfma_f32_16x16x32_bf16 v[52:55], v[80:83], v[32:35], v[52:55]
    v_mfma_f32_16x16x32_bf16 v[40:43], v[76:79], v[16:19], v[40:43]
    v_mfma_f32_16x16x32_bf16 v[44:47], v[84:87], v[16:19], v[44:47]
    v_mfma_f32_16x16x32_bf16 v[48:51], v[76:79], v[36:39], v[48:51]
    v_mfma_f32_16x16x32_bf16 v[52:55], v[84:87], v[36:39], v[52:55]
    v_mul_f32 v40, v96, v40
    v_mul_f32 v41, v96, v41
    v_mul_f32 v42, v96, v42
    v_mul_f32 v43, v96, v43
    ds_write_b128 v114, v[40:43] offset:16384
    v_mul_f32 v44, v96, v44
    v_mul_f32 v45, v96, v45
    v_mul_f32 v46, v96, v46
    v_mul_f32 v47, v96, v47
    ds_write_b128 v114, v[44:47] offset:17408
    v_mul_f32 v48, v97, v48
    v_mul_f32 v49, v97, v49
    v_mul_f32 v50, v97, v50
    v_mul_f32 v51, v97, v51
    ds_write_b128 v114, v[48:51] offset:18432
    v_mul_f32 v52, v97, v52
    v_mul_f32 v53, v97, v53
    v_mul_f32 v54, v97, v54
    v_mul_f32 v55, v97, v55
    ds_write_b128 v114, v[52:55] offset:19456
    s_lshl_b32 s24, s12, 10
    v_add_u32 v114, s24, v112
    s_mul_i32 s21, s14, 28672
    s_waitcnt lgkmcnt(0)
    s_barrier
    ds_read_b128 v[0:3], v114 offset:0
    ds_read_b128 v[4:7], v114 offset:4096
    ds_read_b128 v[8:11], v114 offset:8192
    ds_read_b128 v[12:15], v114 offset:12288
    ds_read_b128 v[16:19], v114 offset:16384
    ds_read_b128 v[20:23], v114 offset:20480
    ds_read_b128 v[24:27], v114 offset:24576
    ds_read_b128 v[28:31], v114 offset:28672
    s_waitcnt lgkmcnt(0)
    s_barrier
    v_pk_add_f32 v[0:1], v[0:1], v[16:17]
    v_pk_add_f32 v[2:3], v[2:3], v[18:19]
    v_pk_add_f32 v[4:5], v[4:5], v[20:21]
    v_pk_add_f32 v[6:7], v[6:7], v[22:23]
    v_pk_add_f32 v[8:9], v[8:9], v[24:25]
    v_pk_add_f32 v[10:11], v[10:11], v[26:27]
    v_pk_add_f32 v[12:13], v[12:13], v[28:29]
    v_pk_add_f32 v[14:15], v[14:15], v[30:31]
    v_pk_add_f32 v[0:1], v[0:1], v[8:9]
    v_pk_add_f32 v[2:3], v[2:3], v[10:11]
    v_pk_add_f32 v[4:5], v[4:5], v[12:13]
    v_pk_add_f32 v[6:7], v[6:7], v[14:15]
    v_pk_add_f32 v[0:1], v[0:1], v[4:5]
    v_pk_add_f32 v[2:3], v[2:3], v[6:7]
    v_cvt_pk_bf16_f32 v0, v0, v1
    v_cvt_pk_bf16_f32 v1, v2, v3
    buffer_store_dwordx2 v[0:1], v110, s[32:35], s21 offen sc1
    buffer_store_dword v0, v111, s[32:35], s21 offen sc1
    s_add_u32 s14, s14, 6
    s_cmp_lt_u32 s14, 64
    s_cbranch_scc1 L_O2_93
    s_branch L_fin
L_X:
    v_and_b32 v20, 63, v119
    v_and_b32 v21, 15, v119
    v_bfe_u32 v22, v119, 4, 2
    v_lshlrev_b32 v101, 4, v20
    v_mov_b32 v100, 0x4444
    v_mov_b32 v1, 0xeeee
    v_and_b32 v2, 2, v21
    v_cmp_ne_u32 vcc, 0, v2
    s_nop 1
    v_cndmask_b32 v100, v100, v1, vcc
    s_sub_u32 s24, s13, 128
    s_lshr_b32 s17, s24, 2
    s_and_b32 s18, s24, 3
    v_lshrrev_b32 v6, 2, v20
    v_lshrrev_b32 v7, 5, v20
    v_lshlrev_b32 v7, 1, v7
    v_and_b32 v102, 3, v20
    v_xor_b32 v7, v7, v102
    s_mov_b32 s27, 1792
    v_mul_lo_u32 v102, v6, s27
    v_lshl_add_u32 v102, v7, 4, v102
    v_lshrrev_b32 v6, 3, v21
    v_lshlrev_b32 v6, 1, v6
    v_xor_b32 v6, v6, v22
    v_lshlrev_b32 v103, 6, v21
    v_lshl_add_u32 v103, v6, 4, v103
    s_lshr_b32 s24, s12, 1
    s_mul_i32 s24, s24, 896
    s_and_b32 s25, s12, 1
    s_mul_i32 s25, s25, 448
    s_add_u32 s24, s24, s25
    v_add_u32 v102, s24, v102
    s_mul_i32 s16, s12, 7168
    s_mov_b32 s14, s18
    s_mul_i32 s15, s14, 28672
    s_add_u32 m0, s16, 0
    s_nop 0
    buffer_load_dwordx4 v102, s[8:11], s15 offen offset:0 lds
    s_add_u32 m0, s16, 960
    s_nop 0
    buffer_load_dwordx4 v102, s[8:11], s15 offen offset:64 lds
    s_add_u32 m0, s16, 1920
    s_nop 0
    buffer_load_dwordx4 v102, s[8:11], s15 offen offset:128 lds
    s_add_u32 m0, s16, 2880
    s_nop 0
    buffer_load_dwordx4 v102, s[8:11], s15 offen offset:192 lds
    s_add_u32 m0, s16, 3840
    s_nop 0
    buffer_load_dwordx4 v102, s[8:11], s15 offen offset:256 lds
    s_add_u32 m0, s16, 4800
    s_nop 0
    buffer_load_dwordx4 v102, s[8:11], s15 offen offset:320 lds
    s_add_u32 m0, s16, 5760
    s_nop 0
    buffer_load_dwordx4 v102, s[8:11], s15 offen offset:384 lds
    v_lshrrev_b32 v6, 3, v21
    v_lshlrev_b32 v6, 1, v6
    v_lshrrev_b32 v7, 1, v22
    v_xor_b32 v6, v6, v7
    v_lshlrev_b32 v8, 6, v21
    v_lshl_add_u32 v8, v6, 4, v8
    v_and_b32 v9, 1, v22
    v_lshl_add_u32 v8, v9, 3, v8
    s_and_b32 s24, s12, 1
    s_lshl_b32 s24, s24, 5
    v_xor_b32 v104, s24, v8
    v_xor_b32 v105, 32, v104
    s_mul_i32 s24, s12, 7
    s_lshr_b32 s25, s24, 1
    s_lshl_b32 s25, s25, 10
    v_add_u32 v104, s25, v104
    s_add_u32 s25, s24, 1
    s_lshr_b32 s25, s25, 1
    s_lshl_b32 s25, s25, 10
    v_add_u32 v105, s25, v105
    s_lshl_b32 s24, s12, 11
    s_add_u32 s24, s24, 90112
    v_lshlrev_b32 v106, 2, v22
    v_bfe_u32 v6, v21, 1, 2
    v_lshl_add_u32 v106, v6, 6, v106
    v_and_b32 v6, 1, v21
    v_lshl_add_u32 v106, v6, 4, v106
    v_add_u32 v106, s24, v106
    v_add_u32 v107, 65536, v101
    v_lshlrev_b32 v108, 8, v7
    v_lshl_add_u32 v108, v21, 4, v108
    v_lshl_add_u32 v108, v9, 3, v108
    s_and_b32 s24, s12, 1
    s_lshl_b32 s25, s24, 10
    s_add_u32 s25, s25, 81920
    v_add_u32 v108, s25, v108
    v_lshlrev_b32 v109, 4, v21
    v_lshl_add_u32 v109, v22, 2, v109
    v_lshlrev_b32 v110, 1, v21
    v_add_u32 v110, s24, v110
    v_lshlrev_b32 v6, 3, v22
    v_sub_u32 v110, v110, v6
    s_mov_b32 s20, 0x20000
    v_mov_b32 v10, 0
L_wd_100:
    global_load_dword v11, v10, s[40:41] offset:128 sc1
    s_waitcnt vmcnt(0)
    v_cmp_gt_u32 vcc, 1, v11
    s_cbranch_vccz L_wdd_101
    s_sleep 2
    s_sub_u32 s20, s20, 1
    s_cbranch_scc0 L_wd_100
    s_branch L_fin
L_wdd_101:
    s_lshl_b32 s26, s17, 6
    s_add_u32 s26, s26, 59769856
    s_mov_b32 s20, 0x20000
    v_lshlrev_b32 v14, 2, v20
    v_cmp_gt_u32 s[42:43], 7, v20
L_wf_102:
    buffer_load_dword v10, v14, s[4:7], s26 offen sc1
    s_waitcnt vmcnt(0)
    v_cmp_gt_u32 vcc, 3, v10
    s_nop 0
    s_and_b64 vcc, vcc, s[42:43]
    s_cbranch_scc0 L_wfd_103
    s_sleep 8
    s_sub_u32 s20, s20, 1
    s_cbranch_scc0 L_wf_102
    s_branch L_fin
L_wfd_103:
    s_mul_i32 s24, s17, 401408
    s_lshl_b32 s21, s18, 1
    s_mul_i32 s25, s12, 100352
    s_add_u32 s25, s25, s24
    s_mov_b32 s24, 0
L_lw_104:
    s_cmp_lt_u32 0, s21
    s_cselect_b32 s27, 1, 0
    s_cmp_lg_u32 s27, s24
    s_cbranch_scc1 L_lws_105
    s_add_u32 s26, s25, 0
    buffer_load_dwordx4 a[0:3], v101, s[4:7], s26 offen sc1
    buffer_load_dwordx4 a[4:7], v101, s[4:7], s26 offen offset:1024 sc1
    s_add_u32 s26, s26, 14336
    buffer_load_dwordx4 a[56:59], v101, s[4:7], s26 offen sc1
    buffer_load_dwordx4 a[60:63], v101, s[4:7], s26 offen offset:1024 sc1
    s_add_u32 s26, s26, 14336
    buffer_load_dwordx4 a[112:115], v101, s[4:7], s26 offen sc1
    buffer_load_dwordx4 a[116:119], v101, s[4:7], s26 offen offset:1024 sc1
    s_add_u32 s26, s26, 14336
    buffer_load_dwordx4 a[168:171], v101, s[4:7], s26 offen sc1
    buffer_load_dwordx4 a[172:175], v101, s[4:7], s26 offen offset:1024 sc1
    s_add_u32 s26, s26, 14336
    buffer_load_dwordx4 a[224:227], v101, s[4:7], s26 offen sc1
    buffer_load_dwordx4 a[228:231], v101, s[4:7], s26 offen offset:1024 sc1
    s_add_u32 s26, s26, 14336
    buffer_load_dwordx4 v[144:147], v101, s[4:7], s26 offen sc1
    buffer_load_dwordx4 v[148:151], v101, s[4:7], s26 offen offset:1024 sc1
    s_add_u32 s26, s26, 14336
    buffer_load_dwordx4 v[200:203], v101, s[4:7], s26 offen sc1
    buffer_load_dwordx4 v[204:207], v101, s[4:7], s26 offen offset:1024 sc1
L_lws_105:
    s_cmp_lt_u32 1, s21
    s_cselect_b32 s27, 1, 0
    s_cmp_lg_u32 s27, s24
    s_cbranch_scc1 L_lws_106
    s_add_u32 s26, s25, 2048
    buffer_load_dwordx4 a[8:11], v101, s[4:7], s26 offen sc1
    buffer_load_dwordx4 a[12:15], v101, s[4:7], s26 offen offset:1024 sc1
    s_add_u32 s26, s26, 14336
    buffer_load_dwordx4 a[64:67], v101, s[4:7], s26 offen sc1
    buffer_load_dwordx4 a[68:71], v101, s[4:7], s26 offen offset:1024 sc1
    s_add_u32 s26, s26, 14336
    buffer_load_dwordx4 a[120:123], v101, s[4:7], s26 offen sc1
    buffer_load_dwordx4 a[124:127], v101, s[4:7], s26 offen offset:1024 sc1
    s_add_u32 s26, s26, 14336
    buffer_load_dwordx4 a[176:179], v101, s[4:7], s26 offen sc1
    buffer_load_dwordx4 a[180:183], v101, s[4:7], s26 offen offset:1024 sc1
    s_add_u32 s26, s26, 14336
    buffer_load_dwordx4 a[232:235], v101, s[4:7], s26 offen sc1
    buffer_load_dwordx4 a[236:239], v101, s[4:7], s26 offen offset:1024 sc1
    s_add_u32 s26, s26, 14336
    buffer_load_dwordx4 v[152:155], v101, s[4:7], s26 offen sc1
    buffer_load_dwordx4 v[156:159], v101, s[4:7], s26 offen offset:1024 sc1
    s_add_u32 s26, s26, 14336
    buffer_load_dwordx4 v[208:211], v101, s[4:7], s26 offen sc1
    buffer_load_dwordx4 v[212:215], v101, s[4:7], s26 offen offset:1024 sc1
L_lws_106:
    s_cmp_lt_u32 2, s21
    s_cselect_b32 s27, 1, 0
    s_cmp_lg_u32 s27, s24
    s_cbranch_scc1 L_lws_107
    s_add_u32 s26, s25, 4096
    buffer_load_dwordx4 a[16:19], v101, s[4:7], s26 offen sc1
    buffer_load_dwordx4 a[20:23], v101, s[4:7], s26 offen offset:1024 sc1
    s_add_u32 s26, s26, 14336
    buffer_load_dwordx4 a[72:75], v101, s[4:7], s26 offen sc1
    buffer_load_dwordx4 a[76:79], v101, s[4:7], s26 offen offset:1024 sc1
    s_add_u32 s26, s26, 14336
    buffer_load_dwordx4 a[128:131], v101, s[4:7], s26 offen sc1
    buffer_load_dwordx4 a[132:135], v101, s[4:7], s26 offen offset:1024 sc1
    s_add_u32 s26, s26, 14336
    buffer_load_dwordx4 a[184:187], v101, s[4:7], s26 offen sc1
    buffer_load_dwordx4 a[188:191], v101, s[4:7], s26 offen offset:1024 sc1
    s_add_u32 s26, s26, 14336
    buffer_load_dwordx4 a[240:243], v101, s[4:7], s26 offen sc1
    buffer_load_dwordx4 a[244:247], v101, s[4:7], s26 offen offset:1024 sc1
    s_add_u32 s26, s26, 14336
    buffer_load_dwordx4 v[160:163], v101, s[4:7], s26 offen sc1
    buffer_load_dwordx4 v[164:167], v101, s[4:7], s26 offen offset:1024 sc1
    s_add_u32 s26, s26, 14336
    buffer_load_dwordx4 v[216:219], v101, s[4:7], s26 offen sc1
    buffer_load_dwordx4 v[220:223], v101, s[4:7], s26 offen offset:1024 sc1
L_lws_107:
    s_cmp_lt_u32 3, s21
    s_cselect_b32 s27, 1, 0
    s_cmp_lg_u32 s27, s24
    s_cbranch_scc1 L_lws_108
    s_add_u32 s26, s25, 6144
    buffer_load_dwordx4 a[24:27], v101, s[4:7], s26 offen sc1
    buffer_load_dwordx4 a[28:31], v101, s[4:7], s26 offen offset:1024 sc1
    s_add_u32 s26, s26, 14336
    buffer_load_dwordx4 a[80:83], v101, s[4:7], s26 offen sc1
    buffer_load_dwordx4 a[84:87], v101, s[4:7], s26 offen offset:1024 sc1
    s_add_u32 s26, s26, 14336
    buffer_load_dwordx4 a[136:139], v101, s[4:7], s26 offen sc1
    buffer_load_dwordx4 a[140:143], v101, s[4:7], s26 offen offset:1024 sc1
    s_add_u32 s26, s26, 14336
    buffer_load_dwordx4 a[192:195], v101, s[4:7], s26 offen sc1
    buffer_load_dwordx4 a[196:199], v101, s[4:7], s26 offen offset:1024 sc1
    s_add_u32 s26, s26, 14336
    buffer_load_dwordx4 a[248:251], v101, s[4:7], s26 offen sc1
    buffer_load_dwordx4 a[252:255], v101, s[4:7], s26 offen offset:1024 sc1
    s_add_u32 s26, s26, 14336
    buffer_load_dwordx4 v[168:171], v101, s[4:7], s26 offen sc1
    buffer_load_dwordx4 v[172:175], v101, s[4:7], s26 offen offset:1024 sc1
    s_add_u32 s26, s26, 14336
    buffer_load_dwordx4 v[224:227], v101, s[4:7], s26 offen sc1
    buffer_load_dwordx4 v[228:231], v101, s[4:7], s26 offen offset:1024 sc1
L_lws_108:
    s_cmp_lt_u32 4, s21
    s_cselect_b32 s27, 1, 0
    s_cmp_lg_u32 s27, s24
    s_cbranch_scc1 L_lws_109
    s_add_u32 s26, s25, 8192
    buffer_load_dwordx4 a[32:35], v101, s[4:7], s26 offen sc1
    buffer_load_dwordx4 a[36:39], v101, s[4:7], s26 offen offset:1024 sc1
    s_add_u32 s26, s26, 14336
    buffer_load_dwordx4 a[88:91], v101, s[4:7], s26 offen sc1
    buffer_load_dwordx4 a[92:95], v101, s[4:7], s26 offen offset:1024 sc1
    s_add_u32 s26, s26, 14336
    buffer_load_dwordx4 a[144:147], v101, s[4:7], s26 offen sc1
    buffer_load_dwordx4 a[148:151], v101, s[4:7], s26 offen offset:1024 sc1
    s_add_u32 s26, s26, 14336
    buffer_load_dwordx4 a[200:203], v101, s[4:7], s26 offen sc1
    buffer_load_dwordx4 a[204:207], v101, s[4:7], s26 offen offset:1024 sc1
    s_add_u32 s26, s26, 14336
    buffer_load_dwordx4 v[120:123], v101, s[4:7], s26 offen sc1
    buffer_load_dwordx4 v[124:127], v101, s[4:7], s26 offen offset:1024 sc1
    s_add_u32 s26, s26, 14336
    buffer_load_dwordx4 v[176:179], v101, s[4:7], s26 offen sc1
    buffer_load_dwordx4 v[180:183], v101, s[4:7], s26 offen offset:1024 sc1
    s_add_u32 s26, s26, 14336
    buffer_load_dwordx4 v[232:235], v101, s[4:7], s26 offen sc1
    buffer_load_dwordx4 v[236:239], v101, s[4:7], s26 offen offset:1024 sc1
L_lws_109:
    s_cmp_lt_u32 5, s21
    s_cselect_b32 s27, 1, 0
    s_cmp_lg_u32 s27, s24
    s_cbranch_scc1 L_lws_110
    s_add_u32 s26, s25, 10240
    buffer_load_dwordx4 a[40:43], v101, s[4:7], s26 offen sc1
    buffer_load_dwordx4 a[44:47], v101, s[4:7], s26 offen offset:1024 sc1
    s_add_u32 s26, s26, 14336
    buffer_load_dwordx4 a[96:99], v101, s[4:7], s26 offen sc1
    buffer_load_dwordx4 a[100:103], v101, s[4:7], s26 offen offset:1024 sc1
    s_add_u32 s26, s26, 14336
    buffer_load_dwordx4 a[152:155], v101, s[4:7], s26 offen sc1
    buffer_load_dwordx4 a[156:159], v101, s[4:7], s26 offen offset:1024 sc1
    s_add_u32 s26, s26, 14336
    buffer_load_dwordx4 a[208:211], v101, s[4:7], s26 offen sc1
    buffer_load_dwordx4 a[212:215], v101, s[4:7], s26 offen offset:1024 sc1
    s_add_u32 s26, s26, 14336
    buffer_load_dwordx4 v[128:131], v101, s[4:7], s26 offen sc1
    buffer_load_dwordx4 v[132:135], v101, s[4:7], s26 offen offset:1024 sc1
    s_add_u32 s26, s26, 14336
    buffer_load_dwordx4 v[184:187], v101, s[4:7], s26 offen sc1
    buffer_load_dwordx4 v[188:191], v101, s[4:7], s26 offen offset:1024 sc1
    s_add_u32 s26, s26, 14336
    buffer_load_dwordx4 v[240:243], v101, s[4:7], s26 offen sc1
    buffer_load_dwordx4 v[244:247], v101, s[4:7], s26 offen offset:1024 sc1
L_lws_110:
    s_cmp_lt_u32 6, s21
    s_cselect_b32 s27, 1, 0
    s_cmp_lg_u32 s27, s24
    s_cbranch_scc1 L_lws_111
    s_add_u32 s26, s25, 12288
    buffer_load_dwordx4 a[48:51], v101, s[4:7], s26 offen sc1
    buffer_load_dwordx4 a[52:55], v101, s[4:7], s26 offen offset:1024 sc1
    s_add_u32 s26, s26, 14336
    buffer_load_dwordx4 a[104:107], v101, s[4:7], s26 offen sc1
    buffer_load_dwordx4 a[108:111], v101, s[4:7], s26 offen offset:1024 sc1
    s_add_u32 s26, s26, 14336
    buffer_load_dwordx4 a[160:163], v101, s[4:7], s26 offen sc1
    buffer_load_dwordx4 a[164:167], v101, s[4:7], s26 offen offset:1024 sc1
    s_add_u32 s26, s26, 14336
    buffer_load_dwordx4 a[216:219], v101, s[4:7], s26 offen sc1
    buffer_load_dwordx4 a[220:223], v101, s[4:7], s26 offen offset:1024 sc1
    s_add_u32 s26, s26, 14336
    buffer_load_dwordx4 v[136:139], v101, s[4:7], s26 offen sc1
    buffer_load_dwordx4 v[140:143], v101, s[4:7], s26 offen offset:1024 sc1
    s_add_u32 s26, s26, 14336
    buffer_load_dwordx4 v[192:195], v101, s[4:7], s26 offen sc1
    buffer_load_dwordx4 v[196:199], v101, s[4:7], s26 offen offset:1024 sc1
    s_add_u32 s26, s26, 14336
    buffer_load_dwordx4 v[248:251], v101, s[4:7], s26 offen sc1
    buffer_load_dwordx4 v[252:255], v101, s[4:7], s26 offen offset:1024 sc1
L_lws_111:
    s_add_u32 s24, s24, 1
    s_cmp_lt_u32 s24, 2
    s_cbranch_scc1 L_lw_104
    s_mov_b32 s20, 0x20000
    v_mov_b32 v10, 0
L_wd_112:
    global_load_dword v11, v10, s[40:41] offset:4 sc1
    s_waitcnt vmcnt(0)
    v_cmp_gt_u32 vcc, 16, v11
    s_cbranch_vccz L_wdd_113
    s_sleep 2
    s_sub_u32 s20, s20, 1
    s_cbranch_scc0 L_wd_112
    s_branch L_fin
L_wdd_113:
    s_mov_b32 s20, 0x20000
    v_mov_b32 v10, 0
L_wd_114:
    global_load_dword v11, v10, s[40:41] offset:132 sc1
    s_waitcnt vmcnt(0)
    v_cmp_gt_u32 vcc, 64, v11
    s_cbranch_vccz L_wdd_115
    s_sleep 2
    s_sub_u32 s20, s20, 1
    s_cbranch_scc0 L_wd_114
    s_branch L_fin
L_wdd_115:
L_X1_116:
    s_waitcnt vmcnt(0)
    s_barrier
    s_xor_b32 s16, s16, 0x8000
    s_add_u32 s28, s14, 4
    s_mul_i32 s15, s28, 28672
    s_add_u32 m0, s16, 0
    s_nop 0
    buffer_load_dwordx4 v102, s[8:11], s15 offen offset:0 lds
    s_add_u32 m0, s16, 960
    s_nop 0
    buffer_load_dwordx4 v102, s[8:11], s15 offen offset:64 lds
    s_add_u32 m0, s16, 1920
    s_nop 0
    buffer_load_dwordx4 v102, s[8:11], s15 offen offset:128 lds
    s_add_u32 m0, s16, 2880
    s_nop 0
    buffer_load_dwordx4 v102, s[8:11], s15 offen offset:192 lds
    s_add_u32 m0, s16, 3840
    s_nop 0
    buffer_load_dwordx4 v102, s[8:11], s15 offen offset:256 lds
    s_add_u32 m0, s16, 4800
    s_nop 0
    buffer_load_dwordx4 v102, s[8:11], s15 offen offset:320 lds
    s_add_u32 m0, s16, 5760
    s_nop 0
    buffer_load_dwordx4 v102, s[8:11], s15 offen offset:384 lds
    ds_read_b128 v[56:59], v103 offset:0
    ds_read_b128 v[60:63], v103 offset:14336
    s_waitcnt lgkmcnt(0)
    v_mfma_f32_16x16x32_bf16 v[0:3], a[0:3], v[56:59], 0
    v_mfma_f32_16x16x32_bf16 v[28:31], a[0:3], v[60:63], 0
    v_mfma_f32_16x16x32_bf16 v[4:7], a[56:59], v[56:59], 0
    ds_read_b128 v[64:67], v103 offset:1024
    v_mfma_f32_16x16x32_bf16 v[32:35], a[56:59], v[60:63], 0
    ds_read_b128 v[68:71], v103 offset:15360
    v_mfma_f32_16x16x32_bf16 v[8:11], a[112:115], v[56:59], 0
    v_mfma_f32_16x16x32_bf16 v[36:39], a[112:115], v[60:63], 0
    v_mfma_f32_16x16x32_bf16 v[12:15], a[168:171], v[56:59], 0
    v_mfma_f32_16x16x32_bf16 v[40:43], a[168:171], v[60:63], 0
    v_mfma_f32_16x16x32_bf16 v[16:19], a[224:227], v[56:59], 0
    v_mfma_f32_16x16x32_bf16 v[44:47], a[224:227], v[60:63], 0
    v_mfma_f32_16x16x32_bf16 v[20:23], v[144:147], v[56:59], 0
    v_mfma_f32_16x16x32_bf16 v[48:51], v[144:147], v[60:63], 0
    v_mfma_f32_16x16x32_bf16 v[24:27], v[200:203], v[56:59], 0
    v_mfma_f32_16x16x32_bf16 v[52:55], v[200:203], v[60:63], 0
    s_waitcnt lgkmcnt(0)
    v_mfma_f32_16x16x32_bf16 v[0:3], a[4:7], v[64:67], v[0:3]
    v_mfma_f32_16x16x32_bf16 v[28:31], a[4:7], v[68:71], v[28:31]
    v_mfma_f32_16x16x32_bf16 v[4:7], a[60:63], v[64:67], v[4:7]
    ds_read_b128 v[56:59], v103 offset:2048
    v_mfma_f32_16x16x32_bf16 v[32:35], a[60:63], v[68:71], v[32:35]
    ds_read_b128 v[60:63], v103 offset:16384
    v_mfma_f32_16x16x32_bf16 v[8:11], a[116:119], v[64:67], v[8:11]
    v_mfma_f32_16x16x32_bf16 v[36:39], a[116:119], v[68:71], v[36:39]
    v_mfma_f32_16x16x32_bf16 v[12:15], a[172:175], v[64:67], v[12:15]
    v_mfma_f32_16x16x32_bf16 v[40:43], a[172:175], v[68:71], v[40:43]
    v_mfma_f32_16x16x32_bf16 v[16:19], a[228:231], v[64:67], v[16:19]
    v_mfma_f32_16x16x32_bf16 v[44:47], a[228:231], v[68:71], v[44:47]
    v_mfma_f32_16x16x32_bf16 v[20:23], v[148:151], v[64:67], v[20:23]
    v_mfma_f32_16x16x32_bf16 v[48:51], v[148:151], v[68:71], v[48:51]
    v_mfma_f32_16x16x32_bf16 v[24:27], v[204:207], v[64:67], v[24:27]
    v_mfma_f32_16x16x32_bf16 v[52:55], v[204:207], v[68:71], v[52:55]
    s_waitcnt lgkmcnt(0)
    v_mfma_f32_16x16x32_bf16 v[0:3], a[8:11], v[56:59], v[0:3]
    v_mfma_f32_16x16x32_bf16 v[28:31], a[8:11], v[60:63], v[28:31]
    v_mfma_f32_16x16x32_bf16 v[4:7], a[64:67], v[56:59], v[4:7]
    ds_read_b128 v[64:67], v103 offset:3072
    v_mfma_f32_16x16x32_bf16 v[32:35], a[64:67], v[60:63], v[32:35]
    ds_read_b128 v[68:71], v103 offset:17408
    v_mfma_f32_16x16x32_bf16 v[8:11], a[120:123], v[56:59], v[8:11]
    v_mfma_f32_16x16x32_bf16 v[36:39], a[120:123], v[60:63], v[36:39]
    v_mfma_f32_16x16x32_bf16 v[12:15], a[176:179], v[56:59], v[12:15]
    v_mfma_f32_16x16x32_bf16 v[40:43], a[176:179], v[60:63], v[40:43]
    v_mfma_f32_16x16x32_bf16 v[16:19], a[232:235], v[56:59], v[16:19]
    v_mfma_f32_16x16x32_bf16 v[44:47], a[232:235], v[60:63], v[44:47]
    v_mfma_f32_16x16x32_bf16 v[20:23], v[152:155], v[56:59], v[20:23]
    v_mfma_f32_16x16x32_bf16 v[48:51], v[152:155], v[60:63], v[48:51]
    v_mfma_f32_16x16x32_bf16 v[24:27], v[208:211], v[56:59], v[24:27]
    v_mfma_f32_16x16x32_bf16 v[52:55], v[208:211], v[60:63], v[52:55]
    s_waitcnt lgkmcnt(0)
    v_mfma_f32_16x16x32_bf16 v[0:3], a[12:15], v[64:67], v[0:3]
    v_mfma_f32_16x16x32_bf16 v[28:31], a[12:15], v[68:71], v[28:31]
    v_mfma_f32_16x16x32_bf16 v[4:7], a[68:71], v[64:67], v[4:7]
    ds_read_b128 v[56:59], v103 offset:4096
    v_mfma_f32_16x16x32_bf16 v[32:35], a[68:71], v[68:71], v[32:35]
    ds_read_b128 v[60:63], v103 offset:18432
    v_mfma_f32_16x16x32_bf16 v[8:11], a[124:127], v[64:67], v[8:11]
    v_mfma_f32_16x16x32_bf16 v[36:39], a[124:127], v[68:71], v[36:39]
    v_mfma_f32_16x16x32_bf16 v[12:15], a[180:183], v[64:67], v[12:15]
    v_mfma_f32_16x16x32_bf16 v[40:43], a[180:183], v[68:71], v[40:43]
    v_mfma_f32_16x16x32_bf16 v[16:19], a[236:239], v[64:67], v[16:19]
    v_mfma_f32_16x16x32_bf16 v[44:47], a[236:239], v[68:71], v[44:47]
    v_mfma_f32_16x16x32_bf16 v[20:23], v[156:159], v[64:67], v[20:23]
    v_mfma_f32_16x16x32_bf16 v[48:51], v[156:159], v[68:71], v[48:51]
    v_mfma_f32_16x16x32_bf16 v[24:27], v[212:215], v[64:67], v[24:27]
    v_mfma_f32_16x16x32_bf16 v[52:55], v[212:215], v[68:71], v[52:55]
    s_waitcnt lgkmcnt(0)
    v_mfma_f32_16x16x32_bf16 v[0:3], a[16:19], v[56:59], v[0:3]
    v_mfma_f32_16x16x32_bf16 v[28:31], a[16:19], v[60:63], v[28:31]
    v_mfma_f32_16x16x32_bf16 v[4:7], a[72:75], v[56:59], v[4:7]
    ds_read_b128 v[64:67], v103 offset:5120
    v_mfma_f32_16x16x32_bf16 v[32:35], a[72:75], v[60:63], v[32:35]
    ds_read_b128 v[68:71], v103 offset:19456
    v_mfma_f32_16x16x32_bf16 v[8:11], a[128:131], v[56:59], v[8:11]
    v_mfma_f32_16x16x32_bf16 v[36:39], a[128:131], v[60:63], v[36:39]
    v_mfma_f32_16x16x32_bf16 v[12:15], a[184:187], v[56:59], v[12:15]
    v_mfma_f32_16x16x32_bf16 v[40:43], a[184:187], v[60:63], v[40:43]
    v_mfma_f32_16x16x32_bf16 v[16:19], a[240:243], v[56:59], v[16:19]
    v_mfma_f32_16x16x32_bf16 v[44:47], a[240:243], v[60:63], v[44:47]
    v_mfma_f32_16x16x32_bf16 v[20:23], v[160:163], v[56:59], v[20:23]
    v_mfma_f32_16x16x32_bf16 v[48:51], v[160:163], v[60:63], v[48:51]
    v_mfma_f32_16x16x32_bf16 v[24:27], v[216:219], v[56:59], v[24:27]
    v_mfma_f32_16x16x32_bf16 v[52:55], v[216:219], v[60:63], v[52:55]
    s_waitcnt lgkmcnt(0)
    v_mfma_f32_16x16x32_bf16 v[0:3], a[20:23], v[64:67], v[0:3]
    v_mfma_f32_16x16x32_bf16 v[28:31], a[20:23], v[68:71], v[28:31]
    v_mfma_f32_16x16x32_bf16 v[4:7], a[76:79], v[64:67], v[4:7]
    ds_read_b128 v[56:59], v103 offset:6144
    v_mfma_f32_16x16x32_bf16 v[32:35], a[76:79], v[68:71], v[32:35]
    ds_read_b128 v[60:63], v103 offset:20480
    v_mfma_f32_16x16x32_bf16 v[8:11], a[132:135], v[64:67], v[8:11]
    v_mfma_f32_16x16x32_bf16 v[36:39], a[132:135], v[68:71], v[36:39]
    v_mfma_f32_16x16x32_bf16 v[12:15], a[188:191], v[64:67], v[12:15]
    v_mfma_f32_16x16x32_bf16 v[40:43], a[188:191], v[68:71], v[40:43]
    v_mfma_f32_16x16x32_bf16 v[16:19], a[244:247], v[64:67], v[16:19]
    v_mfma_f32_16x16x32_bf16 v[44:47], a[244:247], v[68:71], v[44:47]
    v_mfma_f32_16x16x32_bf16 v[20:23], v[164:167], v[64:67], v[20:23]
    v_mfma_f32_16x16x32_bf16 v[48:51], v[164:167], v[68:71], v[48:51]
    v_mfma_f32_16x16x32_bf16 v[24:27], v[220:223], v[64:67], v[24:27]
    v_mfma_f32_16x16x32_bf16 v[52:55], v[220:223], v[68:71], v[52:55]
    s_waitcnt lgkmcnt(0)
    v_mfma_f32_16x16x32_bf16 v[0:3], a[24:27], v[56:59], v[0:3]
    v_mfma_f32_16x16x32_bf16 v[28:31], a[24:27], v[60:63], v[28:31]
    v_mfma_f32_16x16x32_bf16 v[4:7], a[80:83], v[56:59], v[4:7]
    ds_read_b128 v[64:67], v103 offset:7168
    v_mfma_f32_16x16x32_bf16 v[32:35], a[80:83], v[60:63], v[32:35]
    ds_read_b128 v[68:71], v103 offset:21504
    v_mfma_f32_16x16x32_bf16 v[8:11], a[136:139], v[56:59], v[8:11]
    v_mfma_f32_16x16x32_bf16 v[36:39], a[136:139], v[60:63], v[36:39]
    v_mfma_f32_16x16x32_bf16 v[12:15], a[192:195], v[56:59], v[12:15]
    v_mfma_f32_16x16x32_bf16 v[40:43], a[192:195], v[60:63], v[40:43]
    v_mfma_f32_16x16x32_bf16 v[16:19], a[248:251], v[56:59], v[16:19]
    v_mfma_f32_16x16x32_bf16 v[44:47], a[248:251], v[60:63], v[44:47]
    v_mfma_f32_16x16x32_bf16 v[20:23], v[168:171], v[56:59], v[20:23]
    v_mfma_f32_16x16x32_bf16 v[48:51], v[168:171], v[60:63], v[48:51]
    v_mfma_f32_16x16x32_bf16 v[24:27], v[224:227], v[56:59], v[24:27]
    v_mfma_f32_16x16x32_bf16 v[52:55], v[224:227], v[60:63], v[52:55]
    s_waitcnt lgkmcnt(0)
    v_mfma_f32_16x16x32_bf16 v[0:3], a[28:31], v[64:67], v[0:3]
    v_mfma_f32_16x16x32_bf16 v[28:31], a[28:31], v[68:71], v[28:31]
    v_mfma_f32_16x16x32_bf16 v[4:7], a[84:87], v[64:67], v[4:7]
    ds_read_b128 v[56:59], v103 offset:8192
    v_mfma_f32_16x16x32_bf16 v[32:35], a[84:87], v[68:71], v[32:35]
    ds_read_b128 v[60:63], v103 offset:22528
    v_mfma_f32_16x16x32_bf16 v[8:11], a[140:143], v[64:67], v[8:11]
    v_mfma_f32_16x16x32_bf16 v[36:39], a[140:143], v[68:71], v[36:39]
    v_mfma_f32_16x16x32_bf16 v[12:15], a[196:199], v[64:67], v[12:15]
    v_mfma_f32_16x16x32_bf16 v[40:43], a[196:199], v[68:71], v[40:43]
    v_mfma_f32_16x16x32_bf16 v[16:19], a[252:255], v[64:67], v[16:19]
    v_mfma_f32_16x16x32_bf16 v[44:47], a[252:255], v[68:71], v[44:47]
    v_mfma_f32_16x16x32_bf16 v[20:23], v[172:175], v[64:67], v[20:23]
    v_mfma_f32_16x16x32_bf16 v[48:51], v[172:175], v[68:71], v[48:51]
    v_mfma_f32_16x16x32_bf16 v[24:27], v[228:231], v[64:67], v[24:27]
    v_mfma_f32_16x16x32_bf16 v[52:55], v[228:231], v[68:71], v[52:55]
    s_waitcnt lgkmcnt(0)
    v_mfma_f32_16x16x32_bf16 v[0:3], a[32:35], v[56:59], v[0:3]
    v_mfma_f32_16x16x32_bf16 v[28:31], a[32:35], v[60:63], v[28:31]
    v_mfma_f32_16x16x32_bf16 v[4:7], a[88:91], v[56:59], v[4:7]
    ds_read_b128 v[64:67], v103 offset:9216
    v_mfma_f32_16x16x32_bf16 v[32:35], a[88:91], v[60:63], v[32:35]
    ds_read_b128 v[68:71], v103 offset:23552
    v_mfma_f32_16x16x32_bf16 v[8:11], a[144:147], v[56:59], v[8:11]
    v_mfma_f32_16x16x32_bf16 v[36:39], a[144:147], v[60:63], v[36:39]
    v_mfma_f32_16x16x32_bf16 v[12:15], a[200:203], v[56:59], v[12:15]
    v_mfma_f32_16x16x32_bf16 v[40:43], a[200:203], v[60:63], v[40:43]
    v_mfma_f32_16x16x32_bf16 v[16:19], v[120:123], v[56:59], v[16:19]
    v_mfma_f32_16x16x32_bf16 v[44:47], v[120:123], v[60:63], v[44:47]
    v_mfma_f32_16x16x32_bf16 v[20:23], v[176:179], v[56:59], v[20:23]
    v_mfma_f32_16x16x32_bf16 v[48:51], v[176:179], v[60:63], v[48:51]
    v_mfma_f32_16x16x32_bf16 v[24:27], v[232:235], v[56:59], v[24:27]
    v_mfma_f32_16x16x32_bf16 v[52:55], v[232:235], v[60:63], v[52:55]
    s_waitcnt lgkmcnt(0)
    v_mfma_f32_16x16x32_bf16 v[0:3], a[36:39], v[64:67], v[0:3]
    v_mfma_f32_16x16x32_bf16 v[28:31], a[36:39], v[68:71], v[28:31]
    v_mfma_f32_16x16x32_bf16 v[4:7], a[92:95], v[64:67], v[4:7]
    ds_read_b128 v[56:59], v103 offset:10240
    v_mfma_f32_16x16x32_bf16 v[32:35], a[92:95], v[68:71], v[32:35]
    ds_read_b128 v[60:63], v103 offset:24576
    v_mfma_f32_16x16x32_bf16 v[8:11], a[148:151], v[64:67], v[8:11]
    v_mfma_f32_16x16x32_bf16 v[36:39], a[148:151], v[68:71], v[36:39]
    v_mfma_f32_16x16x32_bf16 v[12:15], a[204:207], v[64:67], v[12:15]
    v_mfma_f32_16x16x32_bf16 v[40:43], a[204:207], v[68:71], v[40:43]
    v_mfma_f32_16x16x32_bf16 v[16:19], v[124:127], v[64:67], v[16:19]
    v_mfma_f32_16x16x32_bf16 v[44:47], v[124:127], v[68:71], v[44:47]
    v_mfma_f32_16x16x32_bf16 v[20:23], v[180:183], v[64:67], v[20:23]
    v_mfma_f32_16x16x32_bf16 v[48:51], v[180:183], v[68:71], v[48:51]
    v_mfma_f32_16x16x32_bf16 v[24:27], v[236:239], v[64:67], v[24:27]
    v_mfma_f32_16x16x32_bf16 v[52:55], v[236:239], v[68:71], v[52:55]
    s_waitcnt lgkmcnt(0)
    v_mfma_f32_16x16x32_bf16 v[0:3], a[40:43], v[56:59], v[0:3]
    v_mfma_f32_16x16x32_bf16 v[28:31], a[40:43], v[60:63], v[28:31]
    v_mfma_f32_16x16x32_bf16 v[4:7], a[96:99], v[56:59], v[4:7]
    ds_read_b128 v[64:67], v103 offset:11264
    v_mfma_f32_16x16x32_bf16 v[32:35], a[96:99], v[60:63], v[32:35]
    ds_read_b128 v[68:71], v103 offset:25600
    v_mfma_f32_16x16x32_bf16 v[8:11], a[152:155], v[56:59], v[8:11]
    v_mfma_f32_16x16x32_bf16 v[36:39], a[152:155], v[60:63], v[36:39]
    v_mfma_f32_16x16x32_bf16 v[12:15], a[208:211], v[56:59], v[12:15]
    v_mfma_f32_16x16x32_bf16 v[40:43], a[208:211], v[60:63], v[40:43]
    v_mfma_f32_16x16x32_bf16 v[16:19], v[128:131], v[56:59], v[16:19]
    v_mfma_f32_16x16x32_bf16 v[44:47], v[128:131], v[60:63], v[44:47]
    v_mfma_f32_16x16x32_bf16 v[20:23], v[184:187], v[56:59], v[20:23]
    v_mfma_f32_16x16x32_bf16 v[48:51], v[184:187], v[60:63], v[48:51]
    v_mfma_f32_16x16x32_bf16 v[24:27], v[240:243], v[56:59], v[24:27]
    v_mfma_f32_16x16x32_bf16 v[52:55], v[240:243], v[60:63], v[52:55]
    s_waitcnt lgkmcnt(0)
    v_mfma_f32_16x16x32_bf16 v[0:3], a[44:47], v[64:67], v[0:3]
    v_mfma_f32_16x16x32_bf16 v[28:31], a[44:47], v[68:71], v[28:31]
    v_mfma_f32_16x16x32_bf16 v[4:7], a[100:103], v[64:67], v[4:7]
    ds_read_b128 v[56:59], v103 offset:12288
    v_mfma_f32_16x16x32_bf16 v[32:35], a[100:103], v[68:71], v[32:35]
    ds_read_b128 v[60:63], v103 offset:26624
    v_mfma_f32_16x16x32_bf16 v[8:11], a[156:159], v[64:67], v[8:11]
    v_mfma_f32_16x16x32_bf16 v[36:39], a[156:159], v[68:71], v[36:39]
    v_mfma_f32_16x16x32_bf16 v[12:15], a[212:215], v[64:67], v[12:15]
    v_mfma_f32_16x16x32_bf16 v[40:43], a[212:215], v[68:71], v[40:43]
    v_mfma_f32_16x16x32_bf16 v[16:19], v[132:135], v[64:67], v[16:19]
    v_mfma_f32_16x16x32_bf16 v[44:47], v[132:135], v[68:71], v[44:47]
    v_mfma_f32_16x16x32_bf16 v[20:23], v[188:191], v[64:67], v[20:23]
    v_mfma_f32_16x16x32_bf16 v[48:51], v[188:191], v[68:71], v[48:51]
    v_mfma_f32_16x16x32_bf16 v[24:27], v[244:247], v[64:67], v[24:27]
    v_mfma_f32_16x16x32_bf16 v[52:55], v[244:247], v[68:71], v[52:55]
    s_waitcnt lgkmcnt(0)
    v_mfma_f32_16x16x32_bf16 v[0:3], a[48:51], v[56:59], v[0:3]
    v_mfma_f32_16x16x32_bf16 v[28:31], a[48:51], v[60:63], v[28:31]
    v_mfma_f32_16x16x32_bf16 v[4:7], a[104:107], v[56:59], v[4:7]
    ds_read_b128 v[64:67], v103 offset:13312
    v_mfma_f32_16x16x32_bf16 v[32:35], a[104:107], v[60:63], v[32:35]
    ds_read_b128 v[68:71], v103 offset:27648
    v_mfma_f32_16x16x32_bf16 v[8:11], a[160:163], v[56:59], v[8:11]
    v_mfma_f32_16x16x32_bf16 v[36:39], a[160:163], v[60:63], v[36:39]
    v_mfma_f32_16x16x32_bf16 v[12:15], a[216:219], v[56:59], v[12:15]
    v_mfma_f32_16x16x32_bf16 v[40:43], a[216:219], v[60:63], v[40:43]
    v_mfma_f32_16x16x32_bf16 v[16:19], v[136:139], v[56:59], v[16:19]
    v_mfma_f32_16x16x32_bf16 v[44:47], v[136:139], v[60:63], v[44:47]
    v_mfma_f32_16x16x32_bf16 v[20:23], v[192:195], v[56:59], v[20:23]
    v_mfma_f32_16x16x32_bf16 v[48:51], v[192:195], v[60:63], v[48:51]
    v_mfma_f32_16x16x32_bf16 v[24:27], v[248:251], v[56:59], v[24:27]
    v_mfma_f32_16x16x32_bf16 v[52:55], v[248:251], v[60:63], v[52:55]
    s_waitcnt lgkmcnt(0)
    v_mfma_f32_16x16x32_bf16 v[0:3], a[52:55], v[64:67], v[0:3]
    v_mfma_f32_16x16x32_bf16 v[28:31], a[52:55], v[68:71], v[28:31]
    v_mfma_f32_16x16x32_bf16 v[4:7], a[108:111], v[64:67], v[4:7]
    v_mfma_f32_16x16x32_bf16 v[32:35], a[108:111], v[68:71], v[32:35]
    v_mfma_f32_16x16x32_bf16 v[8:11], a[164:167], v[64:67], v[8:11]
    v_mfma_f32_16x16x32_bf16 v[36:39], a[164:167], v[68:71], v[36:39]
    v_mfma_f32_16x16x32_bf16 v[12:15], a[220:223], v[64:67], v[12:15]
    v_mfma_f32_16x16x32_bf16 v[40:43], a[220:223], v[68:71], v[40:43]
    v_mfma_f32_16x16x32_bf16 v[16:19], v[140:143], v[64:67], v[16:19]
    v_mfma_f32_16x16x32_bf16 v[44:47], v[140:143], v[68:71], v[44:47]
    v_mfma_f32_16x16x32_bf16 v[20:23], v[196:199], v[64:67], v[20:23]
    v_mfma_f32_16x16x32_bf16 v[48:51], v[196:199], v[68:71], v[48:51]
    v_mfma_f32_16x16x32_bf16 v[24:27], v[252:255], v[64:67], v[24:27]
    v_mfma_f32_16x16x32_bf16 v[52:55], v[252:255], v[68:71], v[52:55]
    v_cvt_pk_bf16_f32 v72, v0, v1
    v_cvt_pk_bf16_f32 v73, v2, v3
    v_cvt_pk_bf16_f32 v74, v4, v5
    v_cvt_pk_bf16_f32 v75, v6, v7
    v_cvt_pk_bf16_f32 v76, v8, v9
    v_cvt_pk_bf16_f32 v77, v10, v11
    v_cvt_pk_bf16_f32 v78, v12, v13
    v_cvt_pk_bf16_f32 v79, v14, v15
    v_cvt_pk_bf16_f32 v80, v16, v17
    v_cvt_pk_bf16_f32 v81, v18, v19
    v_cvt_pk_bf16_f32 v82, v20, v21
    v_cvt_pk_bf16_f32 v83, v22, v23
    v_cvt_pk_bf16_f32 v84, v24, v25
    v_cvt_pk_bf16_f32 v85, v26, v27
    v_cvt_pk_bf16_f32 v86, v28, v29
    v_cvt_pk_bf16_f32 v87, v30, v31
    v_cvt_pk_bf16_f32 v88, v32, v33
    v_cvt_pk_bf16_f32 v89, v34, v35
    v_cvt_pk_bf16_f32 v90, v36, v37
    v_cvt_pk_bf16_f32 v91, v38, v39
    v_cvt_pk_bf16_f32 v92, v40, v41
    v_cvt_pk_bf16_f32 v93, v42, v43
    v_cvt_pk_bf16_f32 v94, v44, v45
    v_cvt_pk_bf16_f32 v95, v46, v47
    v_cvt_pk_bf16_f32 v96, v48, v49
    v_cvt_pk_bf16_f32 v97, v50, v51
    v_cvt_pk_bf16_f32 v98, v52, v53
    v_cvt_pk_bf16_f32 v99, v54, v55
    ds_read_b64 v[16:17], v104 offset:0
    ds_read_b64 v[18:19], v104 offset:14336
    ds_read_b64 v[20:21], v105 offset:0
    ds_read_b64 v[22:23], v105 offset:14336
    ds_read_b64 v[24:25], v104 offset:1024
    ds_read_b64 v[26:27], v104 offset:15360
    ds_read_b64 v[28:29], v105 offset:1024
    ds_read_b64 v[30:31], v105 offset:15360
    ds_read_b64 v[32:33], v104 offset:2048
    ds_read_b64 v[34:35], v104 offset:16384
    ds_read_b64 v[36:37], v105 offset:2048
    ds_read_b64 v[38:39], v105 offset:16384
    ds_read_b64 v[40:41], v104 offset:3072
    ds_read_b64 v[42:43], v104 offset:17408
    s_waitcnt lgkmcnt(0)
    v_mfma_f32_16x16x16_bf16 v[0:3], v[16:17], v[72:73], 0
    v_mfma_f32_16x16x16_bf16 v[4:7], v[18:19], v[72:73], 0
    v_mfma_f32_16x16x16_bf16 v[8:11], v[16:17], v[86:87], 0
    v_mfma_f32_16x16x16_bf16 v[12:15], v[18:19], v[86:87], 0
    v_mfma_f32_16x16x16_bf16 v[0:3], v[20:21], v[74:75], v[0:3]
    v_mfma_f32_16x16x16_bf16 v[4:7], v[22:23], v[74:75], v[4:7]
    v_mfma_f32_16x16x16_bf16 v[8:11], v[20:21], v[88:89], v[8:11]
    v_mfma_f32_16x16x16_bf16 v[12:15], v[22:23], v[88:89], v[12:15]
    v_mfma_f32_16x16x16_bf16 v[0:3], v[24:25], v[76:77], v[0:3]
    v_mfma_f32_16x16x16_bf16 v[4:7], v[26:27], v[76:77], v[4:7]
    v_mfma_f32_16x16x16_bf16 v[8:11], v[24:25], v[90:91], v[8:11]
    v_mfma_f32_16x16x16_bf16 v[12:15], v[26:27], v[90:91], v[12:15]
    v_mfma_f32_16x16x16_bf16 v[0:3], v[28:29], v[78:79], v[0:3]
    v_mfma_f32_16x16x16_bf16 v[4:7], v[30:31], v[78:79], v[4:7]
    v_mfma_f32_16x16x16_bf16 v[8:11], v[28:29], v[92:93], v[8:11]
    v_mfma_f32_16x16x16_bf16 v[12:15], v[30:31], v[92:93], v[12:15]
    v_mfma_f32_16x16x16_bf16 v[0:3], v[32:33], v[80:81], v[0:3]
    v_mfma_f32_16x16x16_bf16 v[4:7], v[34:35], v[80:81], v[4:7]
    v_mfma_f32_16x16x16_bf16 v[8:11], v[32:33], v[94:95], v[8:11]
    v_mfma_f32_16x16x16_bf16 v[12:15], v[34:35], v[94:95], v[12:15]
    v_mfma_f32_16x16x16_bf16 v[0:3], v[36:37], v[82:83], v[0:3]
    v_mfma_f32_16x16x16_bf16 v[4:7], v[38:39], v[82:83], v[4:7]
    v_mfma_f32_16x16x16_bf16 v[8:11], v[36:37], v[96:97], v[8:11]
    v_mfma_f32_16x16x16_bf16 v[12:15], v[38:39], v[96:97], v[12:15]
    v_mfma_f32_16x16x16_bf16 v[0:3], v[40:41], v[84:85], v[0:3]
    v_mfma_f32_16x16x16_bf16 v[4:7], v[42:43], v[84:85], v[4:7]
    v_mfma_f32_16x16x16_bf16 v[8:11], v[40:41], v[98:99], v[8:11]
    v_mfma_f32_16x16x16_bf16 v[12:15], v[42:43], v[98:99], v[12:15]
    v_xor_b32 v103, 0x8000, v103
    v_xor_b32 v104, 0x8000, v104
    v_xor_b32 v105, 0x8000, v105
    s_lshl_b32 s24, s12, 12
    v_add_u32 v112, s24, v107
    ds_write_b128 v112, v[0:3] offset:0
    ds_write_b128 v112, v[4:7] offset:1024
    ds_write_b128 v112, v[8:11] offset:2048
    ds_write_b128 v112, v[12:15] offset:3072
    s_and_b32 s24, s12, 1
    s_lshl_b32 s24, s24, 11
    v_add_u32 v112, s24, v107
    s_waitcnt lgkmcnt(0)
    s_barrier
    ds_read_b128 v[0:3], v112 offset:0
    ds_read_b128 v[4:7], v112 offset:1024
    ds_read_b128 v[8:11], v112 offset:4096
    ds_read_b128 v[12:15], v112 offset:5120
    ds_read_b128 v[16:19], v112 offset:8192
    ds_read_b128 v[20:23], v112 offset:9216
    ds_read_b128 v[24:27], v112 offset:12288
    ds_read_b128 v[28:31], v112 offset:13312
    s_waitcnt lgkmcnt(0)
    v_pk_add_f32 v[0:1], v[0:1], v[16:17]
    v_pk_add_f32 v[2:3], v[2:3], v[18:19]
    v_pk_add_f32 v[4:5], v[4:5], v[20:21]
    v_pk_add_f32 v[6:7], v[6:7], v[22:23]
    v_pk_add_f32 v[8:9], v[8:9], v[24:25]
    v_pk_add_f32 v[10:11], v[10:11], v[26:27]
    v_pk_add_f32 v[12:13], v[12:13], v[28:29]
    v_pk_add_f32 v[14:15], v[14:15], v[30:31]
    v_pk_add_f32 v[0:1], v[0:1], v[8:9]
    v_pk_add_f32 v[2:3], v[2:3], v[10:11]
    v_pk_add_f32 v[4:5], v[4:5], v[12:13]
    v_pk_add_f32 v[6:7], v[6:7], v[14:15]
    v_mov_b32 v113, 0xf0000000
    v_cmp_le_i32 vcc, 0, v110
    s_nop 1
    v_cndmask_b32 v56, v113, v0, vcc
    v_cmp_le_i32 vcc, 2, v110
    s_nop 1
    v_cndmask_b32 v57, v113, v1, vcc
    v_cmp_le_i32 vcc, 4, v110
    s_nop 1
    v_cndmask_b32 v58, v113, v2, vcc
    v_cmp_le_i32 vcc, 6, v110
    s_nop 1
    v_cndmask_b32 v59, v113, v3, vcc
    v_cmp_le_i32 vcc, 1, v110
    s_nop 1
    v_cndmask_b32 v60, v113, v4, vcc
    v_cmp_le_i32 vcc, 3, v110
    s_nop 1
    v_cndmask_b32 v61, v113, v5, vcc
    v_cmp_le_i32 vcc, 5, v110
    s_nop 1
    v_cndmask_b32 v62, v113, v6, vcc
    v_cmp_le_i32 vcc, 7, v110
    s_nop 1
    v_cndmask_b32 v63, v113, v7, vcc
    s_mul_i32 s29, s14, 69632
    s_add_u32 s21, s29, 50352128
    s_mul_i32 s24, s12, 1792
    s_add_u32 s21, s21, s24
    s_lshl_b32 s24, s12, 11
    s_add_u32 s24, s24, 90112
    v_add_u32 v112, s24, v101
    v_min_u32 v114, 752, v101
    s_mov_b32 s20, 0x20000
L_ps_119:
    buffer_load_dwordx4 v[24:27], v101, s[4:7], s21 offen sc1
    buffer_load_dwordx4 v[28:31], v114, s[4:7], s21 offen offset:1024 sc1
    s_waitcnt vmcnt(0)
    v_max_u32 v113, v24, v25
    v_max3_u32 v113, v113, v26, v27
    v_max3_u32 v113, v113, v28, v29
    v_max3_u32 v113, v113, v30, v31
    v_cmp_eq_u32 vcc, -1, v113
    s_cbranch_vccz L_psd_120
    s_sleep 2
    s_sub_u32 s20, s20, 1
    s_cbranch_scc0 L_ps_119
    s_branch L_fin
L_psd_120:
    ds_write_b128 v112, v[24:27]
    ds_write_b128 v112, v[28:31] offset:1024
    ds_read_b32 v0, v106 offset:0
    ds_read_b32 v1, v106 offset:32
    ds_read_b32 v2, v106 offset:256
    ds_read_b32 v3, v106 offset:288
    ds_read_b32 v4, v106 offset:512
    ds_read_b32 v5, v106 offset:544
    ds_read_b32 v6, v106 offset:768
    ds_read_b32 v7, v106 offset:800
    ds_read_b32 v8, v106 offset:1024
    ds_read_b32 v9, v106 offset:1056
    ds_read_b32 v10, v106 offset:1280
    ds_read_b32 v11, v106 offset:1312
    ds_read_b32 v12, v106 offset:1536
    ds_read_b32 v13, v106 offset:1568
    s_waitcnt lgkmcnt(0)
    v_mfma_f32_16x16x16_bf16 v[16:19], v[0:1], v[72:73], 0
    v_mfma_f32_16x16x16_bf16 v[20:23], v[0:1], v[86:87], 0
    v_mfma_f32_16x16x16_bf16 v[16:19], v[2:3], v[74:75], v[16:19]
    v_mfma_f32_16x16x16_bf16 v[20:23], v[2:3], v[88:89], v[20:23]
    v_mfma_f32_16x16x16_bf16 v[16:19], v[4:5], v[76:77], v[16:19]
    v_mfma_f32_16x16x16_bf16 v[20:23], v[4:5], v[90:91], v[20:23]
    v_mfma_f32_16x16x16_bf16 v[16:19], v[6:7], v[78:79], v[16:19]
    v_mfma_f32_16x16x16_bf16 v[20:23], v[6:7], v[92:93], v[20:23]
    v_mfma_f32_16x16x16_bf16 v[16:19], v[8:9], v[80:81], v[16:19]
    v_mfma_f32_16x16x16_bf16 v[20:23], v[8:9], v[94:95], v[20:23]
    v_mfma_f32_16x16x16_bf16 v[16:19], v[10:11], v[82:83], v[16:19]
    v_mfma_f32_16x16x16_bf16 v[20:23], v[10:11], v[96:97], v[20:23]
    v_mfma_f32_16x16x16_bf16 v[16:19], v[12:13], v[84:85], v[16:19]
    v_mfma_f32_16x16x16_bf16 v[20:23], v[12:13], v[98:99], v[20:23]
    s_lshl_b32 s24, s12, 11
    s_add_u32 s24, s24, 81920
    v_add_u32 v112, s24, v101
    s_nop 0
    ds_write_b128 v112, v[16:19]
    s_nop 2
    ds_write_b128 v112, v[20:23] offset:1024
    s_waitcnt lgkmcnt(0)
    s_barrier
    s_cmp_ge_u32 s12, 2
    s_cbranch_scc1 L_Xs_117
    ds_read_b64 v[0:1], v108 offset:0
    ds_read_b64 v[2:3], v108 offset:2048
    ds_read_b64 v[4:5], v108 offset:4096
    ds_read_b64 v[6:7], v108 offset:6144
    v_max3_f32 v10, v56, v57, v58
    v_max3_f32 v10, v10, v59, v60
    v_max3_f32 v10, v10, v61, v62
    v_max_f32 v10, v10, v63
    s_waitcnt lgkmcnt(0)
    v_pk_add_f32 v[0:1], v[0:1], v[2:3]
    v_pk_add_f32 v[4:5], v[4:5], v[6:7]
    v_pk_add_f32 v[64:65], v[0:1], v[4:5]
    v_max3_f32 v10, v10, v64, v65
    v_mov_b32 v11, v10
    s_nop 1
    v_permlane16_swap_b32 v10, v11
    v_max_f32 v10, v10, v11
    v_mov_b32 v11, v10
    s_nop 1
    v_permlane32_swap_b32 v10, v11
    v_max_f32 v10, v10, v11
    s_mov_b32 s24, 1035512379
    v_mul_f32 v10, s24, v10
    v_fma_f32 v56, v56, s24, -v10
    v_fma_f32 v57, v57, s24, -v10
    v_fma_f32 v58, v58, s24, -v10
    v_fma_f32 v59, v59, s24, -v10
    v_fma_f32 v60, v60, s24, -v10
    v_fma_f32 v61, v61, s24, -v10
    v_fma_f32 v62, v62, s24, -v10
    v_fma_f32 v63, v63, s24, -v10
    v_fma_f32 v64, v64, s24, -v10
    v_fma_f32 v65, v65, s24, -v10
    v_exp_f32 v56, v56
    v_exp_f32 v57, v57
    v_exp_f32 v58, v58
    v_exp_f32 v59, v59
    v_exp_f32 v60, v60
    v_exp_f32 v61, v61
    v_exp_f32 v62, v62
    v_exp_f32 v63, v63
    v_exp_f32 v64, v64
    v_exp_f32 v65, v65
    v_pk_add_f32 v[0:1], v[56:57], v[58:59]
    v_pk_add_f32 v[2:3], v[60:61], v[62:63]
    v_pk_add_f32 v[0:1], v[0:1], v[64:65]
    v_pk_add_f32 v[0:1], v[0:1], v[2:3]
    v_add_f32 v10, v0, v1
    v_mov_b32 v11, v10
    s_nop 1
    v_permlane16_swap_b32 v10, v11
    v_add_f32 v10, v10, v11
    v_mov_b32 v11, v10
    s_nop 1
    v_permlane32_swap_b32 v10, v11
    v_add_f32 v10, v10, v11
    v_rcp_f32 v10, v10
    s_nop 0
    v_mul_f32 v56, v56, v10
    v_mul_f32 v57, v57, v10
    v_mul_f32 v58, v58, v10
    v_mul_f32 v59, v59, v10
    v_mul_f32 v60, v60, v10
    v_mul_f32 v61, v61, v10
    v_mul_f32 v62, v62, v10
    v_mul_f32 v63, v63, v10
    v_mul_f32 v64, v64, v10
    v_mul_f32 v65, v65, v10
    v_cvt_pk_bf16_f32 v0, |v56|, |v60|
    v_cvt_pk_bf16_f32 v1, |v57|, |v61|
    v_cvt_pk_bf16_f32 v2, |v58|, |v62|
    v_cvt_pk_bf16_f32 v3, |v59|, |v63|
    v_cvt_pk_bf16_f32 v4, |v64|, |v65|
    s_mul_i32 s24, s17, 2560
    s_mul_i32 s25, s12, 1280
    s_add_u32 s24, s24, s25
    s_add_u32 s24, s24, s29
    s_add_u32 s24, s24, 50360320
    buffer_store_dwordx4 v[0:3], v101, s[4:7], s24 offen sc1
    buffer_store_dword v4, v109, s[4:7], s24 offen offset:1024 sc1
L_Xs_117:
    s_mov_b32 s14, s28
    s_cmp_lt_u32 s14, 64
    s_cbranch_scc1 L_X1_116
    s_branch L_fin
L_BA:
    v_and_b32 v20, 63, v119
    v_and_b32 v21, 15, v119
    v_bfe_u32 v22, v119, 4, 2
    s_sub_u32 s24, s13, 192
    s_lshr_b32 s14, s24, 2
    s_and_b32 s15, s24, 3
    v_lshlrev_b32 v172, 4, v20
    v_mov_b32 v173, 0
    v_mov_b32 v175, v20
    s_mov_b32 s19, 1069066811
    v_cmp_eq_u32 s[22:23], 12, v21
    v_cmp_eq_u32 s[28:29], 3, v22
    s_load_dwordx2 s[32:33], s[0:1], 8
    s_mov_b32 s34, 1204224
    s_mov_b32 s35, 0x20000
    s_waitcnt lgkmcnt(0)
    v_lshrrev_b32 v6, 2, v20
    v_lshrrev_b32 v7, 5, v20
    v_lshlrev_b32 v7, 1, v7
    v_and_b32 v24, 3, v20
    v_xor_b32 v7, v7, v24
    v_and_b32 v24, 12, v6
    v_add_u32 v6, v6, v24
    s_mov_b32 s27, 2688
    v_mul_lo_u32 v24, v6, s27
    v_lshl_add_u32 v24, v7, 4, v24
    v_lshrrev_b32 v6, 3, v21
    v_lshlrev_b32 v6, 1, v6
    v_xor_b32 v6, v6, v22
    v_lshlrev_b32 v171, 6, v21
    v_lshl_add_u32 v171, v6, 4, v171
    s_mul_i32 s24, s12, 7
    s_add_u32 s24, s24, 0
    s_lshl_b32 s26, s24, 10
    s_lshr_b32 s25, s24, 1
    s_lshl_b32 s25, s25, 5
    s_and_b32 s24, s24, 1
    s_lshl_b32 s24, s24, 2
    s_add_u32 s24, s24, s25
    s_mul_i32 s24, s24, 2688
    s_mul_i32 s25, s14, 56
    s_add_u32 s24, s24, s25
    s_add_u32 m0, s26, 0
    s_nop 0
    buffer_load_dwordx4 v24, s[32:35], s24 offen offset:0 lds
    s_add_u32 m0, s26, 27776
    s_nop 0
    buffer_load_dwordx4 v24, s[32:35], s24 offen offset:896 lds
    s_add_u32 m0, s26, 55552
    s_nop 0
    buffer_load_dwordx4 v24, s[32:35], s24 offen offset:1792 lds
    s_mul_i32 s24, s12, 7
    s_add_u32 s24, s24, 1
    s_lshl_b32 s26, s24, 10
    s_lshr_b32 s25, s24, 1
    s_lshl_b32 s25, s25, 5
    s_and_b32 s24, s24, 1
    s_lshl_b32 s24, s24, 2
    s_add_u32 s24, s24, s25
    s_mul_i32 s24, s24, 2688
    s_mul_i32 s25, s14, 56
    s_add_u32 s24, s24, s25
    s_add_u32 m0, s26, 0
    s_nop 0
    buffer_load_dwordx4 v24, s[32:35], s24 offen offset:0 lds
    s_add_u32 m0, s26, 27776
    s_nop 0
    buffer_load_dwordx4 v24, s[32:35], s24 offen offset:896 lds
    s_add_u32 m0, s26, 55552
    s_nop 0
    buffer_load_dwordx4 v24, s[32:35], s24 offen offset:1792 lds
    s_mul_i32 s24, s12, 7
    s_add_u32 s24, s24, 2
    s_lshl_b32 s26, s24, 10
    s_lshr_b32 s25, s24, 1
    s_lshl_b32 s25, s25, 5
    s_and_b32 s24, s24, 1
    s_lshl_b32 s24, s24, 2
    s_add_u32 s24, s24, s25
    s_mul_i32 s24, s24, 2688
    s_mul_i32 s25, s14, 56
    s_add_u32 s24, s24, s25
    s_add_u32 m0, s26, 0
    s_nop 0
    buffer_load_dwordx4 v24, s[32:35], s24 offen offset:0 lds
    s_add_u32 m0, s26, 27776
    s_nop 0
    buffer_load_dwordx4 v24, s[32:35], s24 offen offset:896 lds
    s_add_u32 m0, s26, 55552
    s_nop 0
    buffer_load_dwordx4 v24, s[32:35], s24 offen offset:1792 lds
    s_mul_i32 s24, s12, 7
    s_add_u32 s24, s24, 3
    s_lshl_b32 s26, s24, 10
    s_lshr_b32 s25, s24, 1
    s_lshl_b32 s25, s25, 5
    s_and_b32 s24, s24, 1
    s_lshl_b32 s24, s24, 2
    s_add_u32 s24, s24, s25
    s_mul_i32 s24, s24, 2688
    s_mul_i32 s25, s14, 56
    s_add_u32 s24, s24, s25
    s_add_u32 m0, s26, 0
    s_nop 0
    buffer_load_dwordx4 v24, s[32:35], s24 offen offset:0 lds
    s_add_u32 m0, s26, 27776
    s_nop 0
    buffer_load_dwordx4 v24, s[32:35], s24 offen offset:896 lds
    s_add_u32 m0, s26, 55552
    s_nop 0
    buffer_load_dwordx4 v24, s[32:35], s24 offen offset:1792 lds
    s_mul_i32 s24, s12, 7
    s_add_u32 s24, s24, 4
    s_lshl_b32 s26, s24, 10
    s_lshr_b32 s25, s24, 1
    s_lshl_b32 s25, s25, 5
    s_and_b32 s24, s24, 1
    s_lshl_b32 s24, s24, 2
    s_add_u32 s24, s24, s25
    s_mul_i32 s24, s24, 2688
    s_mul_i32 s25, s14, 56
    s_add_u32 s24, s24, s25
    s_add_u32 m0, s26, 0
    s_nop 0
    buffer_load_dwordx4 v24, s[32:35], s24 offen offset:0 lds
    s_add_u32 m0, s26, 27776
    s_nop 0
    buffer_load_dwordx4 v24, s[32:35], s24 offen offset:896 lds
    s_add_u32 m0, s26, 55552
    s_nop 0
    buffer_load_dwordx4 v24, s[32:35], s24 offen offset:1792 lds
    s_mul_i32 s24, s12, 7
    s_add_u32 s24, s24, 5
    s_lshl_b32 s26, s24, 10
    s_lshr_b32 s25, s24, 1
    s_lshl_b32 s25, s25, 5
    s_and_b32 s24, s24, 1
    s_lshl_b32 s24, s24, 2
    s_add_u32 s24, s24, s25
    s_mul_i32 s24, s24, 2688
    s_mul_i32 s25, s14, 56
    s_add_u32 s24, s24, s25
    s_add_u32 m0, s26, 0
    s_nop 0
    buffer_load_dwordx4 v24, s[32:35], s24 offen offset:0 lds
    s_add_u32 m0, s26, 27776
    s_nop 0
    buffer_load_dwordx4 v24, s[32:35], s24 offen offset:896 lds
    s_add_u32 m0, s26, 55552
    s_nop 0
    buffer_load_dwordx4 v24, s[32:35], s24 offen offset:1792 lds
    s_mul_i32 s24, s12, 7
    s_add_u32 s24, s24, 6
    s_lshl_b32 s26, s24, 10
    s_lshr_b32 s25, s24, 1
    s_lshl_b32 s25, s25, 5
    s_and_b32 s24, s24, 1
    s_lshl_b32 s24, s24, 2
    s_add_u32 s24, s24, s25
    s_mul_i32 s24, s24, 2688
    s_mul_i32 s25, s14, 56
    s_add_u32 s24, s24, s25
    s_add_u32 m0, s26, 0
    s_nop 0
    buffer_load_dwordx4 v24, s[32:35], s24 offen offset:0 lds
    s_add_u32 m0, s26, 27776
    s_nop 0
    buffer_load_dwordx4 v24, s[32:35], s24 offen offset:896 lds
    s_add_u32 m0, s26, 55552
    s_nop 0
    buffer_load_dwordx4 v24, s[32:35], s24 offen offset:1792 lds
    s_load_dwordx2 s[36:37], s[0:1], 16
    s_mov_b32 s38, 25088
    s_mov_b32 s39, 0x20000
    s_waitcnt lgkmcnt(0)
    v_mul_u32_u24 v6, 448, v22
    v_lshl_add_u32 v6, v21, 1, v6
    v_mov_b32 v8, 1073741824
    v_cndmask_b32 v7, v6, v8, s[28:29]
    v_cmp_gt_u32 vcc, 12, v21
    s_nop 1
    v_cndmask_b32 v9, v8, v6, vcc
    v_cndmask_b32 v10, v8, v7, vcc
    s_mul_i32 s24, s14, 1568
    buffer_load_ushort v32, v6, s[36:39], s24 offen offset:0
    buffer_load_ushort v48, v6, s[36:39], s24 offen offset:56
    buffer_load_ushort v33, v6, s[36:39], s24 offen offset:112
    buffer_load_ushort v49, v6, s[36:39], s24 offen offset:168
    buffer_load_ushort v34, v7, s[36:39], s24 offen offset:224
    buffer_load_ushort v50, v7, s[36:39], s24 offen offset:280
    buffer_load_ushort v35, v7, s[36:39], s24 offen offset:336
    buffer_load_ushort v51, v7, s[36:39], s24 offen offset:392
    buffer_load_ushort v36, v9, s[36:39], s24 offen offset:32
    buffer_load_ushort v52, v9, s[36:39], s24 offen offset:88
    buffer_load_ushort v37, v9, s[36:39], s24 offen offset:144
    buffer_load_ushort v53, v9, s[36:39], s24 offen offset:200
    buffer_load_ushort v38, v10, s[36:39], s24 offen offset:256
    buffer_load_ushort v54, v10, s[36:39], s24 offen offset:312
    buffer_load_ushort v39, v10, s[36:39], s24 offen offset:368
    buffer_load_ushort v55, v10, s[36:39], s24 offen offset:424
    v_lshlrev_b32 v6, 3, v22
    v_sub_u32 v6, v21, v6
    v_add_u32 v7, 16, v6
    v_mov_b32 v9, 99
    v_cndmask_b32 v7, v9, v7, vcc
    v_mov_b32 v9, 0x3f80
    v_mov_b32 v10, 0x3f800000
    v_cmp_eq_u32 vcc, 0, v6
    s_nop 1
    v_cndmask_b32 v40, 0, v9, vcc
    v_cmp_eq_u32 vcc, 1, v6
    s_nop 1
    v_cndmask_b32 v40, v40, v10, vcc
    v_cmp_eq_u32 vcc, 2, v6
    s_nop 1
    v_cndmask_b32 v41, 0, v9, vcc
    v_cmp_eq_u32 vcc, 3, v6
    s_nop 1
    v_cndmask_b32 v41, v41, v10, vcc
    v_cmp_eq_u32 vcc, 4, v6
    s_nop 1
    v_cndmask_b32 v42, 0, v9, vcc
    v_cmp_eq_u32 vcc, 5, v6
    s_nop 1
    v_cndmask_b32 v42, v42, v10, vcc
    v_cmp_eq_u32 vcc, 6, v6
    s_nop 1
    v_cndmask_b32 v43, 0, v9, vcc
    v_cmp_eq_u32 vcc, 7, v6
    s_nop 1
    v_cndmask_b32 v43, v43, v10, vcc
    v_cmp_eq_u32 vcc, 0, v7
    s_nop 1
    v_cndmask_b32 v44, 0, v9, vcc
    v_cmp_eq_u32 vcc, 1, v7
    s_nop 1
    v_cndmask_b32 v44, v44, v10, vcc
    v_cmp_eq_u32 vcc, 2, v7
    s_nop 1
    v_cndmask_b32 v45, 0, v9, vcc
    v_cmp_eq_u32 vcc, 3, v7
    s_nop 1
    v_cndmask_b32 v45, v45, v10, vcc
    v_cmp_eq_u32 vcc, 4, v7
    s_nop 1
    v_cndmask_b32 v46, 0, v9, vcc
    v_cmp_eq_u32 vcc, 5, v7
    s_nop 1
    v_cndmask_b32 v46, v46, v10, vcc
    v_cmp_eq_u32 vcc, 6, v7
    s_nop 1
    v_cndmask_b32 v47, 0, v9, vcc
    v_cmp_eq_u32 vcc, 7, v7
    s_nop 1
    v_cndmask_b32 v47, v47, v10, vcc
    s_load_dwordx2 s[36:37], s[0:1], 88
    s_mov_b32 s38, 896
    s_mov_b32 s39, 0x20000
    s_waitcnt lgkmcnt(0)
    v_lshlrev_b32 v25, 4, v22
    s_lshl_b32 s24, s12, 11
    v_add_u32 v26, s24, v171
    v_add_u32 v27, s24, v172
    s_mov_b32 s18, s12
    s_waitcnt vmcnt(0)
    s_barrier
    v_lshl_or_b32 v32, v48, 16, v32
    v_lshl_or_b32 v33, v49, 16, v33
    v_lshl_or_b32 v34, v50, 16, v34
    v_lshl_or_b32 v35, v51, 16, v35
    v_lshl_or_b32 v36, v52, 16, v36
    v_lshl_or_b32 v37, v53, 16, v37
    v_lshl_or_b32 v38, v54, 16, v38
    v_lshl_or_b32 v39, v55, 16, v39
L_Bb_121:
    s_lshl_b32 s24, s18, 6
    buffer_load_dwordx4 v[144:147], v25, s[36:39], s24 offen
    ds_read_b128 v[48:51], v26 offset:0
    ds_read_b128 v[52:55], v26 offset:1024
    ds_read_b128 v[56:59], v26 offset:28672
    ds_read_b128 v[60:63], v26 offset:29696
    ds_read_b128 v[64:67], v26 offset:57344
    ds_read_b128 v[68:71], v26 offset:58368
    s_waitcnt lgkmcnt(0)
    v_mfma_f32_16x16x32_bf16 v[72:75], v[48:51], v[32:35], 0
    v_mfma_f32_16x16x32_bf16 v[76:79], v[52:55], v[32:35], 0
    v_mfma_f32_16x16x32_bf16 v[80:83], v[48:51], v[36:39], 0
    v_mfma_f32_16x16x32_bf16 v[84:87], v[52:55], v[36:39], 0
    v_mfma_f32_16x16x32_bf16 v[88:91], v[56:59], v[32:35], 0
    v_mfma_f32_16x16x32_bf16 v[92:95], v[60:63], v[32:35], 0
    v_mfma_f32_16x16x32_bf16 v[96:99], v[56:59], v[36:39], 0
    v_mfma_f32_16x16x32_bf16 v[100:103], v[60:63], v[36:39], 0
    v_mfma_f32_16x16x32_bf16 v[104:107], v[64:67], v[40:43], 0
    v_mfma_f32_16x16x32_bf16 v[108:111], v[68:71], v[40:43], 0
    v_mfma_f32_16x16x32_bf16 v[112:115], v[64:67], v[44:47], 0
    v_mfma_f32_16x16x32_bf16 v[116:119], v[68:71], v[44:47], 0
    s_waitcnt vmcnt(0)
    v_cvt_pk_bf16_f32 v120, v72, v73
    v_cvt_pk_bf16_f32 v121, v74, v75
    v_cvt_pk_bf16_f32 v122, v76, v77
    v_cvt_pk_bf16_f32 v123, v78, v79
    ds_write_b128 v27, v[120:123] offset:0
    v_cvt_pk_bf16_f32 v124, v80, v81
    v_cvt_pk_bf16_f32 v125, v82, v83
    v_cvt_pk_bf16_f32 v126, v84, v85
    v_cvt_pk_bf16_f32 v127, v86, v87
    v_cndmask_b32 v124, v124, v144, s[22:23]
    v_cndmask_b32 v125, v125, v145, s[22:23]
    v_cndmask_b32 v126, v126, v146, s[22:23]
    v_cndmask_b32 v127, v127, v147, s[22:23]
    ds_write_b128 v27, v[124:127] offset:1024
    v_cvt_pk_bf16_f32 v128, v88, v89
    v_cvt_pk_bf16_f32 v129, v90, v91
    v_cvt_pk_bf16_f32 v130, v92, v93
    v_cvt_pk_bf16_f32 v131, v94, v95
    ds_write_b128 v27, v[128:131] offset:28672
    v_cvt_pk_bf16_f32 v132, v96, v97
    v_cvt_pk_bf16_f32 v133, v98, v99
    v_cvt_pk_bf16_f32 v134, v100, v101
    v_cvt_pk_bf16_f32 v135, v102, v103
    ds_write_b128 v27, v[132:135] offset:29696
    v_cvt_pk_bf16_f32 v136, v104, v105
    v_cvt_pk_bf16_f32 v137, v106, v107
    v_cvt_pk_bf16_f32 v138, v108, v109
    v_cvt_pk_bf16_f32 v139, v110, v111
    ds_write_b128 v27, v[136:139] offset:57344
    v_cvt_pk_bf16_f32 v140, v112, v113
    v_cvt_pk_bf16_f32 v141, v114, v115
    v_cvt_pk_bf16_f32 v142, v116, v117
    v_cvt_pk_bf16_f32 v143, v118, v119
    ds_write_b128 v27, v[140:143] offset:58368
    v_add_u32 v26, 8192, v26
    v_add_u32 v27, 8192, v27
    s_add_u32 s18, s18, 4
    s_cmp_lt_u32 s18, 14
    s_cbranch_scc1 L_Bb_121
    s_waitcnt lgkmcnt(0)
    s_barrier
    v_add_u32 v26, 57344, v172
    ds_read_b128 a[0:3], v172 offset:28672
    ds_read_b128 a[4:7], v172 offset:30720
    ds_read_b128 a[8:11], v172 offset:32768
    ds_read_b128 a[12:15], v172 offset:34816
    ds_read_b128 a[16:19], v172 offset:36864
    ds_read_b128 a[20:23], v172 offset:38912
    ds_read_b128 a[24:27], v172 offset:40960
    ds_read_b128 a[28:31], v172 offset:43008
    ds_read_b128 a[32:35], v172 offset:45056
    ds_read_b128 a[36:39], v172 offset:47104
    ds_read_b128 a[40:43], v172 offset:49152
    ds_read_b128 a[44:47], v172 offset:51200
    ds_read_b128 a[48:51], v172 offset:53248
    ds_read_b128 a[52:55], v172 offset:55296
    s_waitcnt lgkmcnt(0)
    ds_read_b128 a[56:59], v172 offset:29696
    ds_read_b128 a[60:63], v172 offset:31744
    ds_read_b128 a[64:67], v172 offset:33792
    ds_read_b128 a[68:71], v172 offset:35840
    ds_read_b128 a[72:75], v172 offset:37888
    ds_read_b128 a[76:79], v172 offset:39936
    ds_read_b128 a[80:83], v172 offset:41984
    ds_read_b128 a[84:87], v172 offset:44032
    ds_read_b128 a[88:91], v172 offset:46080
    ds_read_b128 a[92:95], v172 offset:48128
    ds_read_b128 a[96:99], v172 offset:50176
    ds_read_b128 a[100:103], v172 offset:52224
    ds_read_b128 a[104:107], v172 offset:54272
    ds_read_b128 a[108:111], v172 offset:56320
    s_waitcnt lgkmcnt(0)
    ds_read_b128 a[112:115], v26 offset:0
    ds_read_b128 a[116:119], v26 offset:2048
    ds_read_b128 a[120:123], v26 offset:4096
    ds_read_b128 a[124:127], v26 offset:6144
    ds_read_b128 a[128:131], v26 offset:8192
    ds_read_b128 a[132:135], v26 offset:10240
    ds_read_b128 a[136:139], v26 offset:12288
    ds_read_b128 a[140:143], v26 offset:14336
    ds_read_b128 a[144:147], v26 offset:16384
    ds_read_b128 a[148:151], v26 offset:18432
    ds_read_b128 a[152:155], v26 offset:20480
    ds_read_b128 a[156:159], v26 offset:22528
    ds_read_b128 a[160:163], v26 offset:24576
    ds_read_b128 a[164:167], v26 offset:26624
    s_waitcnt lgkmcnt(0)
    ds_read_b128 a[168:171], v26 offset:1024
    ds_read_b128 a[172:175], v26 offset:3072
    ds_read_b128 a[176:179], v26 offset:5120
    ds_read_b128 a[180:183], v26 offset:7168
    ds_read_b128 a[184:187], v26 offset:9216
    ds_read_b128 a[188:191], v26 offset:11264
    ds_read_b128 a[192:195], v26 offset:13312
    ds_read_b128 a[196:199], v26 offset:15360
    ds_read_b128 a[200:203], v26 offset:17408
    ds_read_b128 a[204:207], v26 offset:19456
    ds_read_b128 a[208:211], v26 offset:21504
    ds_read_b128 a[212:215], v26 offset:23552
    ds_read_b128 a[216:219], v26 offset:25600
    ds_read_b128 a[220:223], v26 offset:27648
    s_waitcnt lgkmcnt(0)
    ds_read_b128 a[224:227], v172 offset:0
    ds_read_b128 a[228:231], v172 offset:2048
    ds_read_b128 a[232:235], v172 offset:4096
    ds_read_b128 a[236:239], v172 offset:6144
    ds_read_b128 a[240:243], v172 offset:8192
    ds_read_b128 a[244:247], v172 offset:10240
    ds_read_b128 a[248:251], v172 offset:12288
    ds_read_b128 a[252:255], v172 offset:14336
    ds_read_b128 v[176:179], v172 offset:16384
    ds_read_b128 v[180:183], v172 offset:18432
    ds_read_b128 v[184:187], v172 offset:20480
    ds_read_b128 v[188:191], v172 offset:22528
    ds_read_b128 v[192:195], v172 offset:24576
    ds_read_b128 v[196:199], v172 offset:26624
    s_waitcnt lgkmcnt(0)
    ds_read_b128 v[200:203], v172 offset:1024
    ds_read_b128 v[204:207], v172 offset:3072
    ds_read_b128 v[208:211], v172 offset:5120
    ds_read_b128 v[212:215], v172 offset:7168
    ds_read_b128 v[216:219], v172 offset:9216
    ds_read_b128 v[220:223], v172 offset:11264
    ds_read_b128 v[224:227], v172 offset:13312
    ds_read_b128 v[228:231], v172 offset:15360
    ds_read_b128 v[232:235], v172 offset:17408
    ds_read_b128 v[236:239], v172 offset:19456
    ds_read_b128 v[240:243], v172 offset:21504
    ds_read_b128 v[244:247], v172 offset:23552
    ds_read_b128 v[248:251], v172 offset:25600
    ds_read_b128 v[252:255], v172 offset:27648
    s_waitcnt lgkmcnt(0)
    s_barrier
    v_lshrrev_b32 v6, 2, v20
    v_lshrrev_b32 v7, 5, v20
    v_lshlrev_b32 v7, 1, v7
    v_and_b32 v170, 3, v20
    v_xor_b32 v7, v7, v170
    s_mov_b32 s27, 1792
    v_mul_lo_u32 v170, v6, s27
    v_lshl_add_u32 v170, v7, 4, v170
    s_mul_i32 s17, s12, 28672
    v_add_u32 v171, s17, v171
    v_lshlrev_b32 v6, 3, v21
    v_mov_b32 v8, 1073741824
    v_cndmask_b32 v174, v8, v6, s[28:29]
    s_lshl_b32 s24, s15, 2
    s_add_u32 s24, s24, s12
    s_mul_i32 s16, s24, 114688
    s_mov_b32 s18, 0
    s_add_u32 m0, s17, 0
    s_nop 0
    buffer_load_dwordx4 v170, s[8:11], s16 offen offset:0 lds
    s_add_u32 m0, s17, 960
    s_nop 0
    buffer_load_dwordx4 v170, s[8:11], s16 offen offset:64 lds
    s_add_u32 m0, s17, 1920
    s_nop 0
    buffer_load_dwordx4 v170, s[8:11], s16 offen offset:128 lds
    s_add_u32 m0, s17, 2880
    s_nop 0
    buffer_load_dwordx4 v170, s[8:11], s16 offen offset:192 lds
    s_add_u32 m0, s17, 3840
    s_nop 0
    buffer_load_dwordx4 v170, s[8:11], s16 offen offset:256 lds
    s_add_u32 m0, s17, 4800
    s_nop 0
    buffer_load_dwordx4 v170, s[8:11], s16 offen offset:320 lds
    s_add_u32 m0, s17, 5760
    s_nop 0
    buffer_load_dwordx4 v170, s[8:11], s16 offen offset:384 lds
    s_add_u32 m0, s17, 6720
    s_nop 0
    buffer_load_dwordx4 v170, s[8:11], s16 offen offset:448 lds
    s_add_u32 m0, s17, 7680
    s_nop 0
    buffer_load_dwordx4 v170, s[8:11], s16 offen offset:512 lds
    s_add_u32 m0, s17, 8640
    s_nop 0
    buffer_load_dwordx4 v170, s[8:11], s16 offen offset:576 lds
    s_add_u32 m0, s17, 9600
    s_nop 0
    buffer_load_dwordx4 v170, s[8:11], s16 offen offset:640 lds
    s_add_u32 m0, s17, 10560
    s_nop 0
    buffer_load_dwordx4 v170, s[8:11], s16 offen offset:704 lds
    s_add_u32 m0, s17, 11520
    s_nop 0
    buffer_load_dwordx4 v170, s[8:11], s16 offen offset:768 lds
    s_add_u32 m0, s17, 12480
    s_nop 0
    buffer_load_dwordx4 v170, s[8:11], s16 offen offset:832 lds
    s_add_u32 m0, s17, 13440
    s_nop 0
    buffer_load_dwordx4 v170, s[8:11], s16 offen offset:896 lds
    s_add_u32 m0, s17, 14400
    s_nop 0
    buffer_load_dwordx4 v170, s[8:11], s16 offen offset:960 lds
    s_add_u32 m0, s17, 15360
    s_nop 0
    buffer_load_dwordx4 v170, s[8:11], s16 offen offset:1024 lds
    s_add_u32 m0, s17, 16320
    s_nop 0
    buffer_load_dwordx4 v170, s[8:11], s16 offen offset:1088 lds
    s_add_u32 m0, s17, 17280
    s_nop 0
    buffer_load_dwordx4 v170, s[8:11], s16 offen offset:1152 lds
    s_add_u32 m0, s17, 18240
    s_nop 0
    buffer_load_dwordx4 v170, s[8:11], s16 offen offset:1216 lds
    s_add_u32 m0, s17, 19200
    s_nop 0
    buffer_load_dwordx4 v170, s[8:11], s16 offen offset:1280 lds
    s_add_u32 m0, s17, 20160
    s_nop 0
    buffer_load_dwordx4 v170, s[8:11], s16 offen offset:1344 lds
    s_add_u32 m0, s17, 21120
    s_nop 0
    buffer_load_dwordx4 v170, s[8:11], s16 offen offset:1408 lds
    s_add_u32 m0, s17, 22080
    s_nop 0
    buffer_load_dwordx4 v170, s[8:11], s16 offen offset:1472 lds
    s_add_u32 m0, s17, 23040
    s_nop 0
    buffer_load_dwordx4 v170, s[8:11], s16 offen offset:1536 lds
    s_add_u32 m0, s17, 24000
    s_nop 0
    buffer_load_dwordx4 v170, s[8:11], s16 offen offset:1600 lds
    s_add_u32 m0, s17, 24960
    s_nop 0
    buffer_load_dwordx4 v170, s[8:11], s16 offen offset:1664 lds
    s_add_u32 m0, s17, 25920
    s_nop 0
    buffer_load_dwordx4 v170, s[8:11], s16 offen offset:1728 lds
    v_mov_b32 v48, 0
    v_mov_b32 v49, 0
    v_mov_b32 v50, 0
    v_mov_b32 v51, 0
    v_mov_b32 v52, 0
    v_mov_b32 v53, 0
    v_mov_b32 v54, 0
    v_mov_b32 v55, 0
    v_mov_b32 v56, 0
    v_mov_b32 v57, 0
    v_mov_b32 v58, 0
    v_mov_b32 v59, 0
    v_mov_b32 v60, 0
    v_mov_b32 v61, 0
    v_mov_b32 v62, 0
    v_mov_b32 v63, 0
    v_mov_b32 v64, 0
    v_mov_b32 v65, 0
    v_mov_b32 v66, 0
    v_mov_b32 v67, 0
    v_mov_b32 v68, 0
    v_mov_b32 v69, 0
    v_mov_b32 v70, 0
    v_mov_b32 v71, 0
    v_mov_b32 v72, 0
    v_mov_b32 v73, 0
    v_mov_b32 v74, 0
    v_mov_b32 v75, 0
    v_mov_b32 v76, 0
    v_mov_b32 v77, 0
    v_mov_b32 v78, 0
    v_mov_b32 v79, 0
    v_cmp_gt_u32 s[42:43], 12, v21
L_B1_122:
    s_waitcnt vmcnt(14)
    ds_read_b128 v[0:3], v171 offset:0
    ds_read_b128 v[4:7], v171 offset:1024
    s_waitcnt lgkmcnt(1)
    v_mfma_f32_16x16x32_bf16 v[16:19], v[0:3], a[0:3], 0
    ds_read_b128 v[8:11], v171 offset:2048
    v_mfma_f32_16x16x32_bf16 v[20:23], v[0:3], a[56:59], 0
    v_mfma_f32_16x16x32_bf16 v[24:27], v[0:3], a[112:115], 0
    v_mfma_f32_16x16x32_bf16 v[28:31], v[0:3], a[168:171], 0
    s_waitcnt lgkmcnt(1)
    v_mfma_f32_16x16x32_bf16 v[16:19], v[4:7], a[4:7], v[16:19]
    ds_read_b128 v[0:3], v171 offset:3072
    v_mfma_f32_16x16x32_bf16 v[20:23], v[4:7], a[60:63], v[20:23]
    v_mfma_f32_16x16x32_bf16 v[24:27], v[4:7], a[116:119], v[24:27]
    v_mfma_f32_16x16x32_bf16 v[28:31], v[4:7], a[172:175], v[28:31]
    s_waitcnt lgkmcnt(1)
    v_mfma_f32_16x16x32_bf16 v[16:19], v[8:11], a[8:11], v[16:19]
    ds_read_b128 v[4:7], v171 offset:4096
    v_mfma_f32_16x16x32_bf16 v[20:23], v[8:11], a[64:67], v[20:23]
    v_mfma_f32_16x16x32_bf16 v[24:27], v[8:11], a[120:123], v[24:27]
    v_mfma_f32_16x16x32_bf16 v[28:31], v[8:11], a[176:179], v[28:31]
    s_waitcnt lgkmcnt(1)
    v_mfma_f32_16x16x32_bf16 v[16:19], v[0:3], a[12:15], v[16:19]
    ds_read_b128 v[8:11], v171 offset:5120
    v_mfma_f32_16x16x32_bf16 v[20:23], v[0:3], a[68:71], v[20:23]
    v_mfma_f32_16x16x32_bf16 v[24:27], v[0:3], a[124:127], v[24:27]
    v_mfma_f32_16x16x32_bf16 v[28:31], v[0:3], a[180:183], v[28:31]
    s_waitcnt lgkmcnt(1)
    v_mfma_f32_16x16x32_bf16 v[16:19], v[4:7], a[16:19], v[16:19]
    ds_read_b128 v[0:3], v171 offset:6144
    v_mfma_f32_16x16x32_bf16 v[20:23], v[4:7], a[72:75], v[20:23]
    v_mfma_f32_16x16x32_bf16 v[24:27], v[4:7], a[128:131], v[24:27]
    v_mfma_f32_16x16x32_bf16 v[28:31], v[4:7], a[184:187], v[28:31]
    s_waitcnt lgkmcnt(1)
    v_mfma_f32_16x16x32_bf16 v[16:19], v[8:11], a[20:23], v[16:19]
    ds_read_b128 v[4:7], v171 offset:7168
    v_mfma_f32_16x16x32_bf16 v[20:23], v[8:11], a[76:79], v[20:23]
    v_mfma_f32_16x16x32_bf16 v[24:27], v[8:11], a[132:135], v[24:27]
    v_mfma_f32_16x16x32_bf16 v[28:31], v[8:11], a[188:191], v[28:31]
    s_waitcnt lgkmcnt(1)
    v_mfma_f32_16x16x32_bf16 v[16:19], v[0:3], a[24:27], v[16:19]
    ds_read_b128 v[8:11], v171 offset:8192
    v_mfma_f32_16x16x32_bf16 v[20:23], v[0:3], a[80:83], v[20:23]
    v_mfma_f32_16x16x32_bf16 v[24:27], v[0:3], a[136:139], v[24:27]
    v_mfma_f32_16x16x32_bf16 v[28:31], v[0:3], a[192:195], v[28:31]
    s_waitcnt lgkmcnt(1)
    v_mfma_f32_16x16x32_bf16 v[16:19], v[4:7], a[28:31], v[16:19]
    ds_read_b128 v[0:3], v171 offset:9216
    v_mfma_f32_16x16x32_bf16 v[20:23], v[4:7], a[84:87], v[20:23]
    v_mfma_f32_16x16x32_bf16 v[24:27], v[4:7], a[140:143], v[24:27]
    v_mfma_f32_16x16x32_bf16 v[28:31], v[4:7], a[196:199], v[28:31]
    s_waitcnt lgkmcnt(1)
    v_mfma_f32_16x16x32_bf16 v[16:19], v[8:11], a[32:35], v[16:19]
    ds_read_b128 v[4:7], v171 offset:10240
    v_mfma_f32_16x16x32_bf16 v[20:23], v[8:11], a[88:91], v[20:23]
    v_mfma_f32_16x16x32_bf16 v[24:27], v[8:11], a[144:147], v[24:27]
    v_mfma_f32_16x16x32_bf16 v[28:31], v[8:11], a[200:203], v[28:31]
    s_waitcnt lgkmcnt(1)
    v_mfma_f32_16x16x32_bf16 v[16:19], v[0:3], a[36:39], v[16:19]
    ds_read_b128 v[8:11], v171 offset:11264
    v_mfma_f32_16x16x32_bf16 v[20:23], v[0:3], a[92:95], v[20:23]
    v_mfma_f32_16x16x32_bf16 v[24:27], v[0:3], a[148:151], v[24:27]
    v_mfma_f32_16x16x32_bf16 v[28:31], v[0:3], a[204:207], v[28:31]
    s_waitcnt lgkmcnt(1)
    v_mfma_f32_16x16x32_bf16 v[16:19], v[4:7], a[40:43], v[16:19]
    ds_read_b128 v[0:3], v171 offset:12288
    v_mfma_f32_16x16x32_bf16 v[20:23], v[4:7], a[96:99], v[20:23]
    v_mfma_f32_16x16x32_bf16 v[24:27], v[4:7], a[152:155], v[24:27]
    v_mfma_f32_16x16x32_bf16 v[28:31], v[4:7], a[208:211], v[28:31]
    s_waitcnt lgkmcnt(1)
    v_mfma_f32_16x16x32_bf16 v[16:19], v[8:11], a[44:47], v[16:19]
    ds_read_b128 v[4:7], v171 offset:13312
    v_mfma_f32_16x16x32_bf16 v[20:23], v[8:11], a[100:103], v[20:23]
    v_mfma_f32_16x16x32_bf16 v[24:27], v[8:11], a[156:159], v[24:27]
    v_mfma_f32_16x16x32_bf16 v[28:31], v[8:11], a[212:215], v[28:31]
    s_waitcnt lgkmcnt(1)
    v_mfma_f32_16x16x32_bf16 v[16:19], v[0:3], a[48:51], v[16:19]
    v_mfma_f32_16x16x32_bf16 v[20:23], v[0:3], a[104:107], v[20:23]
    v_mfma_f32_16x16x32_bf16 v[24:27], v[0:3], a[160:163], v[24:27]
    v_mfma_f32_16x16x32_bf16 v[28:31], v[0:3], a[216:219], v[28:31]
    s_waitcnt lgkmcnt(0)
    v_mfma_f32_16x16x32_bf16 v[16:19], v[4:7], a[52:55], v[16:19]
    v_mfma_f32_16x16x32_bf16 v[20:23], v[4:7], a[108:111], v[20:23]
    v_mfma_f32_16x16x32_bf16 v[24:27], v[4:7], a[164:167], v[24:27]
    v_mfma_f32_16x16x32_bf16 v[28:31], v[4:7], a[220:223], v[28:31]
    s_add_u32 s24, s16, 28672
    s_add_u32 m0, s17, 0
    s_nop 0
    buffer_load_dwordx4 v170, s[8:11], s24 offen offset:0 lds
    s_add_u32 m0, s17, 960
    s_nop 0
    buffer_load_dwordx4 v170, s[8:11], s24 offen offset:64 lds
    s_add_u32 m0, s17, 1920
    s_nop 0
    buffer_load_dwordx4 v170, s[8:11], s24 offen offset:128 lds
    s_add_u32 m0, s17, 2880
    s_nop 0
    buffer_load_dwordx4 v170, s[8:11], s24 offen offset:192 lds
    s_add_u32 m0, s17, 3840
    s_nop 0
    buffer_load_dwordx4 v170, s[8:11], s24 offen offset:256 lds
    s_add_u32 m0, s17, 4800
    s_nop 0
    buffer_load_dwordx4 v170, s[8:11], s24 offen offset:320 lds
    s_add_u32 m0, s17, 5760
    s_nop 0
    buffer_load_dwordx4 v170, s[8:11], s24 offen offset:384 lds
    s_add_u32 m0, s17, 6720
    s_nop 0
    buffer_load_dwordx4 v170, s[8:11], s24 offen offset:448 lds
    s_add_u32 m0, s17, 7680
    s_nop 0
    buffer_load_dwordx4 v170, s[8:11], s24 offen offset:512 lds
    s_add_u32 m0, s17, 8640
    s_nop 0
    buffer_load_dwordx4 v170, s[8:11], s24 offen offset:576 lds
    s_add_u32 m0, s17, 9600
    s_nop 0
    buffer_load_dwordx4 v170, s[8:11], s24 offen offset:640 lds
    s_add_u32 m0, s17, 10560
    s_nop 0
    buffer_load_dwordx4 v170, s[8:11], s24 offen offset:704 lds
    s_add_u32 m0, s17, 11520
    s_nop 0
    buffer_load_dwordx4 v170, s[8:11], s24 offen offset:768 lds
    s_add_u32 m0, s17, 12480
    s_nop 0
    buffer_load_dwordx4 v170, s[8:11], s24 offen offset:832 lds
    s_waitcnt vmcnt(14)
    ds_read_b128 v[0:3], v171 offset:14336
    ds_read_b128 v[4:7], v171 offset:15360
    s_waitcnt lgkmcnt(1)
    v_mfma_f32_16x16x32_bf16 v[32:35], v[0:3], a[0:3], 0
    ds_read_b128 v[8:11], v171 offset:16384
    v_mfma_f32_16x16x32_bf16 v[36:39], v[0:3], a[56:59], 0
    v_mfma_f32_16x16x32_bf16 v[40:43], v[0:3], a[112:115], 0
    v_mfma_f32_16x16x32_bf16 v[44:47], v[0:3], a[168:171], 0
    s_waitcnt lgkmcnt(1)
    v_mfma_f32_16x16x32_bf16 v[32:35], v[4:7], a[4:7], v[32:35]
    ds_read_b128 v[0:3], v171 offset:17408
    v_mfma_f32_16x16x32_bf16 v[36:39], v[4:7], a[60:63], v[36:39]
    v_mfma_f32_16x16x32_bf16 v[40:43], v[4:7], a[116:119], v[40:43]
    v_mfma_f32_16x16x32_bf16 v[44:47], v[4:7], a[172:175], v[44:47]
    s_waitcnt lgkmcnt(1)
    v_mfma_f32_16x16x32_bf16 v[32:35], v[8:11], a[8:11], v[32:35]
    ds_read_b128 v[4:7], v171 offset:18432
    v_mfma_f32_16x16x32_bf16 v[36:39], v[8:11], a[64:67], v[36:39]
    v_mfma_f32_16x16x32_bf16 v[40:43], v[8:11], a[120:123], v[40:43]
    v_mfma_f32_16x16x32_bf16 v[44:47], v[8:11], a[176:179], v[44:47]
    s_waitcnt lgkmcnt(1)
    v_mfma_f32_16x16x32_bf16 v[32:35], v[0:3], a[12:15], v[32:35]
    ds_read_b128 v[8:11], v171 offset:19456
    v_mfma_f32_16x16x32_bf16 v[36:39], v[0:3], a[68:71], v[36:39]
    v_mfma_f32_16x16x32_bf16 v[40:43], v[0:3], a[124:127], v[40:43]
    v_mfma_f32_16x16x32_bf16 v[44:47], v[0:3], a[180:183], v[44:47]
    s_waitcnt lgkmcnt(1)
    v_mfma_f32_16x16x32_bf16 v[32:35], v[4:7], a[16:19], v[32:35]
    ds_read_b128 v[0:3], v171 offset:20480
    v_mfma_f32_16x16x32_bf16 v[36:39], v[4:7], a[72:75], v[36:39]
    v_mfma_f32_16x16x32_bf16 v[40:43], v[4:7], a[128:131], v[40:43]
    v_mfma_f32_16x16x32_bf16 v[44:47], v[4:7], a[184:187], v[44:47]
    s_waitcnt lgkmcnt(1)
    v_mfma_f32_16x16x32_bf16 v[32:35], v[8:11], a[20:23], v[32:35]
    ds_read_b128 v[4:7], v171 offset:21504
    v_mfma_f32_16x16x32_bf16 v[36:39], v[8:11], a[76:79], v[36:39]
    v_mfma_f32_16x16x32_bf16 v[40:43], v[8:11], a[132:135], v[40:43]
    v_mfma_f32_16x16x32_bf16 v[44:47], v[8:11], a[188:191], v[44:47]
    s_waitcnt lgkmcnt(1)
    v_mfma_f32_16x16x32_bf16 v[32:35], v[0:3], a[24:27], v[32:35]
    ds_read_b128 v[8:11], v171 offset:22528
    v_mfma_f32_16x16x32_bf16 v[36:39], v[0:3], a[80:83], v[36:39]
    v_mfma_f32_16x16x32_bf16 v[40:43], v[0:3], a[136:139], v[40:43]
    v_mfma_f32_16x16x32_bf16 v[44:47], v[0:3], a[192:195], v[44:47]
    s_waitcnt lgkmcnt(1)
    v_mfma_f32_16x16x32_bf16 v[32:35], v[4:7], a[28:31], v[32:35]
    ds_read_b128 v[0:3], v171 offset:23552
    v_mfma_f32_16x16x32_bf16 v[36:39], v[4:7], a[84:87], v[36:39]
    v_mfma_f32_16x16x32_bf16 v[40:43], v[4:7], a[140:143], v[40:43]
    v_mfma_f32_16x16x32_bf16 v[44:47], v[4:7], a[196:199], v[44:47]
    s_waitcnt lgkmcnt(1)
    v_mfma_f32_16x16x32_bf16 v[32:35], v[8:11], a[32:35], v[32:35]
    ds_read_b128 v[4:7], v171 offset:24576
    v_mfma_f32_16x16x32_bf16 v[36:39], v[8:11], a[88:91], v[36:39]
    v_mfma_f32_16x16x32_bf16 v[40:43], v[8:11], a[144:147], v[40:43]
    v_mfma_f32_16x16x32_bf16 v[44:47], v[8:11], a[200:203], v[44:47]
    s_waitcnt lgkmcnt(1)
    v_mfma_f32_16x16x32_bf16 v[32:35], v[0:3], a[36:39], v[32:35]
    ds_read_b128 v[8:11], v171 offset:25600
    v_mfma_f32_16x16x32_bf16 v[36:39], v[0:3], a[92:95], v[36:39]
    v_mfma_f32_16x16x32_bf16 v[40:43], v[0:3], a[148:151], v[40:43]
    v_mfma_f32_16x16x32_bf16 v[44:47], v[0:3], a[204:207], v[44:47]
    s_waitcnt lgkmcnt(1)
    v_mfma_f32_16x16x32_bf16 v[32:35], v[4:7], a[40:43], v[32:35]
    ds_read_b128 v[0:3], v171 offset:26624
    v_mfma_f32_16x16x32_bf16 v[36:39], v[4:7], a[96:99], v[36:39]
    v_mfma_f32_16x16x32_bf16 v[40:43], v[4:7], a[152:155], v[40:43]
    v_mfma_f32_16x16x32_bf16 v[44:47], v[4:7], a[208:211], v[44:47]
    s_waitcnt lgkmcnt(1)
    v_mfma_f32_16x16x32_bf16 v[32:35], v[8:11], a[44:47], v[32:35]
    ds_read_b128 v[4:7], v171 offset:27648
    v_mfma_f32_16x16x32_bf16 v[36:39], v[8:11], a[100:103], v[36:39]
    v_mfma_f32_16x16x32_bf16 v[40:43], v[8:11], a[156:159], v[40:43]
    v_mfma_f32_16x16x32_bf16 v[44:47], v[8:11], a[212:215], v[44:47]
    s_waitcnt lgkmcnt(1)
    v_mfma_f32_16x16x32_bf16 v[32:35], v[0:3], a[48:51], v[32:35]
    v_mfma_f32_16x16x32_bf16 v[36:39], v[0:3], a[104:107], v[36:39]
    v_mfma_f32_16x16x32_bf16 v[40:43], v[0:3], a[160:163], v[40:43]
    v_mfma_f32_16x16x32_bf16 v[44:47], v[0:3], a[216:219], v[44:47]
    s_waitcnt lgkmcnt(0)
    v_mfma_f32_16x16x32_bf16 v[32:35], v[4:7], a[52:55], v[32:35]
    v_mfma_f32_16x16x32_bf16 v[36:39], v[4:7], a[108:111], v[36:39]
    v_mfma_f32_16x16x32_bf16 v[40:43], v[4:7], a[164:167], v[40:43]
    v_mfma_f32_16x16x32_bf16 v[44:47], v[4:7], a[220:223], v[44:47]
    s_add_u32 s24, s16, 28672
    s_add_u32 m0, s17, 13440
    s_nop 0
    buffer_load_dwordx4 v170, s[8:11], s24 offen offset:896 lds
    s_add_u32 m0, s17, 14400
    s_nop 0
    buffer_load_dwordx4 v170, s[8:11], s24 offen offset:960 lds
    s_add_u32 m0, s17, 15360
    s_nop 0
    buffer_load_dwordx4 v170, s[8:11], s24 offen offset:1024 lds
    s_add_u32 m0, s17, 16320
    s_nop 0
    buffer_load_dwordx4 v170, s[8:11], s24 offen offset:1088 lds
    s_add_u32 m0, s17, 17280
    s_nop 0
    buffer_load_dwordx4 v170, s[8:11], s24 offen offset:1152 lds
    s_add_u32 m0, s17, 18240
    s_nop 0
    buffer_load_dwordx4 v170, s[8:11], s24 offen offset:1216 lds
    s_add_u32 m0, s17, 19200
    s_nop 0
    buffer_load_dwordx4 v170, s[8:11], s24 offen offset:1280 lds
    s_add_u32 m0, s17, 20160
    s_nop 0
    buffer_load_dwordx4 v170, s[8:11], s24 offen offset:1344 lds
    s_add_u32 m0, s17, 21120
    s_nop 0
    buffer_load_dwordx4 v170, s[8:11], s24 offen offset:1408 lds
    s_add_u32 m0, s17, 22080
    s_nop 0
    buffer_load_dwordx4 v170, s[8:11], s24 offen offset:1472 lds
    s_add_u32 m0, s17, 23040
    s_nop 0
    buffer_load_dwordx4 v170, s[8:11], s24 offen offset:1536 lds
    s_add_u32 m0, s17, 24000
    s_nop 0
    buffer_load_dwordx4 v170, s[8:11], s24 offen offset:1600 lds
    s_add_u32 m0, s17, 24960
    s_nop 0
    buffer_load_dwordx4 v170, s[8:11], s24 offen offset:1664 lds
    s_add_u32 m0, s17, 25920
    s_nop 0
    buffer_load_dwordx4 v170, s[8:11], s24 offen offset:1728 lds
    v_cndmask_b32 v20, v16, v20, s[42:43]
    v_cndmask_b32 v21, v17, v21, s[42:43]
    v_cndmask_b32 v22, v18, v22, s[42:43]
    v_cndmask_b32 v23, v19, v23, s[42:43]
    v_cndmask_b32 v36, v32, v36, s[42:43]
    v_cndmask_b32 v37, v33, v37, s[42:43]
    v_cndmask_b32 v38, v34, v38, s[42:43]
    v_cndmask_b32 v39, v35, v39, s[42:43]
    v_max_f32 v120, v16, v20
    v_min_f32 v128, v16, v20
    v_max_f32 v121, v17, v21
    v_min_f32 v129, v17, v21
    v_max_f32 v122, v18, v22
    v_min_f32 v130, v18, v22
    v_max_f32 v123, v19, v23
    v_min_f32 v131, v19, v23
    v_max_f32 v124, v32, v36
    v_min_f32 v132, v32, v36
    v_max_f32 v125, v33, v37
    v_min_f32 v133, v33, v37
    v_max_f32 v126, v34, v38
    v_min_f32 v134, v34, v38
    v_max_f32 v127, v35, v39
    v_min_f32 v135, v35, v39
    v_max_f32_dpp v120, v120, v120 quad_perm:[1,0,3,2] row_mask:0xf bank_mask:0xf
    v_max_f32_dpp v121, v121, v121 quad_perm:[1,0,3,2] row_mask:0xf bank_mask:0xf
    v_max_f32_dpp v122, v122, v122 quad_perm:[1,0,3,2] row_mask:0xf bank_mask:0xf
    v_max_f32_dpp v123, v123, v123 quad_perm:[1,0,3,2] row_mask:0xf bank_mask:0xf
    v_max_f32_dpp v124, v124, v124 quad_perm:[1,0,3,2] row_mask:0xf bank_mask:0xf
    v_max_f32_dpp v125, v125, v125 quad_perm:[1,0,3,2] row_mask:0xf bank_mask:0xf
    v_max_f32_dpp v126, v126, v126 quad_perm:[1,0,3,2] row_mask:0xf bank_mask:0xf
    v_max_f32_dpp v127, v127, v127 quad_perm:[1,0,3,2] row_mask:0xf bank_mask:0xf
    v_min_f32_dpp v128, v128, v128 quad_perm:[1,0,3,2] row_mask:0xf bank_mask:0xf
    v_min_f32_dpp v129, v129, v129 quad_perm:[1,0,3,2] row_mask:0xf bank_mask:0xf
    v_min_f32_dpp v130, v130, v130 quad_perm:[1,0,3,2] row_mask:0xf bank_mask:0xf
    v_min_f32_dpp v131, v131, v131 quad_perm:[1,0,3,2] row_mask:0xf bank_mask:0xf
    v_min_f32_dpp v132, v132, v132 quad_perm:[1,0,3,2] row_mask:0xf bank_mask:0xf
    v_min_f32_dpp v133, v133, v133 quad_perm:[1,0,3,2] row_mask:0xf bank_mask:0xf
    v_min_f32_dpp v134, v134, v134 quad_perm:[1,0,3,2] row_mask:0xf bank_mask:0xf
    v_min_f32_dpp v135, v135, v135 quad_perm:[1,0,3,2] row_mask:0xf bank_mask:0xf
    v_max_f32_dpp v120, v120, v120 quad_perm:[2,3,0,1] row_mask:0xf bank_mask:0xf
    v_max_f32_dpp v121, v121, v121 quad_perm:[2,3,0,1] row_mask:0xf bank_mask:0xf
    v_max_f32_dpp v122, v122, v122 quad_perm:[2,3,0,1] row_mask:0xf bank_mask:0xf
    v_max_f32_dpp v123, v123, v123 quad_perm:[2,3,0,1] row_mask:0xf bank_mask:0xf
    v_max_f32_dpp v124, v124, v124 quad_perm:[2,3,0,1] row_mask:0xf bank_mask:0xf
    v_max_f32_dpp v125, v125, v125 quad_perm:[2,3,0,1] row_mask:0xf bank_mask:0xf
    v_max_f32_dpp v126, v126, v126 quad_perm:[2,3,0,1] row_mask:0xf bank_mask:0xf
    v_max_f32_dpp v127, v127, v127 quad_perm:[2,3,0,1] row_mask:0xf bank_mask:0xf
    v_min_f32_dpp v128, v128, v128 quad_perm:[2,3,0,1] row_mask:0xf bank_mask:0xf
    v_min_f32_dpp v129, v129, v129 quad_perm:[2,3,0,1] row_mask:0xf bank_mask:0xf
    v_min_f32_dpp v130, v130, v130 quad_perm:[2,3,0,1] row_mask:0xf bank_mask:0xf
    v_min_f32_dpp v131, v131, v131 quad_perm:[2,3,0,1] row_mask:0xf bank_mask:0xf
    v_min_f32_dpp v132, v132, v132 quad_perm:[2,3,0,1] row_mask:0xf bank_mask:0xf
    v_min_f32_dpp v133, v133, v133 quad_perm:[2,3,0,1] row_mask:0xf bank_mask:0xf
    v_min_f32_dpp v134, v134, v134 quad_perm:[2,3,0,1] row_mask:0xf bank_mask:0xf
    v_min_f32_dpp v135, v135, v135 quad_perm:[2,3,0,1] row_mask:0xf bank_mask:0xf
    v_max_f32_dpp v120, v120, v120 row_half_mirror row_mask:0xf bank_mask:0xf
    v_max_f32_dpp v121, v121, v121 row_half_mirror row_mask:0xf bank_mask:0xf
    v_max_f32_dpp v122, v122, v122 row_half_mirror row_mask:0xf bank_mask:0xf
    v_max_f32_dpp v123, v123, v123 row_half_mirror row_mask:0xf bank_mask:0xf
    v_max_f32_dpp v124, v124, v124 row_half_mirror row_mask:0xf bank_mask:0xf
    v_max_f32_dpp v125, v125, v125 row_half_mirror row_mask:0xf bank_mask:0xf
    v_max_f32_dpp v126, v126, v126 row_half_mirror row_mask:0xf bank_mask:0xf
    v_max_f32_dpp v127, v127, v127 row_half_mirror row_mask:0xf bank_mask:0xf
    v_min_f32_dpp v128, v128, v128 row_half_mirror row_mask:0xf bank_mask:0xf
    v_min_f32_dpp v129, v129, v129 row_half_mirror row_mask:0xf bank_mask:0xf
    v_min_f32_dpp v130, v130, v130 row_half_mirror row_mask:0xf bank_mask:0xf
    v_min_f32_dpp v131, v131, v131 row_half_mirror row_mask:0xf bank_mask:0xf
    v_min_f32_dpp v132, v132, v132 row_half_mirror row_mask:0xf bank_mask:0xf
    v_min_f32_dpp v133, v133, v133 row_half_mirror row_mask:0xf bank_mask:0xf
    v_min_f32_dpp v134, v134, v134 row_half_mirror row_mask:0xf bank_mask:0xf
    v_min_f32_dpp v135, v135, v135 row_half_mirror row_mask:0xf bank_mask:0xf
    v_max_f32_dpp v120, v120, v120 row_mirror row_mask:0xf bank_mask:0xf
    v_max_f32_dpp v121, v121, v121 row_mirror row_mask:0xf bank_mask:0xf
    v_max_f32_dpp v122, v122, v122 row_mirror row_mask:0xf bank_mask:0xf
    v_max_f32_dpp v123, v123, v123 row_mirror row_mask:0xf bank_mask:0xf
    v_max_f32_dpp v124, v124, v124 row_mirror row_mask:0xf bank_mask:0xf
    v_max_f32_dpp v125, v125, v125 row_mirror row_mask:0xf bank_mask:0xf
    v_max_f32_dpp v126, v126, v126 row_mirror row_mask:0xf bank_mask:0xf
    v_max_f32_dpp v127, v127, v127 row_mirror row_mask:0xf bank_mask:0xf
    v_min_f32_dpp v128, v128, v128 row_mirror row_mask:0xf bank_mask:0xf
    v_min_f32_dpp v129, v129, v129 row_mirror row_mask:0xf bank_mask:0xf
    v_min_f32_dpp v130, v130, v130 row_mirror row_mask:0xf bank_mask:0xf
    v_min_f32_dpp v131, v131, v131 row_mirror row_mask:0xf bank_mask:0xf
    v_min_f32_dpp v132, v132, v132 row_mirror row_mask:0xf bank_mask:0xf
    v_min_f32_dpp v133, v133, v133 row_mirror row_mask:0xf bank_mask:0xf
    v_min_f32_dpp v134, v134, v134 row_mirror row_mask:0xf bank_mask:0xf
    v_min_f32_dpp v135, v135, v135 row_mirror row_mask:0xf bank_mask:0xf
    v_mul_f32 v120, s19, v120
    v_mul_f32 v121, s19, v121
    v_mul_f32 v122, s19, v122
    v_mul_f32 v123, s19, v123
    v_mul_f32 v124, s19, v124
    v_mul_f32 v125, s19, v125
    v_mul_f32 v126, s19, v126
    v_mul_f32 v127, s19, v127
    v_mul_f32 v128, s19, v128
    v_mul_f32 v129, s19, v129
    v_mul_f32 v130, s19, v130
    v_mul_f32 v131, s19, v131
    v_mul_f32 v132, s19, v132
    v_mul_f32 v133, s19, v133
    v_mul_f32 v134, s19, v134
    v_mul_f32 v135, s19, v135
    v_fma_f32 v80, v16, s19, -v120
    v_fma_f32 v88, v20, s19, -v120
    v_fma_f32 v96, -v16, s19, v128
    v_fma_f32 v104, -v20, s19, v128
    v_fma_f32 v81, v17, s19, -v121
    v_fma_f32 v89, v21, s19, -v121
    v_fma_f32 v97, -v17, s19, v129
    v_fma_f32 v105, -v21, s19, v129
    v_fma_f32 v82, v18, s19, -v122
    v_fma_f32 v90, v22, s19, -v122
    v_fma_f32 v98, -v18, s19, v130
    v_fma_f32 v106, -v22, s19, v130
    v_fma_f32 v83, v19, s19, -v123
    v_fma_f32 v91, v23, s19, -v123
    v_fma_f32 v99, -v19, s19, v131
    v_fma_f32 v107, -v23, s19, v131
    v_fma_f32 v84, v32, s19, -v124
    v_fma_f32 v92, v36, s19, -v124
    v_fma_f32 v100, -v32, s19, v132
    v_fma_f32 v108, -v36, s19, v132
    v_fma_f32 v85, v33, s19, -v125
    v_fma_f32 v93, v37, s19, -v125
    v_fma_f32 v101, -v33, s19, v133
    v_fma_f32 v109, -v37, s19, v133
    v_fma_f32 v86, v34, s19, -v126
    v_fma_f32 v94, v38, s19, -v126
    v_fma_f32 v102, -v34, s19, v134
    v_fma_f32 v110, -v38, s19, v134
    v_fma_f32 v87, v35, s19, -v127
    v_fma_f32 v95, v39, s19, -v127
    v_fma_f32 v103, -v35, s19, v135
    v_fma_f32 v111, -v39, s19, v135
    v_exp_f32 v80, v80
    v_exp_f32 v81, v81
    v_exp_f32 v82, v82
    v_exp_f32 v83, v83
    v_exp_f32 v84, v84
    v_exp_f32 v85, v85
    v_exp_f32 v86, v86
    v_exp_f32 v87, v87
    v_exp_f32 v88, v88
    v_exp_f32 v89, v89
    v_exp_f32 v90, v90
    v_exp_f32 v91, v91
    v_exp_f32 v92, v92
    v_exp_f32 v93, v93
    v_exp_f32 v94, v94
    v_exp_f32 v95, v95
    v_exp_f32 v96, v96
    v_exp_f32 v97, v97
    v_exp_f32 v98, v98
    v_exp_f32 v99, v99
    v_exp_f32 v100, v100
    v_exp_f32 v101, v101
    v_exp_f32 v102, v102
    v_exp_f32 v103, v103
    v_exp_f32 v104, v104
    v_exp_f32 v105, v105
    v_exp_f32 v106, v106
    v_exp_f32 v107, v107
    v_exp_f32 v108, v108
    v_exp_f32 v109, v109
    v_exp_f32 v110, v110
    v_exp_f32 v111, v111
    v_cndmask_b32 v88, 0, v88, s[42:43]
    v_cndmask_b32 v104, 0, v104, s[42:43]
    v_cndmask_b32 v89, 0, v89, s[42:43]
    v_cndmask_b32 v105, 0, v105, s[42:43]
    v_cndmask_b32 v90, 0, v90, s[42:43]
    v_cndmask_b32 v106, 0, v106, s[42:43]
    v_cndmask_b32 v91, 0, v91, s[42:43]
    v_cndmask_b32 v107, 0, v107, s[42:43]
    v_cndmask_b32 v92, 0, v92, s[42:43]
    v_cndmask_b32 v108, 0, v108, s[42:43]
    v_cndmask_b32 v93, 0, v93, s[42:43]
    v_cndmask_b32 v109, 0, v109, s[42:43]
    v_cndmask_b32 v94, 0, v94, s[42:43]
    v_cndmask_b32 v110, 0, v110, s[42:43]
    v_cndmask_b32 v95, 0, v95, s[42:43]
    v_cndmask_b32 v111, 0, v111, s[42:43]
    v_add_f32 v120, v80, v88
    v_add_f32 v128, v96, v104
    v_add_f32 v121, v81, v89
    v_add_f32 v129, v97, v105
    v_add_f32 v122, v82, v90
    v_add_f32 v130, v98, v106
    v_add_f32 v123, v83, v91
    v_add_f32 v131, v99, v107
    v_add_f32 v124, v84, v92
    v_add_f32 v132, v100, v108
    v_add_f32 v125, v85, v93
    v_add_f32 v133, v101, v109
    v_add_f32 v126, v86, v94
    v_add_f32 v134, v102, v110
    v_add_f32 v127, v87, v95
    v_add_f32 v135, v103, v111
    v_add_f32_dpp v120, v120, v120 quad_perm:[1,0,3,2] row_mask:0xf bank_mask:0xf
    v_add_f32_dpp v121, v121, v121 quad_perm:[1,0,3,2] row_mask:0xf bank_mask:0xf
    v_add_f32_dpp v122, v122, v122 quad_perm:[1,0,3,2] row_mask:0xf bank_mask:0xf
    v_add_f32_dpp v123, v123, v123 quad_perm:[1,0,3,2] row_mask:0xf bank_mask:0xf
    v_add_f32_dpp v124, v124, v124 quad_perm:[1,0,3,2] row_mask:0xf bank_mask:0xf
    v_add_f32_dpp v125, v125, v125 quad_perm:[1,0,3,2] row_mask:0xf bank_mask:0xf
    v_add_f32_dpp v126, v126, v126 quad_perm:[1,0,3,2] row_mask:0xf bank_mask:0xf
    v_add_f32_dpp v127, v127, v127 quad_perm:[1,0,3,2] row_mask:0xf bank_mask:0xf
    v_add_f32_dpp v128, v128, v128 quad_perm:[1,0,3,2] row_mask:0xf bank_mask:0xf
    v_add_f32_dpp v129, v129, v129 quad_perm:[1,0,3,2] row_mask:0xf bank_mask:0xf
    v_add_f32_dpp v130, v130, v130 quad_perm:[1,0,3,2] row_mask:0xf bank_mask:0xf
    v_add_f32_dpp v131, v131, v131 quad_perm:[1,0,3,2] row_mask:0xf bank_mask:0xf
    v_add_f32_dpp v132, v132, v132 quad_perm:[1,0,3,2] row_mask:0xf bank_mask:0xf
    v_add_f32_dpp v133, v133, v133 quad_perm:[1,0,3,2] row_mask:0xf bank_mask:0xf
    v_add_f32_dpp v134, v134, v134 quad_perm:[1,0,3,2] row_mask:0xf bank_mask:0xf
    v_add_f32_dpp v135, v135, v135 quad_perm:[1,0,3,2] row_mask:0xf bank_mask:0xf
    v_add_f32_dpp v120, v120, v120 quad_perm:[2,3,0,1] row_mask:0xf bank_mask:0xf
    v_add_f32_dpp v121, v121, v121 quad_perm:[2,3,0,1] row_mask:0xf bank_mask:0xf
    v_add_f32_dpp v122, v122, v122 quad_perm:[2,3,0,1] row_mask:0xf bank_mask:0xf
    v_add_f32_dpp v123, v123, v123 quad_perm:[2,3,0,1] row_mask:0xf bank_mask:0xf
    v_add_f32_dpp v124, v124, v124 quad_perm:[2,3,0,1] row_mask:0xf bank_mask:0xf
    v_add_f32_dpp v125, v125, v125 quad_perm:[2,3,0,1] row_mask:0xf bank_mask:0xf
    v_add_f32_dpp v126, v126, v126 quad_perm:[2,3,0,1] row_mask:0xf bank_mask:0xf
    v_add_f32_dpp v127, v127, v127 quad_perm:[2,3,0,1] row_mask:0xf bank_mask:0xf
    v_add_f32_dpp v128, v128, v128 quad_perm:[2,3,0,1] row_mask:0xf bank_mask:0xf
    v_add_f32_dpp v129, v129, v129 quad_perm:[2,3,0,1] row_mask:0xf bank_mask:0xf
    v_add_f32_dpp v130, v130, v130 quad_perm:[2,3,0,1] row_mask:0xf bank_mask:0xf
    v_add_f32_dpp v131, v131, v131 quad_perm:[2,3,0,1] row_mask:0xf bank_mask:0xf
    v_add_f32_dpp v132, v132, v132 quad_perm:[2,3,0,1] row_mask:0xf bank_mask:0xf
    v_add_f32_dpp v133, v133, v133 quad_perm:[2,3,0,1] row_mask:0xf bank_mask:0xf
    v_add_f32_dpp v134, v134, v134 quad_perm:[2,3,0,1] row_mask:0xf bank_mask:0xf
    v_add_f32_dpp v135, v135, v135 quad_perm:[2,3,0,1] row_mask:0xf bank_mask:0xf
    v_add_f32_dpp v120, v120, v120 row_half_mirror row_mask:0xf bank_mask:0xf
    v_add_f32_dpp v121, v121, v121 row_half_mirror row_mask:0xf bank_mask:0xf
    v_add_f32_dpp v122, v122, v122 row_half_mirror row_mask:0xf bank_mask:0xf
    v_add_f32_dpp v123, v123, v123 row_half_mirror row_mask:0xf bank_mask:0xf
    v_add_f32_dpp v124, v124, v124 row_half_mirror row_mask:0xf bank_mask:0xf
    v_add_f32_dpp v125, v125, v125 row_half_mirror row_mask:0xf bank_mask:0xf
    v_add_f32_dpp v126, v126, v126 row_half_mirror row_mask:0xf bank_mask:0xf
    v_add_f32_dpp v127, v127, v127 row_half_mirror row_mask:0xf bank_mask:0xf
    v_add_f32_dpp v128, v128, v128 row_half_mirror row_mask:0xf bank_mask:0xf
    v_add_f32_dpp v129, v129, v129 row_half_mirror row_mask:0xf bank_mask:0xf
    v_add_f32_dpp v130, v130, v130 row_half_mirror row_mask:0xf bank_mask:0xf
    v_add_f32_dpp v131, v131, v131 row_half_mirror row_mask:0xf bank_mask:0xf
    v_add_f32_dpp v132, v132, v132 row_half_mirror row_mask:0xf bank_mask:0xf
    v_add_f32_dpp v133, v133, v133 row_half_mirror row_mask:0xf bank_mask:0xf
    v_add_f32_dpp v134, v134, v134 row_half_mirror row_mask:0xf bank_mask:0xf
    v_add_f32_dpp v135, v135, v135 row_half_mirror row_mask:0xf bank_mask:0xf
    v_add_f32_dpp v120, v120, v120 row_mirror row_mask:0xf bank_mask:0xf
    v_add_f32_dpp v121, v121, v121 row_mirror row_mask:0xf bank_mask:0xf
    v_add_f32_dpp v122, v122, v122 row_mirror row_mask:0xf bank_mask:0xf
    v_add_f32_dpp v123, v123, v123 row_mirror row_mask:0xf bank_mask:0xf
    v_add_f32_dpp v124, v124, v124 row_mirror row_mask:0xf bank_mask:0xf
    v_add_f32_dpp v125, v125, v125 row_mirror row_mask:0xf bank_mask:0xf
    v_add_f32_dpp v126, v126, v126 row_mirror row_mask:0xf bank_mask:0xf
    v_add_f32_dpp v127, v127, v127 row_mirror row_mask:0xf bank_mask:0xf
    v_add_f32_dpp v128, v128, v128 row_mirror row_mask:0xf bank_mask:0xf
    v_add_f32_dpp v129, v129, v129 row_mirror row_mask:0xf bank_mask:0xf
    v_add_f32_dpp v130, v130, v130 row_mirror row_mask:0xf bank_mask:0xf
    v_add_f32_dpp v131, v131, v131 row_mirror row_mask:0xf bank_mask:0xf
    v_add_f32_dpp v132, v132, v132 row_mirror row_mask:0xf bank_mask:0xf
    v_add_f32_dpp v133, v133, v133 row_mirror row_mask:0xf bank_mask:0xf
    v_add_f32_dpp v134, v134, v134 row_mirror row_mask:0xf bank_mask:0xf
    v_add_f32_dpp v135, v135, v135 row_mirror row_mask:0xf bank_mask:0xf
    v_rcp_f32 v120, v120
    v_rcp_f32 v121, v121
    v_rcp_f32 v122, v122
    v_rcp_f32 v123, v123
    v_rcp_f32 v124, v124
    v_rcp_f32 v125, v125
    v_rcp_f32 v126, v126
    v_rcp_f32 v127, v127
    v_rcp_f32 v128, v128
    v_rcp_f32 v129, v129
    v_rcp_f32 v130, v130
    v_rcp_f32 v131, v131
    v_rcp_f32 v132, v132
    v_rcp_f32 v133, v133
    v_rcp_f32 v134, v134
    v_rcp_f32 v135, v135
    v_mul_f32 v80, v80, v120
    v_mul_f32 v81, v81, v121
    v_mul_f32 v82, v82, v122
    v_mul_f32 v83, v83, v123
    v_mul_f32 v84, v84, v124
    v_mul_f32 v85, v85, v125
    v_mul_f32 v86, v86, v126
    v_mul_f32 v87, v87, v127
    v_mul_f32 v88, v88, v120
    v_mul_f32 v89, v89, v121
    v_mul_f32 v90, v90, v122
    v_mul_f32 v91, v91, v123
    v_mul_f32 v92, v92, v124
    v_mul_f32 v93, v93, v125
    v_mul_f32 v94, v94, v126
    v_mul_f32 v95, v95, v127
    v_mul_f32 v96, v96, v128
    v_mul_f32 v97, v97, v129
    v_mul_f32 v98, v98, v130
    v_mul_f32 v99, v99, v131
    v_mul_f32 v100, v100, v132
    v_mul_f32 v101, v101, v133
    v_mul_f32 v102, v102, v134
    v_mul_f32 v103, v103, v135
    v_mul_f32 v104, v104, v128
    v_mul_f32 v105, v105, v129
    v_mul_f32 v106, v106, v130
    v_mul_f32 v107, v107, v131
    v_mul_f32 v108, v108, v132
    v_mul_f32 v109, v109, v133
    v_mul_f32 v110, v110, v134
    v_mul_f32 v111, v111, v135
    v_cvt_pk_bf16_f32 v136, v80, v84
    v_cvt_pk_bf16_f32 v137, v81, v85
    v_cvt_pk_bf16_f32 v138, v82, v86
    v_cvt_pk_bf16_f32 v139, v83, v87
    v_cvt_pk_bf16_f32 v140, v88, v92
    v_cvt_pk_bf16_f32 v141, v89, v93
    v_cvt_pk_bf16_f32 v142, v90, v94
    v_cvt_pk_bf16_f32 v143, v91, v95
    v_cvt_pk_bf16_f32 v144, v96, v100
    v_cvt_pk_bf16_f32 v145, v97, v101
    v_cvt_pk_bf16_f32 v146, v98, v102
    v_cvt_pk_bf16_f32 v147, v99, v103
    v_cvt_pk_bf16_f32 v148, v104, v108
    v_cvt_pk_bf16_f32 v149, v105, v109
    v_cvt_pk_bf16_f32 v150, v106, v110
    v_cvt_pk_bf16_f32 v151, v107, v111
    v_mov_b32 v120, 0x3f803f80
    v_cvt_pk_bf16_f32 v152, v24, v40
    v_cvt_pk_bf16_f32 v153, v25, v41
    v_cvt_pk_bf16_f32 v154, v26, v42
    v_cvt_pk_bf16_f32 v155, v27, v43
    v_cvt_pk_bf16_f32 v156, v28, v44
    v_cndmask_b32 v156, v156, v120, s[22:23]
    v_cvt_pk_bf16_f32 v157, v29, v45
    v_cndmask_b32 v157, v157, v120, s[22:23]
    v_cvt_pk_bf16_f32 v158, v30, v46
    v_cndmask_b32 v158, v158, v120, s[22:23]
    v_cvt_pk_bf16_f32 v159, v31, v47
    v_cndmask_b32 v159, v159, v120, s[22:23]
    v_mfma_f32_16x16x32_bf16 v[48:51], v[136:139], v[152:155], v[48:51]
    s_nop 0
    v_mfma_f32_16x16x32_bf16 v[52:55], v[136:139], v[156:159], v[52:55]
    v_mfma_f32_16x16x32_bf16 v[56:59], v[140:143], v[152:155], v[56:59]
    v_mfma_f32_16x16x32_bf16 v[60:63], v[140:143], v[156:159], v[60:63]
    v_mfma_f32_16x16x32_bf16 v[64:67], v[144:147], v[152:155], v[64:67]
    v_mfma_f32_16x16x32_bf16 v[68:71], v[144:147], v[156:159], v[68:71]
    v_mfma_f32_16x16x32_bf16 v[72:75], v[148:151], v[152:155], v[72:75]
    v_mfma_f32_16x16x32_bf16 v[76:79], v[148:151], v[156:159], v[76:79]
    s_add_u32 s16, s16, 28672
    s_add_u32 s18, s18, 1
    s_cmp_lt_u32 s18, 4
    s_cbranch_scc1 L_B1_122
    s_lshl_b32 s24, s12, 13
    s_add_u32 s24, s24, 114688
    v_add_u32 v120, s24, v172
    s_lshl_b32 s24, s12, 11
    s_add_u32 s24, s24, 114688
    v_add_u32 v121, s24, v172
    ds_write_b128 v120, v[48:51] offset:0
    ds_write_b128 v120, v[52:55] offset:1024
    ds_write_b128 v120, v[56:59] offset:2048
    ds_write_b128 v120, v[60:63] offset:3072
    ds_write_b128 v120, v[64:67] offset:4096
    ds_write_b128 v120, v[68:71] offset:5120
    ds_write_b128 v120, v[72:75] offset:6144
    ds_write_b128 v120, v[76:79] offset:7168
    s_waitcnt vmcnt(0) lgkmcnt(0)
    s_barrier
    ds_read_b128 v[0:3], v121 offset:0
    ds_read_b128 v[4:7], v121 offset:1024
    ds_read_b128 v[8:11], v121 offset:8192
    ds_read_b128 v[12:15], v121 offset:9216
    ds_read_b128 v[16:19], v121 offset:16384
    ds_read_b128 v[20:23], v121 offset:17408
    ds_read_b128 v[24:27], v121 offset:24576
    ds_read_b128 v[28:31], v121 offset:25600
    s_lshl_b32 s24, s15, 2
    s_add_u32 s24, s24, s12
    s_mul_i32 s16, s24, 114688
    s_mov_b32 s18, 0
    s_add_u32 m0, s17, 0
    s_nop 0
    buffer_load_dwordx4 v170, s[8:11], s16 offen offset:0 lds
    s_add_u32 m0, s17, 960
    s_nop 0
    buffer_load_dwordx4 v170, s[8:11], s16 offen offset:64 lds
    s_add_u32 m0, s17, 1920
    s_nop 0
    buffer_load_dwordx4 v170, s[8:11], s16 offen offset:128 lds
    s_add_u32 m0, s17, 2880
    s_nop 0
    buffer_load_dwordx4 v170, s[8:11], s16 offen offset:192 lds
    s_add_u32 m0, s17, 3840
    s_nop 0
    buffer_load_dwordx4 v170, s[8:11], s16 offen offset:256 lds
    s_add_u32 m0, s17, 4800
    s_nop 0
    buffer_load_dwordx4 v170, s[8:11], s16 offen offset:320 lds
    s_add_u32 m0, s17, 5760
    s_nop 0
    buffer_load_dwordx4 v170, s[8:11], s16 offen offset:384 lds
    s_add_u32 m0, s17, 6720
    s_nop 0
    buffer_load_dwordx4 v170, s[8:11], s16 offen offset:448 lds
    s_add_u32 m0, s17, 7680
    s_nop 0
    buffer_load_dwordx4 v170, s[8:11], s16 offen offset:512 lds
    s_add_u32 m0, s17, 8640
    s_nop 0
    buffer_load_dwordx4 v170, s[8:11], s16 offen offset:576 lds
    s_add_u32 m0, s17, 9600
    s_nop 0
    buffer_load_dwordx4 v170, s[8:11], s16 offen offset:640 lds
    s_add_u32 m0, s17, 10560
    s_nop 0
    buffer_load_dwordx4 v170, s[8:11], s16 offen offset:704 lds
    s_add_u32 m0, s17, 11520
    s_nop 0
    buffer_load_dwordx4 v170, s[8:11], s16 offen offset:768 lds
    s_add_u32 m0, s17, 12480
    s_nop 0
    buffer_load_dwordx4 v170, s[8:11], s16 offen offset:832 lds
    s_add_u32 m0, s17, 13440
    s_nop 0
    buffer_load_dwordx4 v170, s[8:11], s16 offen offset:896 lds
    s_add_u32 m0, s17, 14400
    s_nop 0
    buffer_load_dwordx4 v170, s[8:11], s16 offen offset:960 lds
    s_add_u32 m0, s17, 15360
    s_nop 0
    buffer_load_dwordx4 v170, s[8:11], s16 offen offset:1024 lds
    s_add_u32 m0, s17, 16320
    s_nop 0
    buffer_load_dwordx4 v170, s[8:11], s16 offen offset:1088 lds
    s_add_u32 m0, s17, 17280
    s_nop 0
    buffer_load_dwordx4 v170, s[8:11], s16 offen offset:1152 lds
    s_add_u32 m0, s17, 18240
    s_nop 0
    buffer_load_dwordx4 v170, s[8:11], s16 offen offset:1216 lds
    s_add_u32 m0, s17, 19200
    s_nop 0
    buffer_load_dwordx4 v170, s[8:11], s16 offen offset:1280 lds
    s_add_u32 m0, s17, 20160
    s_nop 0
    buffer_load_dwordx4 v170, s[8:11], s16 offen offset:1344 lds
    s_add_u32 m0, s17, 21120
    s_nop 0
    buffer_load_dwordx4 v170, s[8:11], s16 offen offset:1408 lds
    s_add_u32 m0, s17, 22080
    s_nop 0
    buffer_load_dwordx4 v170, s[8:11], s16 offen offset:1472 lds
    s_add_u32 m0, s17, 23040
    s_nop 0
    buffer_load_dwordx4 v170, s[8:11], s16 offen offset:1536 lds
    s_add_u32 m0, s17, 24000
    s_nop 0
    buffer_load_dwordx4 v170, s[8:11], s16 offen offset:1600 lds
    s_add_u32 m0, s17, 24960
    s_nop 0
    buffer_load_dwordx4 v170, s[8:11], s16 offen offset:1664 lds
    s_add_u32 m0, s17, 25920
    s_nop 0
    buffer_load_dwordx4 v170, s[8:11], s16 offen offset:1728 lds
    s_waitcnt lgkmcnt(0)
    v_pk_add_f32 v[0:1], v[0:1], v[16:17]
    v_pk_add_f32 v[2:3], v[2:3], v[18:19]
    v_pk_add_f32 v[4:5], v[4:5], v[20:21]
    v_pk_add_f32 v[6:7], v[6:7], v[22:23]
    v_pk_add_f32 v[8:9], v[8:9], v[24:25]
    v_pk_add_f32 v[10:11], v[10:11], v[26:27]
    v_pk_add_f32 v[12:13], v[12:13], v[28:29]
    v_pk_add_f32 v[14:15], v[14:15], v[30:31]
    v_pk_add_f32 v[0:1], v[0:1], v[8:9]
    v_pk_add_f32 v[2:3], v[2:3], v[10:11]
    v_pk_add_f32 v[4:5], v[4:5], v[12:13]
    v_pk_add_f32 v[6:7], v[6:7], v[14:15]
    s_lshl_b32 s21, s14, 15
    s_add_u32 s21, s21, 58785792
    s_lshl_b32 s24, s15, 13
    s_lshl_b32 s25, s12, 11
    s_add_u32 s24, s24, s25
    s_add_u32 s24, s24, s21
    buffer_store_dwordx4 v[0:3], v172, s[4:7], s24 offen sc1
    buffer_store_dwordx4 v[4:7], v172, s[4:7], s24 offen offset:1024 sc1
    s_mov_b32 s20, 0x20000
    v_mov_b32 v10, 0
L_wd_123:
    global_load_dword v11, v10, s[40:41] offset:128 sc1
    s_waitcnt vmcnt(0)
    v_cmp_gt_u32 vcc, 1, v11
    s_cbranch_vccz L_wdd_124
    s_sleep 2
    s_sub_u32 s20, s20, 1
    s_cbranch_scc0 L_wd_123
    s_branch L_fin
L_wdd_124:
    s_lshl_b32 s30, s14, 6
    s_add_u32 s30, s30, 59772928
    s_lshl_b32 s24, s15, 4
    s_lshl_b32 s25, s12, 2
    s_add_u32 s24, s24, s25
    s_add_u32 s24, s24, s30
    v_mov_b32 v8, 1
    s_mov_b64 exec, 1
    buffer_store_dword v8, v173, s[4:7], s24 offen sc1
    s_mov_b64 exec, -1
    s_mov_b32 s20, 0x20000
    v_lshlrev_b32 v14, 2, v175
    v_cmp_gt_u32 s[42:43], 16, v175
L_wf_125:
    buffer_load_dword v10, v14, s[4:7], s30 offen sc1
    s_waitcnt vmcnt(0)
    v_cmp_gt_u32 vcc, 1, v10
    s_nop 0
    s_and_b64 vcc, vcc, s[42:43]
    s_cbranch_scc0 L_wfd_126
    s_sleep 2
    s_sub_u32 s20, s20, 1
    s_cbranch_scc0 L_wf_125
    s_branch L_fin
L_wfd_126:
    s_add_u32 s24, s21, 0
    buffer_load_dwordx4 v[0:3], v172, s[4:7], s24 offen offset:0 sc1
    buffer_load_dwordx4 v[4:7], v172, s[4:7], s24 offen offset:1024 sc1
    buffer_load_dwordx4 v[8:11], v172, s[4:7], s24 offen offset:2048 sc1
    buffer_load_dwordx4 v[12:15], v172, s[4:7], s24 offen offset:3072 sc1
    s_add_u32 s24, s21, 4096
    buffer_load_dwordx4 v[16:19], v172, s[4:7], s24 offen offset:0 sc1
    buffer_load_dwordx4 v[20:23], v172, s[4:7], s24 offen offset:1024 sc1
    buffer_load_dwordx4 v[24:27], v172, s[4:7], s24 offen offset:2048 sc1
    buffer_load_dwordx4 v[28:31], v172, s[4:7], s24 offen offset:3072 sc1
    s_add_u32 s24, s21, 8192
    buffer_load_dwordx4 v[32:35], v172, s[4:7], s24 offen offset:0 sc1
    buffer_load_dwordx4 v[36:39], v172, s[4:7], s24 offen offset:1024 sc1
    buffer_load_dwordx4 v[40:43], v172, s[4:7], s24 offen offset:2048 sc1
    buffer_load_dwordx4 v[44:47], v172, s[4:7], s24 offen offset:3072 sc1
    s_add_u32 s24, s21, 12288
    buffer_load_dwordx4 v[48:51], v172, s[4:7], s24 offen offset:0 sc1
    buffer_load_dwordx4 v[52:55], v172, s[4:7], s24 offen offset:1024 sc1
    buffer_load_dwordx4 v[56:59], v172, s[4:7], s24 offen offset:2048 sc1
    buffer_load_dwordx4 v[60:63], v172, s[4:7], s24 offen offset:3072 sc1
    s_add_u32 s24, s21, 16384
    buffer_load_dwordx4 v[64:67], v172, s[4:7], s24 offen offset:0 sc1
    buffer_load_dwordx4 v[68:71], v172, s[4:7], s24 offen offset:1024 sc1
    buffer_load_dwordx4 v[72:75], v172, s[4:7], s24 offen offset:2048 sc1
    buffer_load_dwordx4 v[76:79], v172, s[4:7], s24 offen offset:3072 sc1
    s_add_u32 s24, s21, 20480
    buffer_load_dwordx4 v[80:83], v172, s[4:7], s24 offen offset:0 sc1
    buffer_load_dwordx4 v[84:87], v172, s[4:7], s24 offen offset:1024 sc1
    buffer_load_dwordx4 v[88:91], v172, s[4:7], s24 offen offset:2048 sc1
    buffer_load_dwordx4 v[92:95], v172, s[4:7], s24 offen offset:3072 sc1
    s_add_u32 s24, s21, 24576
    buffer_load_dwordx4 v[96:99], v172, s[4:7], s24 offen offset:0 sc1
    buffer_load_dwordx4 v[100:103], v172, s[4:7], s24 offen offset:1024 sc1
    buffer_load_dwordx4 v[104:107], v172, s[4:7], s24 offen offset:2048 sc1
    buffer_load_dwordx4 v[108:111], v172, s[4:7], s24 offen offset:3072 sc1
    s_add_u32 s24, s21, 28672
    buffer_load_dwordx4 v[112:115], v172, s[4:7], s24 offen offset:0 sc1
    buffer_load_dwordx4 v[116:119], v172, s[4:7], s24 offen offset:1024 sc1
    buffer_load_dwordx4 v[120:123], v172, s[4:7], s24 offen offset:2048 sc1
    buffer_load_dwordx4 v[124:127], v172, s[4:7], s24 offen offset:3072 sc1
    s_waitcnt vmcnt(0)
    v_pk_add_f32 v[0:1], v[0:1], v[64:65]
    v_pk_add_f32 v[2:3], v[2:3], v[66:67]
    v_pk_add_f32 v[4:5], v[4:5], v[68:69]
    v_pk_add_f32 v[6:7], v[6:7], v[70:71]
    v_pk_add_f32 v[8:9], v[8:9], v[72:73]
    v_pk_add_f32 v[10:11], v[10:11], v[74:75]
    v_pk_add_f32 v[12:13], v[12:13], v[76:77]
    v_pk_add_f32 v[14:15], v[14:15], v[78:79]
    v_pk_add_f32 v[16:17], v[16:17], v[80:81]
    v_pk_add_f32 v[18:19], v[18:19], v[82:83]
    v_pk_add_f32 v[20:21], v[20:21], v[84:85]
    v_pk_add_f32 v[22:23], v[22:23], v[86:87]
    v_pk_add_f32 v[24:25], v[24:25], v[88:89]
    v_pk_add_f32 v[26:27], v[26:27], v[90:91]
    v_pk_add_f32 v[28:29], v[28:29], v[92:93]
    v_pk_add_f32 v[30:31], v[30:31], v[94:95]
    v_pk_add_f32 v[32:33], v[32:33], v[96:97]
    v_pk_add_f32 v[34:35], v[34:35], v[98:99]
    v_pk_add_f32 v[36:37], v[36:37], v[100:101]
    v_pk_add_f32 v[38:39], v[38:39], v[102:103]
    v_pk_add_f32 v[40:41], v[40:41], v[104:105]
    v_pk_add_f32 v[42:43], v[42:43], v[106:107]
    v_pk_add_f32 v[44:45], v[44:45], v[108:109]
    v_pk_add_f32 v[46:47], v[46:47], v[110:111]
    v_pk_add_f32 v[48:49], v[48:49], v[112:113]
    v_pk_add_f32 v[50:51], v[50:51], v[114:115]
    v_pk_add_f32 v[52:53], v[52:53], v[116:117]
    v_pk_add_f32 v[54:55], v[54:55], v[118:119]
    v_pk_add_f32 v[56:57], v[56:57], v[120:121]
    v_pk_add_f32 v[58:59], v[58:59], v[122:123]
    v_pk_add_f32 v[60:61], v[60:61], v[124:125]
    v_pk_add_f32 v[62:63], v[62:63], v[126:127]
    v_pk_add_f32 v[0:1], v[0:1], v[32:33]
    v_pk_add_f32 v[2:3], v[2:3], v[34:35]
    v_pk_add_f32 v[4:5], v[4:5], v[36:37]
    v_pk_add_f32 v[6:7], v[6:7], v[38:39]
    v_pk_add_f32 v[8:9], v[8:9], v[40:41]
    v_pk_add_f32 v[10:11], v[10:11], v[42:43]
    v_pk_add_f32 v[12:13], v[12:13], v[44:45]
    v_pk_add_f32 v[14:15], v[14:15], v[46:47]
    v_pk_add_f32 v[16:17], v[16:17], v[48:49]
    v_pk_add_f32 v[18:19], v[18:19], v[50:51]
    v_pk_add_f32 v[20:21], v[20:21], v[52:53]
    v_pk_add_f32 v[22:23], v[22:23], v[54:55]
    v_pk_add_f32 v[24:25], v[24:25], v[56:57]
    v_pk_add_f32 v[26:27], v[26:27], v[58:59]
    v_pk_add_f32 v[28:29], v[28:29], v[60:61]
    v_pk_add_f32 v[30:31], v[30:31], v[62:63]
    v_cvt_pk_bf16_f32 v128, v0, v1
    v_cvt_pk_bf16_f32 v129, v2, v3
    v_cvt_pk_bf16_f32 v130, v8, v9
    v_cvt_pk_bf16_f32 v131, v10, v11
    v_cvt_pk_bf16_f32 v132, v4, v5
    v_cvt_pk_bf16_f32 v133, v6, v7
    v_cvt_pk_bf16_f32 v134, v12, v13
    v_cvt_pk_bf16_f32 v135, v14, v15
    v_cvt_pk_bf16_f32 v136, v16, v17
    v_cvt_pk_bf16_f32 v137, v18, v19
    v_cvt_pk_bf16_f32 v138, v24, v25
    v_cvt_pk_bf16_f32 v139, v26, v27
    v_cvt_pk_bf16_f32 v140, v20, v21
    v_cvt_pk_bf16_f32 v141, v22, v23
    v_cvt_pk_bf16_f32 v142, v28, v29
    v_cvt_pk_bf16_f32 v143, v30, v31
    v_mov_b32_dpp v144, v132 row_newbcast:12 row_mask:0xf bank_mask:0xf
    v_mov_b32_dpp v145, v133 row_newbcast:12 row_mask:0xf bank_mask:0xf
    v_mov_b32_dpp v146, v134 row_newbcast:12 row_mask:0xf bank_mask:0xf
    v_mov_b32_dpp v147, v135 row_newbcast:12 row_mask:0xf bank_mask:0xf
    v_mov_b32_dpp v148, v140 row_newbcast:12 row_mask:0xf bank_mask:0xf
    v_mov_b32_dpp v149, v141 row_newbcast:12 row_mask:0xf bank_mask:0xf
    v_mov_b32_dpp v150, v142 row_newbcast:12 row_mask:0xf bank_mask:0xf
    v_mov_b32_dpp v151, v143 row_newbcast:12 row_mask:0xf bank_mask:0xf
    s_lshl_b32 s24, s15, 2
    s_add_u32 s24, s24, s12
    s_lshl_b32 s30, s24, 6
    s_lshl_b32 s25, s14, 2
    s_add_u32 s30, s30, s25
    s_add_u32 s30, s30, 59773952
    s_lshl_b32 s21, s24, 17
    s_lshl_b32 s25, s14, 11
    s_add_u32 s21, s21, s25
    s_add_u32 s21, s21, 56623104
    s_lshl_b32 s31, s24, 9
    s_add_u32 s31, s31, 58720256
    s_cmp_eq_u32 s14, 0
    s_cselect_b32 s31, s31, 1073741824
L_B2_127:
    s_waitcnt vmcnt(14)
    ds_read_b128 v[0:3], v171 offset:0
    ds_read_b128 v[4:7], v171 offset:1024
    s_waitcnt lgkmcnt(1)
    v_mfma_f32_16x16x32_bf16 v[16:19], a[224:227], v[0:3], 0
    ds_read_b128 v[8:11], v171 offset:2048
    v_mfma_f32_16x16x32_bf16 v[20:23], v[200:203], v[0:3], 0
    s_waitcnt lgkmcnt(1)
    v_mfma_f32_16x16x32_bf16 v[16:19], a[228:231], v[4:7], v[16:19]
    ds_read_b128 v[0:3], v171 offset:3072
    v_mfma_f32_16x16x32_bf16 v[20:23], v[204:207], v[4:7], v[20:23]
    s_waitcnt lgkmcnt(1)
    v_mfma_f32_16x16x32_bf16 v[16:19], a[232:235], v[8:11], v[16:19]
    ds_read_b128 v[4:7], v171 offset:4096
    v_mfma_f32_16x16x32_bf16 v[20:23], v[208:211], v[8:11], v[20:23]
    s_waitcnt lgkmcnt(1)
    v_mfma_f32_16x16x32_bf16 v[16:19], a[236:239], v[0:3], v[16:19]
    ds_read_b128 v[8:11], v171 offset:5120
    v_mfma_f32_16x16x32_bf16 v[20:23], v[212:215], v[0:3], v[20:23]
    s_waitcnt lgkmcnt(1)
    v_mfma_f32_16x16x32_bf16 v[16:19], a[240:243], v[4:7], v[16:19]
    ds_read_b128 v[0:3], v171 offset:6144
    v_mfma_f32_16x16x32_bf16 v[20:23], v[216:219], v[4:7], v[20:23]
    s_waitcnt lgkmcnt(1)
    v_mfma_f32_16x16x32_bf16 v[16:19], a[244:247], v[8:11], v[16:19]
    ds_read_b128 v[4:7], v171 offset:7168
    v_mfma_f32_16x16x32_bf16 v[20:23], v[220:223], v[8:11], v[20:23]
    s_waitcnt lgkmcnt(1)
    v_mfma_f32_16x16x32_bf16 v[16:19], a[248:251], v[0:3], v[16:19]
    ds_read_b128 v[8:11], v171 offset:8192
    v_mfma_f32_16x16x32_bf16 v[20:23], v[224:227], v[0:3], v[20:23]
    s_waitcnt lgkmcnt(1)
    v_mfma_f32_16x16x32_bf16 v[16:19], a[252:255], v[4:7], v[16:19]
    ds_read_b128 v[0:3], v171 offset:9216
    v_mfma_f32_16x16x32_bf16 v[20:23], v[228:231], v[4:7], v[20:23]
    s_waitcnt lgkmcnt(1)
    v_mfma_f32_16x16x32_bf16 v[16:19], v[176:179], v[8:11], v[16:19]
    ds_read_b128 v[4:7], v171 offset:10240
    v_mfma_f32_16x16x32_bf16 v[20:23], v[232:235], v[8:11], v[20:23]
    s_waitcnt lgkmcnt(1)
    v_mfma_f32_16x16x32_bf16 v[16:19], v[180:183], v[0:3], v[16:19]
    ds_read_b128 v[8:11], v171 offset:11264
    v_mfma_f32_16x16x32_bf16 v[20:23], v[236:239], v[0:3], v[20:23]
    s_waitcnt lgkmcnt(1)
    v_mfma_f32_16x16x32_bf16 v[16:19], v[184:187], v[4:7], v[16:19]
    ds_read_b128 v[0:3], v171 offset:12288
    v_mfma_f32_16x16x32_bf16 v[20:23], v[240:243], v[4:7], v[20:23]
    s_waitcnt lgkmcnt(1)
    v_mfma_f32_16x16x32_bf16 v[16:19], v[188:191], v[8:11], v[16:19]
    ds_read_b128 v[4:7], v171 offset:13312
    v_mfma_f32_16x16x32_bf16 v[20:23], v[244:247], v[8:11], v[20:23]
    s_waitcnt lgkmcnt(1)
    v_mfma_f32_16x16x32_bf16 v[16:19], v[192:195], v[0:3], v[16:19]
    v_mfma_f32_16x16x32_bf16 v[20:23], v[248:251], v[0:3], v[20:23]
    s_waitcnt lgkmcnt(0)
    v_mfma_f32_16x16x32_bf16 v[16:19], v[196:199], v[4:7], v[16:19]
    v_mfma_f32_16x16x32_bf16 v[20:23], v[252:255], v[4:7], v[20:23]
    s_add_u32 s24, s16, 28672
    s_add_u32 m0, s17, 0
    s_nop 0
    buffer_load_dwordx4 v170, s[8:11], s24 offen offset:0 lds
    s_add_u32 m0, s17, 960
    s_nop 0
    buffer_load_dwordx4 v170, s[8:11], s24 offen offset:64 lds
    s_add_u32 m0, s17, 1920
    s_nop 0
    buffer_load_dwordx4 v170, s[8:11], s24 offen offset:128 lds
    s_add_u32 m0, s17, 2880
    s_nop 0
    buffer_load_dwordx4 v170, s[8:11], s24 offen offset:192 lds
    s_add_u32 m0, s17, 3840
    s_nop 0
    buffer_load_dwordx4 v170, s[8:11], s24 offen offset:256 lds
    s_add_u32 m0, s17, 4800
    s_nop 0
    buffer_load_dwordx4 v170, s[8:11], s24 offen offset:320 lds
    s_add_u32 m0, s17, 5760
    s_nop 0
    buffer_load_dwordx4 v170, s[8:11], s24 offen offset:384 lds
    s_add_u32 m0, s17, 6720
    s_nop 0
    buffer_load_dwordx4 v170, s[8:11], s24 offen offset:448 lds
    s_add_u32 m0, s17, 7680
    s_nop 0
    buffer_load_dwordx4 v170, s[8:11], s24 offen offset:512 lds
    s_add_u32 m0, s17, 8640
    s_nop 0
    buffer_load_dwordx4 v170, s[8:11], s24 offen offset:576 lds
    s_add_u32 m0, s17, 9600
    s_nop 0
    buffer_load_dwordx4 v170, s[8:11], s24 offen offset:640 lds
    s_add_u32 m0, s17, 10560
    s_nop 0
    buffer_load_dwordx4 v170, s[8:11], s24 offen offset:704 lds
    s_add_u32 m0, s17, 11520
    s_nop 0
    buffer_load_dwordx4 v170, s[8:11], s24 offen offset:768 lds
    s_add_u32 m0, s17, 12480
    s_nop 0
    buffer_load_dwordx4 v170, s[8:11], s24 offen offset:832 lds
    s_waitcnt vmcnt(14)
    ds_read_b128 v[0:3], v171 offset:14336
    ds_read_b128 v[4:7], v171 offset:15360
    s_waitcnt lgkmcnt(1)
    v_mfma_f32_16x16x32_bf16 v[24:27], a[224:227], v[0:3], 0
    ds_read_b128 v[8:11], v171 offset:16384
    v_mfma_f32_16x16x32_bf16 v[28:31], v[200:203], v[0:3], 0
    s_waitcnt lgkmcnt(1)
    v_mfma_f32_16x16x32_bf16 v[24:27], a[228:231], v[4:7], v[24:27]
    ds_read_b128 v[0:3], v171 offset:17408
    v_mfma_f32_16x16x32_bf16 v[28:31], v[204:207], v[4:7], v[28:31]
    s_waitcnt lgkmcnt(1)
    v_mfma_f32_16x16x32_bf16 v[24:27], a[232:235], v[8:11], v[24:27]
    ds_read_b128 v[4:7], v171 offset:18432
    v_mfma_f32_16x16x32_bf16 v[28:31], v[208:211], v[8:11], v[28:31]
    s_waitcnt lgkmcnt(1)
    v_mfma_f32_16x16x32_bf16 v[24:27], a[236:239], v[0:3], v[24:27]
    ds_read_b128 v[8:11], v171 offset:19456
    v_mfma_f32_16x16x32_bf16 v[28:31], v[212:215], v[0:3], v[28:31]
    s_waitcnt lgkmcnt(1)
    v_mfma_f32_16x16x32_bf16 v[24:27], a[240:243], v[4:7], v[24:27]
    ds_read_b128 v[0:3], v171 offset:20480
    v_mfma_f32_16x16x32_bf16 v[28:31], v[216:219], v[4:7], v[28:31]
    s_waitcnt lgkmcnt(1)
    v_mfma_f32_16x16x32_bf16 v[24:27], a[244:247], v[8:11], v[24:27]
    ds_read_b128 v[4:7], v171 offset:21504
    v_mfma_f32_16x16x32_bf16 v[28:31], v[220:223], v[8:11], v[28:31]
    s_waitcnt lgkmcnt(1)
    v_mfma_f32_16x16x32_bf16 v[24:27], a[248:251], v[0:3], v[24:27]
    ds_read_b128 v[8:11], v171 offset:22528
    v_mfma_f32_16x16x32_bf16 v[28:31], v[224:227], v[0:3], v[28:31]
    s_waitcnt lgkmcnt(1)
    v_mfma_f32_16x16x32_bf16 v[24:27], a[252:255], v[4:7], v[24:27]
    ds_read_b128 v[0:3], v171 offset:23552
    v_mfma_f32_16x16x32_bf16 v[28:31], v[228:231], v[4:7], v[28:31]
    s_waitcnt lgkmcnt(1)
    v_mfma_f32_16x16x32_bf16 v[24:27], v[176:179], v[8:11], v[24:27]
    ds_read_b128 v[4:7], v171 offset:24576
    v_mfma_f32_16x16x32_bf16 v[28:31], v[232:235], v[8:11], v[28:31]
    s_waitcnt lgkmcnt(1)
    v_mfma_f32_16x16x32_bf16 v[24:27], v[180:183], v[0:3], v[24:27]
    ds_read_b128 v[8:11], v171 offset:25600
    v_mfma_f32_16x16x32_bf16 v[28:31], v[236:239], v[0:3], v[28:31]
    s_waitcnt lgkmcnt(1)
    v_mfma_f32_16x16x32_bf16 v[24:27], v[184:187], v[4:7], v[24:27]
    ds_read_b128 v[0:3], v171 offset:26624
    v_mfma_f32_16x16x32_bf16 v[28:31], v[240:243], v[4:7], v[28:31]
    s_waitcnt lgkmcnt(1)
    v_mfma_f32_16x16x32_bf16 v[24:27], v[188:191], v[8:11], v[24:27]
    ds_read_b128 v[4:7], v171 offset:27648
    v_mfma_f32_16x16x32_bf16 v[28:31], v[244:247], v[8:11], v[28:31]
    s_waitcnt lgkmcnt(1)
    v_mfma_f32_16x16x32_bf16 v[24:27], v[192:195], v[0:3], v[24:27]
    v_mfma_f32_16x16x32_bf16 v[28:31], v[248:251], v[0:3], v[28:31]
    s_waitcnt lgkmcnt(0)
    v_mfma_f32_16x16x32_bf16 v[24:27], v[196:199], v[4:7], v[24:27]
    v_mfma_f32_16x16x32_bf16 v[28:31], v[252:255], v[4:7], v[28:31]
    s_add_u32 s24, s16, 28672
    s_add_u32 m0, s17, 13440
    s_nop 0
    buffer_load_dwordx4 v170, s[8:11], s24 offen offset:896 lds
    s_add_u32 m0, s17, 14400
    s_nop 0
    buffer_load_dwordx4 v170, s[8:11], s24 offen offset:960 lds
    s_add_u32 m0, s17, 15360
    s_nop 0
    buffer_load_dwordx4 v170, s[8:11], s24 offen offset:1024 lds
    s_add_u32 m0, s17, 16320
    s_nop 0
    buffer_load_dwordx4 v170, s[8:11], s24 offen offset:1088 lds
    s_add_u32 m0, s17, 17280
    s_nop 0
    buffer_load_dwordx4 v170, s[8:11], s24 offen offset:1152 lds
    s_add_u32 m0, s17, 18240
    s_nop 0
    buffer_load_dwordx4 v170, s[8:11], s24 offen offset:1216 lds
    s_add_u32 m0, s17, 19200
    s_nop 0
    buffer_load_dwordx4 v170, s[8:11], s24 offen offset:1280 lds
    s_add_u32 m0, s17, 20160
    s_nop 0
    buffer_load_dwordx4 v170, s[8:11], s24 offen offset:1344 lds
    s_add_u32 m0, s17, 21120
    s_nop 0
    buffer_load_dwordx4 v170, s[8:11], s24 offen offset:1408 lds
    s_add_u32 m0, s17, 22080
    s_nop 0
    buffer_load_dwordx4 v170, s[8:11], s24 offen offset:1472 lds
    s_add_u32 m0, s17, 23040
    s_nop 0
    buffer_load_dwordx4 v170, s[8:11], s24 offen offset:1536 lds
    s_add_u32 m0, s17, 24000
    s_nop 0
    buffer_load_dwordx4 v170, s[8:11], s24 offen offset:1600 lds
    s_add_u32 m0, s17, 24960
    s_nop 0
    buffer_load_dwordx4 v170, s[8:11], s24 offen offset:1664 lds
    s_add_u32 m0, s17, 25920
    s_nop 0
    buffer_load_dwordx4 v170, s[8:11], s24 offen offset:1728 lds
    v_mul_f32 v112, s19, v20
    v_cndmask_b32 v20, v20, v16, s[28:29]
    v_cndmask_b32 v21, v21, v16, s[28:29]
    v_cndmask_b32 v22, v22, v16, s[28:29]
    v_cndmask_b32 v23, v23, v16, s[28:29]
    v_max3_f32 v104, v16, v17, v18
    v_max3_f32 v104, v104, v19, v20
    v_max3_f32 v104, v104, v21, v22
    v_max_f32 v104, v104, v23
    v_min3_f32 v105, v16, v17, v18
    v_min3_f32 v105, v105, v19, v20
    v_min3_f32 v105, v105, v21, v22
    v_min_f32 v105, v105, v23
    v_mul_f32 v113, s19, v28
    v_cndmask_b32 v28, v28, v24, s[28:29]
    v_cndmask_b32 v29, v29, v24, s[28:29]
    v_cndmask_b32 v30, v30, v24, s[28:29]
    v_cndmask_b32 v31, v31, v24, s[28:29]
    v_max3_f32 v106, v24, v25, v26
    v_max3_f32 v106, v106, v27, v28
    v_max3_f32 v106, v106, v29, v30
    v_max_f32 v106, v106, v31
    v_min3_f32 v107, v24, v25, v26
    v_min3_f32 v107, v107, v27, v28
    v_min3_f32 v107, v107, v29, v30
    v_min_f32 v107, v107, v31
    v_mov_b32 v108, v104
    v_mov_b32 v109, v106
    s_nop 0
    v_permlane16_swap_b32 v104, v108
    v_permlane16_swap_b32 v106, v109
    v_max_f32 v104, v104, v108
    v_max_f32 v106, v106, v109
    v_mov_b32 v108, v104
    v_mov_b32 v109, v106
    s_nop 0
    v_permlane32_swap_b32 v104, v108
    v_permlane32_swap_b32 v106, v109
    v_max_f32 v104, v104, v108
    v_max_f32 v106, v106, v109
    v_mov_b32 v108, v105
    v_mov_b32 v109, v107
    s_nop 0
    v_permlane16_swap_b32 v105, v108
    v_permlane16_swap_b32 v107, v109
    v_min_f32 v105, v105, v108
    v_min_f32 v107, v107, v109
    v_mov_b32 v108, v105
    v_mov_b32 v109, v107
    s_nop 0
    v_permlane32_swap_b32 v105, v108
    v_permlane32_swap_b32 v107, v109
    v_min_f32 v105, v105, v108
    v_min_f32 v107, v107, v109
    v_mul_f32 v104, s19, v104
    v_mul_f32 v105, s19, v105
    v_mul_f32 v106, s19, v106
    v_mul_f32 v107, s19, v107
    v_fma_f32 v32, v16, s19, -v104
    v_fma_f32 v40, -v16, s19, v105
    v_fma_f32 v33, v17, s19, -v104
    v_fma_f32 v41, -v17, s19, v105
    v_fma_f32 v34, v18, s19, -v104
    v_fma_f32 v42, -v18, s19, v105
    v_fma_f32 v35, v19, s19, -v104
    v_fma_f32 v43, -v19, s19, v105
    v_fma_f32 v36, v20, s19, -v104
    v_fma_f32 v44, -v20, s19, v105
    v_fma_f32 v37, v21, s19, -v104
    v_fma_f32 v45, -v21, s19, v105
    v_fma_f32 v38, v22, s19, -v104
    v_fma_f32 v46, -v22, s19, v105
    v_fma_f32 v39, v23, s19, -v104
    v_fma_f32 v47, -v23, s19, v105
    v_fma_f32 v48, v24, s19, -v106
    v_fma_f32 v56, -v24, s19, v107
    v_fma_f32 v49, v25, s19, -v106
    v_fma_f32 v57, -v25, s19, v107
    v_fma_f32 v50, v26, s19, -v106
    v_fma_f32 v58, -v26, s19, v107
    v_fma_f32 v51, v27, s19, -v106
    v_fma_f32 v59, -v27, s19, v107
    v_fma_f32 v52, v28, s19, -v106
    v_fma_f32 v60, -v28, s19, v107
    v_fma_f32 v53, v29, s19, -v106
    v_fma_f32 v61, -v29, s19, v107
    v_fma_f32 v54, v30, s19, -v106
    v_fma_f32 v62, -v30, s19, v107
    v_fma_f32 v55, v31, s19, -v106
    v_fma_f32 v63, -v31, s19, v107
    v_exp_f32 v32, v32
    v_exp_f32 v33, v33
    v_exp_f32 v34, v34
    v_exp_f32 v35, v35
    v_exp_f32 v36, v36
    v_exp_f32 v37, v37
    v_exp_f32 v38, v38
    v_exp_f32 v39, v39
    v_exp_f32 v40, v40
    v_exp_f32 v41, v41
    v_exp_f32 v42, v42
    v_exp_f32 v43, v43
    v_exp_f32 v44, v44
    v_exp_f32 v45, v45
    v_exp_f32 v46, v46
    v_exp_f32 v47, v47
    v_exp_f32 v48, v48
    v_exp_f32 v49, v49
    v_exp_f32 v50, v50
    v_exp_f32 v51, v51
    v_exp_f32 v52, v52
    v_exp_f32 v53, v53
    v_exp_f32 v54, v54
    v_exp_f32 v55, v55
    v_exp_f32 v56, v56
    v_exp_f32 v57, v57
    v_exp_f32 v58, v58
    v_exp_f32 v59, v59
    v_exp_f32 v60, v60
    v_exp_f32 v61, v61
    v_exp_f32 v62, v62
    v_exp_f32 v63, v63
    v_exp_f32 v112, -v112
    v_exp_f32 v113, -v113
    v_cndmask_b32 v36, v36, 0, s[28:29]
    v_cndmask_b32 v37, v37, 0, s[28:29]
    v_cndmask_b32 v38, v38, 0, s[28:29]
    v_cndmask_b32 v39, v39, 0, s[28:29]
    v_pk_add_f32 v[108:109], v[32:33], v[34:35]
    v_pk_add_f32 v[110:111], v[36:37], v[38:39]
    v_pk_add_f32 v[108:109], v[108:109], v[110:111]
    v_add_f32 v104, v108, v109
    v_cndmask_b32 v44, v44, 0, s[28:29]
    v_cndmask_b32 v45, v45, 0, s[28:29]
    v_cndmask_b32 v46, v46, 0, s[28:29]
    v_cndmask_b32 v47, v47, 0, s[28:29]
    v_pk_add_f32 v[108:109], v[40:41], v[42:43]
    v_pk_add_f32 v[110:111], v[44:45], v[46:47]
    v_pk_add_f32 v[108:109], v[108:109], v[110:111]
    v_add_f32 v105, v108, v109
    v_cndmask_b32 v52, v52, 0, s[28:29]
    v_cndmask_b32 v53, v53, 0, s[28:29]
    v_cndmask_b32 v54, v54, 0, s[28:29]
    v_cndmask_b32 v55, v55, 0, s[28:29]
    v_pk_add_f32 v[108:109], v[48:49], v[50:51]
    v_pk_add_f32 v[110:111], v[52:53], v[54:55]
    v_pk_add_f32 v[108:109], v[108:109], v[110:111]
    v_add_f32 v106, v108, v109
    v_cndmask_b32 v60, v60, 0, s[28:29]
    v_cndmask_b32 v61, v61, 0, s[28:29]
    v_cndmask_b32 v62, v62, 0, s[28:29]
    v_cndmask_b32 v63, v63, 0, s[28:29]
    v_pk_add_f32 v[108:109], v[56:57], v[58:59]
    v_pk_add_f32 v[110:111], v[60:61], v[62:63]
    v_pk_add_f32 v[108:109], v[108:109], v[110:111]
    v_add_f32 v107, v108, v109
    v_mov_b32 v108, v104
    v_mov_b32 v109, v105
    v_mov_b32 v110, v106
    v_mov_b32 v111, v107
    v_permlane16_swap_b32 v104, v108
    v_permlane16_swap_b32 v105, v109
    v_permlane16_swap_b32 v106, v110
    v_permlane16_swap_b32 v107, v111
    v_add_f32 v104, v104, v108
    v_add_f32 v105, v105, v109
    v_add_f32 v106, v106, v110
    v_add_f32 v107, v107, v111
    v_mov_b32 v108, v104
    v_mov_b32 v109, v105
    v_mov_b32 v110, v106
    v_mov_b32 v111, v107
    v_permlane32_swap_b32 v104, v108
    v_permlane32_swap_b32 v105, v109
    v_permlane32_swap_b32 v106, v110
    v_permlane32_swap_b32 v107, v111
    v_add_f32 v104, v104, v108
    v_add_f32 v105, v105, v109
    v_add_f32 v106, v106, v110
    v_add_f32 v107, v107, v111
    v_rcp_f32 v104, v104
    v_rcp_f32 v105, v105
    v_rcp_f32 v106, v106
    v_rcp_f32 v107, v107
    v_add_f32 v112, 1.0, v112
    v_add_f32 v113, 1.0, v113
    v_rcp_f32 v112, v112
    v_rcp_f32 v113, v113
    v_mul_f32 v32, v32, v104
    v_mul_f32 v33, v33, v104
    v_mul_f32 v34, v34, v104
    v_mul_f32 v35, v35, v104
    v_mul_f32 v36, v36, v104
    v_mul_f32 v37, v37, v104
    v_mul_f32 v38, v38, v104
    v_mul_f32 v39, v39, v104
    v_cvt_pk_bf16_f32 v64, v32, v33
    v_cvt_pk_bf16_f32 v65, v34, v35
    v_cvt_pk_bf16_f32 v66, v36, v37
    v_cvt_pk_bf16_f32 v67, v38, v39
    v_mul_f32 v40, v40, v105
    v_mul_f32 v41, v41, v105
    v_mul_f32 v42, v42, v105
    v_mul_f32 v43, v43, v105
    v_mul_f32 v44, v44, v105
    v_mul_f32 v45, v45, v105
    v_mul_f32 v46, v46, v105
    v_mul_f32 v47, v47, v105
    v_cvt_pk_bf16_f32 v68, v40, v41
    v_cvt_pk_bf16_f32 v69, v42, v43
    v_cvt_pk_bf16_f32 v70, v44, v45
    v_cvt_pk_bf16_f32 v71, v46, v47
    v_mul_f32 v48, v48, v106
    v_mul_f32 v49, v49, v106
    v_mul_f32 v50, v50, v106
    v_mul_f32 v51, v51, v106
    v_mul_f32 v52, v52, v106
    v_mul_f32 v53, v53, v106
    v_mul_f32 v54, v54, v106
    v_mul_f32 v55, v55, v106
    v_cvt_pk_bf16_f32 v72, v48, v49
    v_cvt_pk_bf16_f32 v73, v50, v51
    v_cvt_pk_bf16_f32 v74, v52, v53
    v_cvt_pk_bf16_f32 v75, v54, v55
    v_mul_f32 v56, v56, v107
    v_mul_f32 v57, v57, v107
    v_mul_f32 v58, v58, v107
    v_mul_f32 v59, v59, v107
    v_mul_f32 v60, v60, v107
    v_mul_f32 v61, v61, v107
    v_mul_f32 v62, v62, v107
    v_mul_f32 v63, v63, v107
    v_cvt_pk_bf16_f32 v76, v56, v57
    v_cvt_pk_bf16_f32 v77, v58, v59
    v_cvt_pk_bf16_f32 v78, v60, v61
    v_cvt_pk_bf16_f32 v79, v62, v63
    v_mfma_f32_16x16x32_bf16 v[80:83], v[144:147], v[64:67], 0
    v_mfma_f32_16x16x32_bf16 v[84:87], v[128:131], v[64:67], 0
    v_mfma_f32_16x16x32_bf16 v[88:91], v[132:135], v[64:67], 0
    v_mfma_f32_16x16x32_bf16 v[92:95], v[144:147], v[72:75], 0
    v_mfma_f32_16x16x32_bf16 v[96:99], v[128:131], v[72:75], 0
    v_mfma_f32_16x16x32_bf16 v[100:103], v[132:135], v[72:75], 0
    v_mfma_f32_16x16x32_bf16 v[80:83], v[148:151], v[68:71], v[80:83]
    v_mfma_f32_16x16x32_bf16 v[84:87], v[136:139], v[68:71], v[84:87]
    v_mfma_f32_16x16x32_bf16 v[88:91], v[140:143], v[68:71], v[88:91]
    v_mfma_f32_16x16x32_bf16 v[92:95], v[148:151], v[76:79], v[92:95]
    v_mfma_f32_16x16x32_bf16 v[96:99], v[136:139], v[76:79], v[96:99]
    v_mfma_f32_16x16x32_bf16 v[100:103], v[140:143], v[76:79], v[100:103]
    buffer_store_dwordx2 v[112:113], v174, s[4:7], s31 offen sc1
    v_add_f32 v80, 0x358637bd, v80
    v_rcp_f32 v80, v80
    s_nop 0
    v_mul_f32 v84, v84, v80
    v_mul_f32 v85, v85, v80
    v_mul_f32 v86, v86, v80
    v_mul_f32 v87, v87, v80
    v_mul_f32 v88, v88, v80
    v_mul_f32 v89, v89, v80
    v_mul_f32 v90, v90, v80
    v_mul_f32 v91, v91, v80
    v_cvt_pk_bf16_f32 v64, v84, v85
    v_cvt_pk_bf16_f32 v65, v86, v87
    v_cvt_pk_bf16_f32 v66, v88, v89
    v_cvt_pk_bf16_f32 v67, v90, v91
    buffer_store_dwordx4 v[64:67], v172, s[4:7], s21 offen offset:0 sc1
    v_add_f32 v92, 0x358637bd, v92
    v_rcp_f32 v92, v92
    s_nop 0
    v_mul_f32 v96, v96, v92
    v_mul_f32 v97, v97, v92
    v_mul_f32 v98, v98, v92
    v_mul_f32 v99, v99, v92
    v_mul_f32 v100, v100, v92
    v_mul_f32 v101, v101, v92
    v_mul_f32 v102, v102, v92
    v_mul_f32 v103, v103, v92
    v_cvt_pk_bf16_f32 v68, v96, v97
    v_cvt_pk_bf16_f32 v69, v98, v99
    v_cvt_pk_bf16_f32 v70, v100, v101
    v_cvt_pk_bf16_f32 v71, v102, v103
    buffer_store_dwordx4 v[68:71], v172, s[4:7], s21 offen offset:1024 sc1
    s_add_u32 s16, s16, 28672
    s_add_u32 s21, s21, 32768
    s_add_u32 s31, s31, 128
    s_add_u32 s18, s18, 1
    v_mov_b32 v104, s18
    s_waitcnt vmcnt(0)
    s_mov_b64 exec, 1
    buffer_store_dword v104, v173, s[4:7], s30 offen sc1
    s_mov_b64 exec, -1
    s_cmp_lt_u32 s18, 4
    s_cbranch_scc1 L_B2_127
    s_branch L_fin
L_fin:
L_end:
    s_endpgm
.section .rodata,"a"
.p2align 6
.amdhsa_kernel gated_mix__linear_kernel_hedgehog__memory_aug_recurrent_mem_tr__prompt_kernel
  .amdhsa_next_free_vgpr 512
  .amdhsa_next_free_sgpr 96
  .amdhsa_accum_offset 256
  .amdhsa_group_segment_fixed_size 0
  .amdhsa_kernarg_size 120
  .amdhsa_user_sgpr_count 2
  .amdhsa_user_sgpr_kernarg_segment_ptr 1
  .amdhsa_system_sgpr_workgroup_id_x 1
  .amdhsa_float_denorm_mode_32 3
.end_amdhsa_kernel
```
